```python
import torch

def _softmax(x, axis=-1):
    return torch.softmax(x, dim=axis)
def _gelu(x):
    return torch.nn.functional.gelu(x, approximate="tanh")
def _silu(x):
    return torch.nn.functional.silu(x)
def _sigmoid(x):
    return torch.sigmoid(x)
def _layernorm(x, axis=-1, eps=1e-5):
    m = x.mean(dim=axis, keepdim=True)
    v = x.var(dim=axis, keepdim=True, unbiased=False)
    return (x - m) / torch.sqrt(v + eps)
def _scatter_add(tgt, idx, src, axis=0):
    return tgt.clone().index_add_(axis, idx, src)
def _segment_sum(src, seg, n):
    out = torch.zeros((n,) + src.shape[1:], dtype=src.dtype)
    return out.index_add_(0, seg, src)
def _pad(x, pw):
    flat = tuple(v for pair in reversed(pw) for v in pair)
    return torch.nn.functional.pad(x, flat)

kernel_name = 'gated_mix__ssm_conv_s5__glu_gated_reglu__prompt'

def setup_inputs():

    _w = (lambda a: (lambda t: t.to(torch.bfloat16) if t.is_floating_point() else t)(torch.as_tensor(a)))
    def _A_setup():
        B, S, D = 1, 2048, 1024
        P = D
        Lambda_re = -0.5 * (lambda _x: torch.exp(torch.as_tensor(_x)))((lambda *s: torch.randn(*s, dtype=torch.bfloat16) * 0.2)(P))
        Lambda_im = (lambda *s: torch.randn(*s, dtype=torch.bfloat16) * 0.4)(P) * 1.0
        B_re = (lambda *s: torch.randn(*s, dtype=torch.bfloat16) * 0.2)(P, D) * (D ** -0.5)
        B_im = (lambda *s: torch.randn(*s, dtype=torch.bfloat16) * 0.2)(P, D) * (D ** -0.5)
        C_re = (lambda *s: torch.randn(*s, dtype=torch.bfloat16) * 0.2)(D, P) * (P ** -0.5)
        C_im = (lambda *s: torch.randn(*s, dtype=torch.bfloat16) * 0.2)(D, P) * (P ** -0.5)
        log_dt = (lambda *s: torch.randn(*s, dtype=torch.bfloat16) * 0.2)(P) * 0.3 - 2.0
        Dskip = (lambda *s: torch.randn(*s, dtype=torch.bfloat16) * 0.05)(D)
        return {
            "x": _w((lambda *s: torch.randn(*s, dtype=torch.bfloat16) * 0.05)(B, S, D)),
            "Lambda_re": _w(Lambda_re),
            "Lambda_im": _w(Lambda_im),
            "B_re": _w(B_re),
            "B_im": _w(B_im),
            "C_re": _w(C_re),
            "C_im": _w(C_im),
            "log_dt": _w(log_dt),
            "Dskip": _w(Dskip),
        }
    _A_in = _A_setup()

    def _B_setup():
        B, S, D, F = 1, 2048, 1024, 3584
        return {
            "x": _w((lambda *s: torch.randn(*s, dtype=torch.bfloat16) * 0.05)(B, S, D)),
            "W_gate": _w((lambda *s: torch.randn(*s, dtype=torch.bfloat16) * 0.8)(D, F) * (2.0 / D) ** 0.5),
            "W_up": _w((lambda *s: torch.randn(*s, dtype=torch.bfloat16) * 0.8)(D, F) * (2.0 / D) ** 0.5),
            "W_down": _w((lambda *s: torch.randn(*s, dtype=torch.bfloat16) * 0.8)(F, D) * (1.0 / F) ** 0.5),
        }
    _B_in = _B_setup()

    return {
        "A_x": _A_in["x"],
        "A_Lambda_re": _A_in["Lambda_re"],
        "A_Lambda_im": _A_in["Lambda_im"],
        "A_B_re": _A_in["B_re"],
        "A_B_im": _A_in["B_im"],
        "A_C_re": _A_in["C_re"],
        "A_C_im": _A_in["C_im"],
        "A_log_dt": _A_in["log_dt"],
        "A_Dskip": _A_in["Dskip"],
        "B_x": _B_in["x"],
        "B_W_gate": _B_in["W_gate"],
        "B_W_up": _B_in["W_up"],
        "B_W_down": _B_in["W_down"],
        "gate_w": _w((lambda *s: torch.randn(*s, dtype=torch.bfloat16) * 0.05)(1024) * 16.0),
    }

def reference(A_x, A_Lambda_re, A_Lambda_im, A_B_re, A_B_im, A_C_re, A_C_im, A_log_dt, A_Dskip, B_x, B_W_gate, B_W_up, B_W_down, gate_w):
    def _A_ref(x, Lambda_re, Lambda_im, B_re, B_im, C_re, C_im, log_dt, Dskip):
        Bsz, L, H = x.shape
        Lam = Lambda_re + 1j * Lambda_im
        Bmat = B_re + 1j * B_im
        Cmat = C_re + 1j * C_im
        dt = torch.exp(log_dt)
        Lam_bar = torch.exp(dt * Lam)
        B_bar = ((Lam_bar - 1.0) / Lam)[:, None] * Bmat
        Bu = torch.einsum("bld,pd->blp", x + 0j, B_bar)
        h = torch.zeros_like(Bu[:, 0, :])
        hs = []
        for t in range(L):
            h = Lam_bar[None, :] * h + Bu[:, t, :]
            hs.append(h)
        hseq = torch.stack(hs, 1)
        y = 2.0 * torch.einsum("blp,dp->bld", hseq, Cmat).real + x * Dskip[None, None, :]
        return y

    def _B_ref(x, W_gate, W_up, W_down):
        gate = torch.einsum("bsd,df->bsf", x, W_gate)
        up = torch.einsum("bsd,df->bsf", x, W_up)
        gate = gate * (lambda x, dt: x.to(dt))(gate > 0, gate.dtype)
        h = gate * up
        return torch.einsum("bsf,fd->bsd", h, W_down)

    x = A_x
    g = _sigmoid((x * gate_w).sum(-1, keepdims=True))
    a = _A_ref(x, A_Lambda_re, A_Lambda_im, A_B_re, A_B_im, A_C_re, A_C_im, A_log_dt, A_Dskip)
    b = _B_ref(x, B_W_gate, B_W_up, B_W_down)
    return g * a + (1 - g) * b
```

```asm
; @launch grid=(256,1,1) block=(256,1,1) lds=163840
.amdgcn_target "amdgcn-amd-amdhsa--gfx950"
.text
.globl gated_mix__ssm_conv_s5__glu_gated_reglu__prompt_kernel
.p2align 8
.type gated_mix__ssm_conv_s5__glu_gated_reglu__prompt_kernel,@function
gated_mix__ssm_conv_s5__glu_gated_reglu__prompt_kernel:
    s_cmp_ge_u32 s2, 256
    s_cbranch_scc1 K1_done
    s_load_dwordx16 s[36:51], s[0:1], 0
    s_load_dwordx16 s[52:67], s[0:1], 64
    s_load_dwordx2 s[68:69], s[0:1], 128
    s_getpc_b64 s[84:85]
CT1:
    s_add_u32 s84, s84, CP_a-CT1
    s_addc_u32 s85, s85, 0
    v_lshlrev_b32 v26, 7, v0
    v_min_u32 v26, CP_b-CP_a-4, v26
    global_load_dword a255, v26, s[84:85]
CP_a:
    v_lshrrev_b32 v16, 6, v0
    v_and_b32 v17, 63, v0
    v_readfirstlane_b32 s3, v16
    s_lshr_b32 s4, s2, 5
    s_and_b32 s5, s2, 7
    s_lshl_b32 s5, s5, 2
    s_bfe_u32 s6, s2, 0x20003
    s_add_u32 s5, s5, s6
    v_and_b32 v18, 15, v0
    v_bfe_u32 v19, v0, 4, 2
    v_lshrrev_b32 v20, 3, v17
    v_and_b32 v21, 7, v17
    v_xor_b32 v21, v21, v20
    s_lshl_b32 s6, s4, 8
    s_lshl_b32 s7, s3, 6
    s_add_u32 s6, s6, s7
    v_lshl_add_u32 v1, v20, 2, s6
    v_lshlrev_b32 v1, 11, v1
    v_lshl_add_u32 v1, v21, 4, v1
    v_add_u32 v2, 0xfc00, v1
    s_mov_b32 s10, 0x400000
    s_mov_b32 s11, 0x00020000
    s_mov_b32 s14, 0x700000
    s_mov_b32 s15, 0x00020000
    s_mov_b32 s18, 0x200000
    s_mov_b32 s19, 0x00020000
    s_mov_b32 s22, 0x10000000
    s_mov_b32 s23, 0x00020000
    s_mov_b32 s26, 256
    s_mov_b32 s27, 0x00020000
    s_mov_b32 s90, 0x700000
    s_mov_b32 s91, 0x00020000
    s_mov_b32 s28, 0
    s_mov_b32 s29, 4096
    s_mov_b32 s30, 0
    s_mov_b32 s31, 0
    s_mov_b32 s77, 0x70000000
    s_lshl_b32 s32, s3, 12
    s_add_u32 s32, s32, 65536
    s_lshl_b32 s34, s3, 14
    s_lshl_b32 s35, s3, 11
    s_add_u32 s35, s35, 131072
    v_lshrrev_b32 v22, 2, v20
    v_and_b32 v23, 3, v20
    v_lshl_add_u32 v22, v22, 3, v23
    s_and_b32 s7, s3, 1
    s_lshl_b32 s6, s5, 5
    s_lshl_b32 s70, s7, 2
    s_add_u32 s6, s6, s70
    v_add_u32 v22, s6, v22
    v_lshlrev_b32 v22, 11, v22
    v_lshl_add_u32 v10, v21, 4, v22
    v_add_u32 v11, 0x7c00, v10
    s_mul_i32 s72, s5, 224
    s_mul_i32 s70, s7, 28672
    s_add_u32 s72, s72, s70
    s_and_b32 s73, s5, 1
    s_lshl_b32 s73, s73, 1
    s_movk_i32 s74, 4682
    s_movk_i32 s75, 7168
    s_waitcnt lgkmcnt(0)
    s_mov_b32 s8, s36
    s_mov_b32 s9, s37
    s_cmp_ge_u32 s3, 2
    s_cselect_b32 s12, s58, s56
    s_cselect_b32 s13, s59, s57
    s_cselect_b32 s16, s44, s42
    s_cselect_b32 s17, s45, s43
    s_cselect_b32 s86, s48, s46
    s_cselect_b32 s87, s49, s47
    s_mov_b32 s20, s68
    s_mov_b32 s21, s69
    s_mov_b32 s24, s66
    s_mov_b32 s25, s67
    s_mov_b32 s88, s60
    s_mov_b32 s89, s61
    s_lshl_b32 s6, s4, 8
    s_lshl_b32 s70, s5, 3
    s_add_u32 s6, s6, s70
    s_lshl_b32 s70, s3, 1
    s_add_u32 s71, s6, s70
    v_and_b32 v24, 31, v0
    v_lshl_add_u32 v24, s5, 5, v24
    v_lshlrev_b32 v24, 1, v24
    global_load_ushort v48, v24, s[38:39]
    global_load_ushort v49, v24, s[40:41]
    global_load_ushort v50, v24, s[50:51]
    s_lshl_b32 s6, s4, 1
    s_lshr_b32 s7, s3, 1
    s_add_u32 s6, s6, s7
    s_lshl_b32 s6, s6, 6
    s_lshl_b32 s7, s5, 1
    s_add_u32 s6, s6, s7
    s_and_b32 s7, s3, 1
    s_add_u32 s6, s6, s7
    s_lshl_b32 s76, s6, 7
    s_add_u32 s76, s76, 24117248
    s_add_u32 s7, s76, 0x20000
    v_mov_b32 v21, 0
    s_lshl_b32 s70, s71, 11
    v_lshlrev_b32 v25, 5, v17
    s_lshl_b32 s6, s2, 2
    s_add_u32 s6, s6, s3
    s_lshl_b32 s6, s6, 7
    s_add_u32 s6, s6, 24379392
    buffer_load_dwordx4 v[96:99], v25, s[8:11], s70 offen
    buffer_load_dwordx4 v[100:103], v25, s[8:11], s70 offen offset:16
    buffer_load_dwordx4 v[104:107], v25, s[8:11], s70 offen offset:2048
    buffer_load_dwordx4 v[108:111], v25, s[8:11], s70 offen offset:2064
    global_load_dwordx4 v[112:115], v25, s[62:63]
    global_load_dwordx4 v[116:119], v25, s[62:63] offset:16
    s_mov_b64 exec, 1
    buffer_store_dword v21, off, s[20:23], s76 sc1
    buffer_store_dword v21, off, s[20:23], s7 sc1
    buffer_store_dword v21, off, s[20:23], s6 sc1
    s_mov_b64 exec, -1
    s_and_b32 s7, s3, 1
    s_add_u32 m0, s34, 0
    s_nop 0
    buffer_load_dwordx4 v1, s[8:11], s28 offen offset:0  lds
    s_add_u32 m0, s34, 0
    s_nop 0
    buffer_load_dwordx4 v2, s[8:11], s28 offen offset:1024  lds
    s_add_u32 m0, s34, 0
    s_nop 0
    buffer_load_dwordx4 v1, s[8:11], s28 offen offset:2048  lds
    s_add_u32 m0, s34, 0
    s_nop 0
    buffer_load_dwordx4 v2, s[8:11], s28 offen offset:3072  lds
    s_add_u32 m0, s34, 4096
    s_nop 0
    buffer_load_dwordx4 v1, s[8:11], s29 offen offset:0  lds
    s_add_u32 m0, s34, 4096
    s_nop 0
    buffer_load_dwordx4 v2, s[8:11], s29 offen offset:1024  lds
    s_add_u32 m0, s34, 4096
    s_nop 0
    buffer_load_dwordx4 v1, s[8:11], s29 offen offset:2048  lds
    s_add_u32 m0, s34, 4096
    s_nop 0
    buffer_load_dwordx4 v2, s[8:11], s29 offen offset:3072  lds
    s_add_u32 s28, s28, 128
    s_cmp_lt_u32 s28, 2048
    s_cselect_b32 s28, s28, s77
    s_add_u32 s29, s28, 4096
    v_add_u32 v20, 0, v17
    v_mul_u32_u24 v21, s74, v20
    v_lshrrev_b32 v21, 16, v21
    v_mul_u32_u24 v22, 14, v21
    v_sub_u32 v22, v20, v22
    v_add_u32 v22, s73, v22
    v_subrev_u32 v23, 14, v22
    v_min_u32 v22, v22, v23
    v_lshrrev_b32 v23, 2, v21
    v_and_b32 v21, 3, v21
    v_lshl_add_u32 v21, v23, 3, v21
    v_mul_u32_u24 v21, s75, v21
    v_lshl_add_u32 v21, v22, 4, v21
    v_add_u32 v21, s72, v21
    v_subrev_u32 v3, 0, v21
    s_add_u32 m0, s32, 0
    s_nop 0
    buffer_load_dwordx4 v3, s[12:15], s30 offen offset:0 nt lds
    v_add_u32 v20, 64, v17
    v_mul_u32_u24 v21, s74, v20
    v_lshrrev_b32 v21, 16, v21
    v_mul_u32_u24 v22, 14, v21
    v_sub_u32 v22, v20, v22
    v_add_u32 v22, s73, v22
    v_subrev_u32 v23, 14, v22
    v_min_u32 v22, v22, v23
    v_lshrrev_b32 v23, 2, v21
    v_and_b32 v21, 3, v21
    v_lshl_add_u32 v21, v23, 3, v21
    v_mul_u32_u24 v21, s75, v21
    v_lshl_add_u32 v21, v22, 4, v21
    v_add_u32 v21, s72, v21
    v_subrev_u32 v4, 1024, v21
    s_add_u32 m0, s32, 0
    s_nop 0
    buffer_load_dwordx4 v4, s[12:15], s30 offen offset:1024 nt lds
    v_add_u32 v20, 128, v17
    v_mul_u32_u24 v21, s74, v20
    v_lshrrev_b32 v21, 16, v21
    v_mul_u32_u24 v22, 14, v21
    v_sub_u32 v22, v20, v22
    v_add_u32 v22, s73, v22
    v_subrev_u32 v23, 14, v22
    v_min_u32 v22, v22, v23
    v_lshrrev_b32 v23, 2, v21
    v_and_b32 v21, 3, v21
    v_lshl_add_u32 v21, v23, 3, v21
    v_mul_u32_u24 v21, s75, v21
    v_lshl_add_u32 v21, v22, 4, v21
    v_add_u32 v21, s72, v21
    v_subrev_u32 v5, 2048, v21
    s_add_u32 m0, s32, 0
    s_nop 0
    buffer_load_dwordx4 v5, s[12:15], s30 offen offset:2048 nt lds
    v_add_u32 v20, 192, v17
    v_mul_u32_u24 v21, s74, v20
    v_lshrrev_b32 v21, 16, v21
    v_mul_u32_u24 v22, 14, v21
    v_sub_u32 v22, v20, v22
    v_add_u32 v22, s73, v22
    v_subrev_u32 v23, 14, v22
    v_min_u32 v22, v22, v23
    v_lshrrev_b32 v23, 2, v21
    v_and_b32 v21, 3, v21
    v_lshl_add_u32 v21, v23, 3, v21
    v_mul_u32_u24 v21, s75, v21
    v_lshl_add_u32 v21, v22, 4, v21
    v_add_u32 v21, s72, v21
    v_subrev_u32 v6, 3072, v21
    v_mov_b32 v20, s77
    v_cmp_gt_u32 vcc, 32, v17
    s_nop 1
    v_cndmask_b32 v6, v20, v6, vcc
    s_add_u32 m0, s32, 0
    s_nop 0
    buffer_load_dwordx4 v6, s[12:15], s30 offen offset:3072 nt lds
    s_add_u32 s30, s30, 229376
    s_waitcnt vmcnt(15)
    v_lshlrev_b32 v48, 16, v48
    s_add_u32 m0, s35, 0
    s_nop 0
    buffer_load_dwordx4 v10, s[16:19], s31 offen offset:0 nt lds
    v_and_b32 v123, 0xffff0000, v112
    v_lshlrev_b32 v49, 16, v49
    v_lshlrev_b32 v122, 16, v112
    v_lshlrev_b32 v50, 16, v50
    v_and_b32 v129, 0xffff0000, v96
    v_mul_f32 v50, 0x3fb8aa3b, v50
    v_lshlrev_b32 v128, 16, v96
    v_exp_f32 v50, v50
    v_pk_mul_f32 v[128:129], v[128:129], v[122:123]
    v_cvt_pk_bf16_f32 v50, v50, v50
    v_cvt_pk_bf16_f32 v128, v128, v129
    v_lshlrev_b32 v50, 16, v50
    v_and_b32 v129, 0xffff0000, v128
    v_mul_f32 v51, v50, v48
    s_add_u32 m0, s35, 0
    s_nop 0
    buffer_load_dwordx4 v11, s[16:19], s31 offen offset:1024 nt lds
    s_add_u32 s31, s31, 128
    s_cmp_lt_u32 s31, 2048
    s_cselect_b32 s31, s31, s77
    v_lshlrev_b32 v128, 16, v128
    v_mul_f32 v52, v50, v49
    v_mov_b64 v[124:125], v[128:129]
    v_mul_f32 v51, 0x3fb8aa3b, v51
    v_and_b32 v131, 0xffff0000, v104
    v_exp_f32 v51, v51
    v_lshlrev_b32 v130, 16, v104
    v_mul_f32 v52, 0.15915494, v52
    v_pk_mul_f32 v[130:131], v[130:131], v[122:123]
    v_fract_f32 v52, v52
    v_cvt_pk_bf16_f32 v130, v130, v131
    v_cos_f32 v53, v52
    v_and_b32 v131, 0xffff0000, v130
    v_sin_f32 v54, v52
    s_add_u32 m0, s32, 16384
    s_nop 0
    buffer_load_dwordx4 v3, s[12:15], s30 offen offset:0 nt lds
    v_lshlrev_b32 v130, 16, v130
    v_mul_f32 v64, v51, v53
    v_mov_b64 v[126:127], v[130:131]
    v_mul_f32 v65, v51, v54
    v_and_b32 v123, 0xffff0000, v113
    v_add_f32 v51, -1.0, v64
    v_lshlrev_b32 v122, 16, v113
    v_mul_f32 v52, v48, v48
    v_and_b32 v129, 0xffff0000, v97
    v_fmac_f32 v52, v49, v49
    v_lshlrev_b32 v128, 16, v97
    v_rcp_f32 v53, v52
    v_pk_mul_f32 v[128:129], v[128:129], v[122:123]
    v_mul_f32 v54, v51, v48
    s_add_u32 m0, s32, 16384
    s_nop 0
    buffer_load_dwordx4 v4, s[12:15], s30 offen offset:1024 nt lds
    v_cvt_pk_bf16_f32 v128, v128, v129
    v_fmac_f32 v54, v65, v49
    v_and_b32 v129, 0xffff0000, v128
    v_mul_f32 v55, v65, v48
    v_lshlrev_b32 v128, 16, v128
    v_fma_f32 v55, -v51, v49, v55
    v_pk_add_f32 v[124:125], v[124:125], v[128:129]
    v_fma_f32 v52, -v52, v53, 2.0
    v_and_b32 v131, 0xffff0000, v105
    v_mul_f32 v53, v53, v52
    v_lshlrev_b32 v130, 16, v105
    v_add_f32 v53, v53, v53
    v_pk_mul_f32 v[130:131], v[130:131], v[122:123]
    v_mul_f32 v88, v54, v53
    s_add_u32 m0, s32, 16384
    s_nop 0
    buffer_load_dwordx4 v5, s[12:15], s30 offen offset:2048 nt lds
    v_cvt_pk_bf16_f32 v130, v130, v131
    v_mul_f32 v89, v55, v53
    v_and_b32 v131, 0xffff0000, v130
    v_mul_f32 v66, v64, v64
    v_lshlrev_b32 v130, 16, v130
    v_fma_f32 v66, -v65, v65, v66
    v_pk_add_f32 v[126:127], v[126:127], v[130:131]
    v_mul_f32 v67, v64, v65
    v_and_b32 v123, 0xffff0000, v114
    v_add_f32 v67, v67, v67
    v_lshlrev_b32 v122, 16, v114
    v_mul_f32 v68, v66, v66
    v_and_b32 v129, 0xffff0000, v98
    v_fma_f32 v68, -v67, v67, v68
    s_add_u32 m0, s32, 16384
    s_nop 0
    buffer_load_dwordx4 v6, s[12:15], s30 offen offset:3072 nt lds
    s_add_u32 s30, s30, 229376
    v_lshlrev_b32 v128, 16, v98
    v_mul_f32 v69, v66, v67
    v_pk_mul_f32 v[128:129], v[128:129], v[122:123]
    v_add_f32 v69, v69, v69
    v_cvt_pk_bf16_f32 v128, v128, v129
    v_mul_f32 v70, v68, v68
    v_and_b32 v129, 0xffff0000, v128
    v_fma_f32 v70, -v69, v69, v70
    v_lshlrev_b32 v128, 16, v128
    v_mul_f32 v71, v68, v69
    v_pk_add_f32 v[124:125], v[124:125], v[128:129]
    v_add_f32 v71, v71, v71
    v_and_b32 v131, 0xffff0000, v106
    v_mul_f32 v72, v70, v70
    s_add_u32 m0, s34, 8192
    s_nop 0
    buffer_load_dwordx4 v1, s[8:11], s28 offen offset:0  lds
    v_lshlrev_b32 v130, 16, v106
    v_fma_f32 v72, -v71, v71, v72
    v_pk_mul_f32 v[130:131], v[130:131], v[122:123]
    v_mul_f32 v73, v70, v71
    v_cvt_pk_bf16_f32 v130, v130, v131
    v_add_f32 v73, v73, v73
    v_and_b32 v131, 0xffff0000, v130
    v_mul_f32 v74, v72, v72
    v_lshlrev_b32 v130, 16, v130
    v_fma_f32 v74, -v73, v73, v74
    v_pk_add_f32 v[126:127], v[126:127], v[130:131]
    v_mul_f32 v75, v72, v73
    v_and_b32 v123, 0xffff0000, v115
    v_add_f32 v75, v75, v75
    s_add_u32 m0, s34, 8192
    s_nop 0
    buffer_load_dwordx4 v2, s[8:11], s28 offen offset:1024  lds
    v_lshlrev_b32 v122, 16, v115
    v_mul_f32 v76, v74, v74
    v_and_b32 v129, 0xffff0000, v99
    v_fma_f32 v76, -v75, v75, v76
    v_lshlrev_b32 v128, 16, v99
    v_mul_f32 v77, v74, v75
    v_pk_mul_f32 v[128:129], v[128:129], v[122:123]
    v_add_f32 v77, v77, v77
    v_cvt_pk_bf16_f32 v128, v128, v129
    v_mul_f32 v78, v76, v76
    v_and_b32 v129, 0xffff0000, v128
    v_fma_f32 v78, -v77, v77, v78
    v_lshlrev_b32 v128, 16, v128
    v_mul_f32 v79, v76, v77
    s_add_u32 m0, s34, 8192
    s_nop 0
    buffer_load_dwordx4 v1, s[8:11], s28 offen offset:2048  lds
    v_pk_add_f32 v[124:125], v[124:125], v[128:129]
    v_add_f32 v79, v79, v79
    v_and_b32 v131, 0xffff0000, v107
    v_mul_f32 v80, v78, v78
    v_lshlrev_b32 v130, 16, v107
    v_fma_f32 v80, -v79, v79, v80
    v_pk_mul_f32 v[130:131], v[130:131], v[122:123]
    v_mul_f32 v81, v78, v79
    v_cvt_pk_bf16_f32 v130, v130, v131
    v_add_f32 v81, v81, v81
    v_and_b32 v131, 0xffff0000, v130
    v_mul_f32 v82, v80, v80
    v_lshlrev_b32 v130, 16, v130
    v_fma_f32 v82, -v81, v81, v82
    s_add_u32 m0, s34, 8192
    s_nop 0
    buffer_load_dwordx4 v2, s[8:11], s28 offen offset:3072  lds
    v_pk_add_f32 v[126:127], v[126:127], v[130:131]
    v_mul_f32 v83, v80, v81
    v_and_b32 v123, 0xffff0000, v116
    v_add_f32 v83, v83, v83
    v_lshlrev_b32 v122, 16, v116
    v_lshrrev_b32 v51, 5, v0
    v_and_b32 v129, 0xffff0000, v100
    v_mov_b32 v56, 1.0
    v_lshlrev_b32 v128, 16, v100
    v_mov_b32 v57, 0
    v_pk_mul_f32 v[128:129], v[128:129], v[122:123]
    v_mov_b32 v60, 1.0
    v_cvt_pk_bf16_f32 v128, v128, v129
    v_mov_b32 v61, 0
    s_add_u32 m0, s34, 12288
    s_nop 0
    buffer_load_dwordx4 v1, s[8:11], s29 offen offset:0  lds
    v_and_b32 v129, 0xffff0000, v128
    v_and_b32 v54, 1, v51
    v_lshlrev_b32 v128, 16, v128
    v_cmp_ne_u32 vcc, 0, v54
    v_pk_add_f32 v[124:125], v[124:125], v[128:129]
    v_mul_f32 v52, v56, v68
    v_and_b32 v131, 0xffff0000, v108
    v_fma_f32 v52, -v57, v69, v52
    v_lshlrev_b32 v130, 16, v108
    v_mul_f32 v53, v56, v69
    v_pk_mul_f32 v[130:131], v[130:131], v[122:123]
    v_fmac_f32 v53, v57, v68
    v_cvt_pk_bf16_f32 v130, v130, v131
    v_mul_f32 v62, v60, v76
    s_add_u32 m0, s34, 12288
    s_nop 0
    buffer_load_dwordx4 v2, s[8:11], s29 offen offset:1024  lds
    v_and_b32 v131, 0xffff0000, v130
    v_fma_f32 v62, -v61, v77, v62
    v_lshlrev_b32 v130, 16, v130
    v_mul_f32 v63, v60, v77
    v_pk_add_f32 v[126:127], v[126:127], v[130:131]
    v_fmac_f32 v63, v61, v76
    v_and_b32 v123, 0xffff0000, v117
    v_cndmask_b32 v56, v56, v52, vcc
    v_lshlrev_b32 v122, 16, v117
    v_cndmask_b32 v57, v57, v53, vcc
    v_and_b32 v129, 0xffff0000, v101
    v_cndmask_b32 v60, v60, v62, vcc
    v_lshlrev_b32 v128, 16, v101
    v_cndmask_b32 v61, v61, v63, vcc
    s_add_u32 m0, s34, 12288
    s_nop 0
    buffer_load_dwordx4 v1, s[8:11], s29 offen offset:2048  lds
    v_pk_mul_f32 v[128:129], v[128:129], v[122:123]
    v_and_b32 v54, 2, v51
    v_cvt_pk_bf16_f32 v128, v128, v129
    v_cmp_ne_u32 vcc, 0, v54
    v_and_b32 v129, 0xffff0000, v128
    v_mul_f32 v52, v56, v70
    v_lshlrev_b32 v128, 16, v128
    v_fma_f32 v52, -v57, v71, v52
    v_pk_add_f32 v[124:125], v[124:125], v[128:129]
    v_mul_f32 v53, v56, v71
    v_and_b32 v131, 0xffff0000, v109
    v_fmac_f32 v53, v57, v70
    v_lshlrev_b32 v130, 16, v109
    v_mul_f32 v62, v60, v78
    s_add_u32 m0, s34, 12288
    s_nop 0
    buffer_load_dwordx4 v2, s[8:11], s29 offen offset:3072  lds
    s_add_u32 s28, s28, 128
    s_cmp_lt_u32 s28, 2048
    s_cselect_b32 s28, s28, s77
    s_add_u32 s29, s28, 4096
    v_pk_mul_f32 v[130:131], v[130:131], v[122:123]
    v_fma_f32 v62, -v61, v79, v62
    v_cvt_pk_bf16_f32 v130, v130, v131
    v_mul_f32 v63, v60, v79
    v_and_b32 v131, 0xffff0000, v130
    v_fmac_f32 v63, v61, v78
    v_lshlrev_b32 v130, 16, v130
    v_cndmask_b32 v56, v56, v52, vcc
    v_pk_add_f32 v[126:127], v[126:127], v[130:131]
    v_cndmask_b32 v57, v57, v53, vcc
    v_and_b32 v123, 0xffff0000, v118
    v_cndmask_b32 v60, v60, v62, vcc
    v_lshlrev_b32 v122, 16, v118
    v_cndmask_b32 v61, v61, v63, vcc
    s_add_u32 m0, s32, 32768
    s_nop 0
    buffer_load_dwordx4 v3, s[12:15], s30 offen offset:0 nt lds
    v_and_b32 v129, 0xffff0000, v102
    v_and_b32 v54, 4, v51
    v_lshlrev_b32 v128, 16, v102
    v_cmp_ne_u32 vcc, 0, v54
    v_pk_mul_f32 v[128:129], v[128:129], v[122:123]
    v_mul_f32 v52, v56, v72
    v_cvt_pk_bf16_f32 v128, v128, v129
    v_fma_f32 v52, -v57, v73, v52
    v_and_b32 v129, 0xffff0000, v128
    v_mul_f32 v53, v56, v73
    v_lshlrev_b32 v128, 16, v128
    v_fmac_f32 v53, v57, v72
    v_pk_add_f32 v[124:125], v[124:125], v[128:129]
    v_mul_f32 v62, v60, v80
    s_add_u32 m0, s32, 32768
    s_nop 0
    buffer_load_dwordx4 v4, s[12:15], s30 offen offset:1024 nt lds
    v_and_b32 v131, 0xffff0000, v110
    v_fma_f32 v62, -v61, v81, v62
    v_lshlrev_b32 v130, 16, v110
    v_mul_f32 v63, v60, v81
    v_pk_mul_f32 v[130:131], v[130:131], v[122:123]
    v_fmac_f32 v63, v61, v80
    v_cvt_pk_bf16_f32 v130, v130, v131
    v_cndmask_b32 v56, v56, v52, vcc
    v_and_b32 v131, 0xffff0000, v130
    v_cndmask_b32 v57, v57, v53, vcc
    v_lshlrev_b32 v130, 16, v130
    v_cndmask_b32 v60, v60, v62, vcc
    v_pk_add_f32 v[126:127], v[126:127], v[130:131]
    v_cndmask_b32 v61, v61, v63, vcc
    s_add_u32 m0, s32, 32768
    s_nop 0
    buffer_load_dwordx4 v5, s[12:15], s30 offen offset:2048 nt lds
    v_and_b32 v123, 0xffff0000, v119
    v_mul_f32 v58, v56, v74
    v_lshlrev_b32 v122, 16, v119
    v_fma_f32 v58, -v57, v75, v58
    v_and_b32 v129, 0xffff0000, v103
    v_mul_f32 v59, v56, v75
    v_lshlrev_b32 v128, 16, v103
    v_fmac_f32 v59, v57, v74
    v_pk_mul_f32 v[128:129], v[128:129], v[122:123]
    v_mul_f32 v62, v60, v82
    v_cvt_pk_bf16_f32 v128, v128, v129
    v_fma_f32 v62, -v61, v83, v62
    v_and_b32 v129, 0xffff0000, v128
    v_mul_f32 v63, v60, v83
    s_add_u32 m0, s32, 32768
    s_nop 0
    buffer_load_dwordx4 v6, s[12:15], s30 offen offset:3072 nt lds
    s_add_u32 s30, s30, 229376
    v_lshlrev_b32 v128, 16, v128
    v_fmac_f32 v63, v61, v82
    v_pk_add_f32 v[124:125], v[124:125], v[128:129]
    v_mul_f32 v84, v62, v82
    v_and_b32 v131, 0xffff0000, v111
    v_fma_f32 v84, -v63, v83, v84
    v_lshlrev_b32 v130, 16, v111
    v_mul_f32 v85, v62, v83
    v_pk_mul_f32 v[130:131], v[130:131], v[122:123]
    v_fmac_f32 v85, v63, v82
    v_cvt_pk_bf16_f32 v130, v130, v131
    v_mul_f32 v86, v84, v82
    v_and_b32 v131, 0xffff0000, v130
    v_fma_f32 v86, -v85, v83, v86
    s_add_u32 m0, s35, 8192
    s_nop 0
    buffer_load_dwordx4 v10, s[16:19], s31 offen offset:0 nt lds
    v_lshlrev_b32 v130, 16, v130
    v_mul_f32 v87, v84, v83
    v_pk_add_f32 v[126:127], v[126:127], v[130:131]
    v_fmac_f32 v87, v85, v82
    v_add_f32 v124, v124, v125
    v_and_b32 v52, 31, v0
    v_add_f32 v126, v126, v127
    v_lshlrev_b32 v52, 2, v52
    v_add_f32_dpp v124, v124, v124 row_shr:1 row_mask:0xf bank_mask:0xf bound_ctrl:0
    v_lshl_add_u32 v53, v51, 8, v52
    v_add_f32_dpp v126, v126, v126 row_shr:1 row_mask:0xf bank_mask:0xf bound_ctrl:0
    v_add_u32 v53, 149504, v53
    v_add_f32_dpp v124, v124, v124 row_shr:2 row_mask:0xf bank_mask:0xf bound_ctrl:0
    v_add_u32 v52, 147456, v52
    s_add_u32 m0, s35, 8192
    s_nop 0
    buffer_load_dwordx4 v11, s[16:19], s31 offen offset:1024 nt lds
    s_add_u32 s31, s31, 128
    s_cmp_lt_u32 s31, 2048
    s_cselect_b32 s31, s31, s77
    v_add_f32_dpp v126, v126, v126 row_shr:2 row_mask:0xf bank_mask:0xf bound_ctrl:0
    ds_write2_b32 v53, v56, v57 offset0:0 offset1:32
    v_add_f32_dpp v124, v124, v124 row_shr:4 row_mask:0xf bank_mask:0xf bound_ctrl:0
    ds_write_b32 v53, v58 offset:2048
    v_add_f32_dpp v126, v126, v126 row_shr:4 row_mask:0xf bank_mask:0xf bound_ctrl:0
    ds_write_b32 v53, v59 offset:2176
    v_add_f32_dpp v124, v124, v124 row_shr:8 row_mask:0xf bank_mask:0xf bound_ctrl:0
    ds_write_b32 v53, v60 offset:4096
    v_add_f32_dpp v126, v126, v126 row_shr:8 row_mask:0xf bank_mask:0xf bound_ctrl:0
    ds_write_b32 v53, v61 offset:4224
    v_readlane_b32 s78, v124, 15
    ds_write_b32 v53, v62 offset:6144
    v_readlane_b32 s79, v124, 31
    ds_write_b32 v53, v63 offset:6272
    s_add_u32 m0, s32, 49152
    s_nop 0
    buffer_load_dwordx4 v3, s[12:15], s30 offen offset:0 nt lds
    v_readlane_b32 s80, v124, 47
    ds_write_b32 v53, v84 offset:8192
    v_readlane_b32 s81, v124, 63
    ds_write_b32 v53, v85 offset:8320
    v_readlane_b32 s82, v126, 15
    ds_write_b32 v53, v86 offset:10240
    v_readlane_b32 s83, v126, 31
    ds_write_b32 v53, v87 offset:10368
    v_readlane_b32 s84, v126, 47
    ds_write2_b32 v52, v64, v65 offset0:0 offset1:32
    v_readlane_b32 s85, v126, 63
    ds_write2_b32 v52, v68, v69 offset0:64 offset1:96
    v_mov_b32 v120, s78
    ds_write2_b32 v52, v70, v71 offset0:128 offset1:160
    s_add_u32 m0, s32, 49152
    s_nop 0
    buffer_load_dwordx4 v4, s[12:15], s30 offen offset:1024 nt lds
    v_add_f32 v120, s79, v120
    ds_write2_b32 v52, v72, v73 offset0:192 offset1:224
    v_add_f32 v120, s80, v120
    ds_write_b32 v52, v74 offset:1024
    v_add_f32 v120, s81, v120
    ds_write_b32 v52, v75 offset:1152
    v_mov_b32 v121, s82
    ds_write_b32 v52, v88 offset:1280
    v_add_f32 v121, s83, v121
    ds_write_b32 v52, v89 offset:1408
    v_add_f32 v121, s84, v121
    v_add_f32 v121, s85, v121
    v_cvt_pk_bf16_f32 v120, v120, v121
    v_lshlrev_b32 v121, 16, v120
    s_add_u32 m0, s32, 49152
    s_nop 0
    buffer_load_dwordx4 v5, s[12:15], s30 offen offset:2048 nt lds
    v_and_b32 v122, 0xffff0000, v120
    v_mul_f32 v121, 0xbfb8aa3b, v121
    v_mul_f32 v122, 0xbfb8aa3b, v122
    v_exp_f32 v121, v121
    v_exp_f32 v122, v122
    v_add_f32 v121, 1.0, v121
    v_add_f32 v122, 1.0, v122
    v_rcp_f32 v121, v121
    v_rcp_f32 v122, v122
    s_nop 0
    v_cvt_pk_bf16_f32 v120, v121, v122
    v_lshlrev_b32 v122, 16, v120
    v_and_b32 v123, 0xffff0000, v120
    s_lshl_b32 s6, s71, 2
    s_add_u32 s6, s6, 23068672
    s_mov_b64 exec, 1
    buffer_store_dwordx2 v[122:123], off, s[20:23], s6 sc1
    s_mov_b64 exec, -1
    s_and_b32 s7, s3, 1
    v_mul_u32_u24 v26, 37, v17
    v_lshrrev_b32 v26, 8, v26
    v_mul_u32_u24 v27, 7, v26
    v_sub_u32 v27, v17, v27
    v_lshlrev_b32 v27, 7, v27
    s_lshr_b32 s6, s2, 3
    s_lshl_b32 s6, s6, 1
    s_add_u32 s6, s6, s7
    s_lshl_b32 s6, s6, 1
    s_and_b32 s70, s2, 7
    v_add_u32 v28, s6, v26
    v_mul_u32_u24 v28, s75, v28
    v_add_u32 v28, v28, v27
    s_mul_i32 s71, s70, 896
    v_add_u32 v28, s71, v28
    v_lshrrev_b32 v26, 1, v17
    v_and_b32 v27, 1, v17
    v_lshlrev_b32 v27, 7, v27
    s_lshl_b32 s71, s70, 7
    s_add_u32 s71, s71, s6
    v_add_u32 v29, s71, v26
    v_lshl_add_u32 v29, v29, 11, v27
    s_lshl_b32 s6, s4, 8
    s_lshl_b32 s70, s5, 3
    s_add_u32 s6, s6, s70
    s_lshl_b32 s70, s3, 1
    s_add_u32 s71, s6, s70
    v_add_u32 v30, s71, v26
    v_lshl_add_u32 v30, v30, 11, v27
    s_mov_b32 s94, 768
    s_mov_b32 s95, 2752512
    s_bfe_u32 s78, s2, 0x10004
    s_bfe_u32 s79, s2, 0x10003
    s_and_b32 s70, s2, 7
    s_lshl_b32 s6, s4, 4
    s_lshl_b32 s70, s70, 1
    s_add_u32 s6, s6, s70
    s_add_u32 s6, s6, s78
    s_lshl_b32 s6, s6, 2
    s_add_u32 s6, s6, s3
    s_mul_i32 s92, s6, 14336
    s_cmp_eq_u32 s78, s79
    s_cselect_b32 s92, s92, s77
    v_lshlrev_b32 v31, 7, v17
    s_and_b32 s7, s3, 1
    s_lshl_b32 s6, s4, 7
    s_lshl_b32 s70, s7, 6
    s_add_u32 s6, s6, s70
    v_add_u32 v9, s6, v18
    v_lshlrev_b32 v9, 11, v9
    v_lshl_add_u32 v9, v19, 4, v9
    s_lshl_b32 s6, s5, 6
    v_add_u32 v9, s6, v9
    s_lshl_b32 s6, s5, 5
    s_lshl_b32 s7, s4, 2
    s_add_u32 s6, s6, s7
    s_add_u32 s6, s6, s3
    s_lshl_b32 s6, s6, 8
    s_add_u32 s6, s6, 23076864
    v_lshlrev_b32 v26, 4, v17
    v_mov_b32 v24, -1
    v_mov_b32 v25, -1
    v_mov_b32 v22, -1
    v_mov_b32 v23, -1
    s_mov_b64 exec, 0xffff
    buffer_store_dwordx4 v[22:25], v26, s[20:23], s6 offen sc1
    s_mov_b64 exec, -1
    s_bfe_u32 s93, s2, 0x20005
    s_max_u32 s93, s93, 1
    s_add_u32 s93, s93, 1
    s_cmp_eq_u32 s3, 0
    s_cselect_b32 s93, s93, 99
    v_lshrrev_b32 v26, 2, v18
    v_lshl_add_u32 v26, v19, 2, v26
    v_mul_u32_u24 v26, 224, v26
    v_and_b32 v27, 3, v17
    v_lshl_add_u32 v12, v27, 3, v26
    v_add_u32 v12, 65536, v12
    v_and_b32 v26, 7, v17
    v_xor_b32 v26, v26, v19
    v_lshlrev_b32 v26, 4, v26
    v_lshl_add_u32 v26, v18, 7, v26
    v_add_u32 v13, 131072, v26
    v_xor_b32 v14, 64, v13
    v_add_u32 v7, s34, v26
    v_xor_b32 v8, 64, v7
    s_mov_b32 s33, 0
    s_waitcnt vmcnt(23)
    s_barrier
    ds_read_b128 a[128:131], v7 offset:0
    ds_read_b128 a[132:135], v7 offset:2048
    ds_read_b128 a[136:139], v7 offset:4096
    ds_read_b128 a[140:143], v7 offset:6144
    ds_read_b64_tr_b16 a[192:193], v12 offset:0
    ds_read_b64_tr_b16 a[194:195], v12 offset:4096
    ds_read_b64_tr_b16 a[196:197], v12 offset:8192
    ds_read_b64_tr_b16 a[198:199], v12 offset:12288
    ds_read_b64_tr_b16 a[200:201], v12 offset:32
    ds_read_b64_tr_b16 a[202:203], v12 offset:4128
    ds_read_b64_tr_b16 a[204:205], v12 offset:8224
    ds_read_b64_tr_b16 a[206:207], v12 offset:12320
    ds_read_b64_tr_b16 a[208:209], v12 offset:64
    ds_read_b64_tr_b16 a[210:211], v12 offset:4160
    ds_read_b128 a[144:147], v8 offset:0
    ds_read_b128 a[148:151], v8 offset:2048
    ds_read_b128 a[152:155], v8 offset:4096
    ds_read_b128 a[156:159], v8 offset:6144
    ds_read_b128 a[220:223], v13 offset:0
    ds_read_b128 a[224:227], v13 offset:4096
    ds_read_b128 a[228:231], v13 offset:2048
    ds_read_b128 a[232:235], v13 offset:6144
    s_waitcnt lgkmcnt(14)
    v_mfma_f32_16x16x32_bf16 v[160:163], a[192:195], a[128:131], 0
    ds_read_b64_tr_b16 a[212:213], v12 offset:8256
    v_mfma_f32_16x16x32_bf16 v[164:167], a[192:195], a[132:135], 0
    ds_read_b64_tr_b16 a[214:215], v12 offset:12352
    v_mfma_f32_16x16x32_bf16 v[168:171], a[192:195], a[136:139], 0
    ds_read_b128 a[236:239], v14 offset:0
    v_mfma_f32_16x16x32_bf16 v[172:175], a[192:195], a[140:143], 0
    s_waitcnt lgkmcnt(14)
    v_mfma_f32_16x16x32_bf16 v[176:179], a[196:199], a[128:131], 0
    s_add_u32 m0, s32, 49152
    ds_read_b64_tr_b16 a[216:217], v12 offset:96
    v_mfma_f32_16x16x32_bf16 v[180:183], a[196:199], a[132:135], 0
    ds_read_b64_tr_b16 a[218:219], v12 offset:4192
    v_mfma_f32_16x16x32_bf16 v[184:187], a[196:199], a[136:139], 0
    buffer_load_dwordx4 v6, s[12:15], s30 offen offset:3072 nt lds
    v_mfma_f32_16x16x32_bf16 v[188:191], a[196:199], a[140:143], 0
    s_add_u32 s30, s30, 229376
    s_waitcnt lgkmcnt(14)
    v_mfma_f32_16x16x32_bf16 v[192:195], a[200:203], a[128:131], 0
    ds_read_b64_tr_b16 a[192:193], v12 offset:8288
    v_mfma_f32_16x16x32_bf16 v[196:199], a[200:203], a[132:135], 0
    ds_read_b64_tr_b16 a[194:195], v12 offset:12384
    v_mfma_f32_16x16x32_bf16 v[200:203], a[200:203], a[136:139], 0
    ds_read_b128 a[240:243], v14 offset:4096
    v_mfma_f32_16x16x32_bf16 v[204:207], a[200:203], a[140:143], 0
    s_waitcnt lgkmcnt(14)
    v_mfma_f32_16x16x32_bf16 v[208:211], a[204:207], a[128:131], 0
    s_add_u32 m0, s34, 0
    v_mfma_f32_16x16x32_bf16 v[212:215], a[204:207], a[132:135], 0
    ds_read_b64_tr_b16 a[196:197], v12 offset:128
    v_mfma_f32_16x16x32_bf16 v[216:219], a[204:207], a[136:139], 0
    ds_read_b64_tr_b16 a[198:199], v12 offset:4224
    v_mfma_f32_16x16x32_bf16 v[220:223], a[204:207], a[140:143], 0
    buffer_load_dwordx4 v1, s[8:11], s28 offen offset:0  lds
    s_waitcnt lgkmcnt(14)
    v_mfma_f32_16x16x32_bf16 v[224:227], a[208:211], a[128:131], 0
    ds_read_b64_tr_b16 a[200:201], v12 offset:8320
    v_mfma_f32_16x16x32_bf16 v[228:231], a[208:211], a[132:135], 0
    ds_read_b64_tr_b16 a[202:203], v12 offset:12416
    v_mfma_f32_16x16x32_bf16 v[232:235], a[208:211], a[136:139], 0
    ds_read_b128 a[244:247], v14 offset:2048
    v_mfma_f32_16x16x32_bf16 v[236:239], a[208:211], a[140:143], 0
    s_waitcnt lgkmcnt(11)
    v_mfma_f32_16x16x32_bf16 v[240:243], a[212:215], a[128:131], 0
    s_add_u32 m0, s34, 0
    v_mfma_f32_16x16x32_bf16 v[244:247], a[212:215], a[132:135], 0
    ds_read_b64_tr_b16 a[204:205], v12 offset:160
    v_mfma_f32_16x16x32_bf16 v[248:251], a[212:215], a[136:139], 0
    ds_read_b64_tr_b16 a[206:207], v12 offset:4256
    v_mfma_f32_16x16x32_bf16 v[252:255], a[212:215], a[140:143], 0
    buffer_load_dwordx4 v2, s[8:11], s28 offen offset:1024  lds
    s_waitcnt lgkmcnt(10)
    v_mfma_f32_16x16x32_bf16 a[0:3], a[216:219], a[128:131], 0
    ds_read_b64_tr_b16 a[208:209], v12 offset:8352
    v_mfma_f32_16x16x32_bf16 a[4:7], a[216:219], a[132:135], 0
    ds_read_b64_tr_b16 a[210:211], v12 offset:12448
    v_mfma_f32_16x16x32_bf16 a[8:11], a[216:219], a[136:139], 0
    ds_read_b128 a[248:251], v14 offset:6144
    v_mfma_f32_16x16x32_bf16 a[12:15], a[216:219], a[140:143], 0
    s_waitcnt lgkmcnt(11)
    v_mfma_f32_16x16x32_bf16 a[16:19], a[192:195], a[128:131], 0
    s_add_u32 m0, s34, 0
    v_mfma_f32_16x16x32_bf16 a[20:23], a[192:195], a[132:135], 0
    ds_read_b64_tr_b16 a[212:213], v12 offset:192
    v_mfma_f32_16x16x32_bf16 a[24:27], a[192:195], a[136:139], 0
    ds_read_b64_tr_b16 a[214:215], v12 offset:4288
    v_mfma_f32_16x16x32_bf16 a[28:31], a[192:195], a[140:143], 0
    buffer_load_dwordx4 v1, s[8:11], s28 offen offset:2048  lds
    s_waitcnt lgkmcnt(10)
    v_mfma_f32_16x16x32_bf16 a[32:35], a[196:199], a[128:131], 0
    ds_read_b64_tr_b16 a[216:217], v12 offset:8384
    v_mfma_f32_16x16x32_bf16 a[36:39], a[196:199], a[132:135], 0
    v_mfma_f32_16x16x32_bf16 a[40:43], a[196:199], a[136:139], 0
    ds_read_b64_tr_b16 a[218:219], v12 offset:12480
    v_mfma_f32_16x16x32_bf16 a[44:47], a[196:199], a[140:143], 0
    s_waitcnt lgkmcnt(10)
    v_mfma_f32_16x16x32_bf16 a[48:51], a[200:203], a[128:131], 0
    s_add_u32 m0, s34, 0
    v_mfma_f32_16x16x32_bf16 a[52:55], a[200:203], a[132:135], 0
    v_mfma_f32_16x16x32_bf16 a[56:59], a[200:203], a[136:139], 0
    buffer_load_dwordx4 v2, s[8:11], s28 offen offset:3072  lds
    v_mfma_f32_16x16x32_bf16 a[60:63], a[200:203], a[140:143], 0
    s_waitcnt lgkmcnt(7)
    v_mfma_f32_16x16x32_bf16 a[64:67], a[204:207], a[128:131], 0
    v_mfma_f32_16x16x32_bf16 a[68:71], a[204:207], a[132:135], 0
    v_mfma_f32_16x16x32_bf16 a[72:75], a[204:207], a[136:139], 0
    v_mfma_f32_16x16x32_bf16 a[76:79], a[204:207], a[140:143], 0
    s_waitcnt lgkmcnt(5)
    v_mfma_f32_16x16x32_bf16 a[80:83], a[208:211], a[128:131], 0
    v_mfma_f32_16x16x32_bf16 a[84:87], a[208:211], a[132:135], 0
    v_mfma_f32_16x16x32_bf16 a[88:91], a[208:211], a[136:139], 0
    v_mfma_f32_16x16x32_bf16 a[92:95], a[208:211], a[140:143], 0
    s_waitcnt vmcnt(24)
    s_waitcnt lgkmcnt(0)
    s_barrier
    v_mfma_f32_16x16x32_bf16 a[96:99], a[212:215], a[128:131], 0
    ds_read_b64_tr_b16 a[192:193], v12 offset:16384
    v_mfma_f32_16x16x32_bf16 a[100:103], a[212:215], a[132:135], 0
    v_mfma_f32_16x16x32_bf16 a[104:107], a[212:215], a[136:139], 0
    ds_read_b64_tr_b16 a[194:195], v12 offset:20480
    v_mfma_f32_16x16x32_bf16 a[108:111], a[212:215], a[140:143], 0
    v_mfma_f32_16x16x32_bf16 a[112:115], a[216:219], a[128:131], 0
    s_add_u32 m0, s32, 0
    v_mfma_f32_16x16x32_bf16 a[116:119], a[216:219], a[132:135], 0
    ds_read_b64_tr_b16 a[196:197], v12 offset:24576
    v_mfma_f32_16x16x32_bf16 a[120:123], a[216:219], a[136:139], 0
    ds_read_b64_tr_b16 a[198:199], v12 offset:28672
    v_mfma_f32_16x16x32_bf16 a[124:127], a[216:219], a[140:143], 0
    buffer_load_dwordx4 v3, s[12:15], s30 offen offset:0 nt lds
    v_mfma_f32_16x16x32_bf16 v[96:99], a[220:223], a[128:131], 0
    s_add_u32 m0, s35, 0
    v_mfma_f32_16x16x32_bf16 v[100:103], a[220:223], a[132:135], 0
    ds_read_b64_tr_b16 a[200:201], v12 offset:16416
    v_mfma_f32_16x16x32_bf16 v[104:107], a[220:223], a[136:139], 0
    ds_read_b64_tr_b16 a[202:203], v12 offset:20512
    v_mfma_f32_16x16x32_bf16 v[108:111], a[220:223], a[140:143], 0
    buffer_load_dwordx4 v10, s[16:19], s31 offen offset:0 nt lds
    v_mfma_f32_16x16x32_bf16 v[112:115], a[224:227], a[128:131], 0
    s_add_u32 m0, s32, 0
    v_mfma_f32_16x16x32_bf16 v[116:119], a[224:227], a[132:135], 0
    ds_read_b64_tr_b16 a[204:205], v12 offset:24608
    v_mfma_f32_16x16x32_bf16 v[120:123], a[224:227], a[136:139], 0
    ds_read_b64_tr_b16 a[206:207], v12 offset:28704
    v_mfma_f32_16x16x32_bf16 v[124:127], a[224:227], a[140:143], 0
    buffer_load_dwordx4 v4, s[12:15], s30 offen offset:1024 nt lds
    v_mfma_f32_16x16x32_bf16 v[128:131], a[228:231], a[128:131], 0
    s_add_u32 m0, s35, 0
    ds_read_b64_tr_b16 a[208:209], v12 offset:16448
    v_mfma_f32_16x16x32_bf16 v[132:135], a[228:231], a[132:135], 0
    ds_read_b64_tr_b16 a[210:211], v12 offset:20544
    buffer_load_dwordx4 v11, s[16:19], s31 offen offset:1024 nt lds
    v_mfma_f32_16x16x32_bf16 v[136:139], a[228:231], a[136:139], 0
    s_add_u32 s31, s31, 128
    s_cmp_lt_u32 s31, 2048
    v_mfma_f32_16x16x32_bf16 v[140:143], a[228:231], a[140:143], 0
    s_cselect_b32 s31, s31, s77
    v_mfma_f32_16x16x32_bf16 v[144:147], a[232:235], a[128:131], 0
    s_add_u32 m0, s32, 0
    v_mfma_f32_16x16x32_bf16 v[148:151], a[232:235], a[132:135], 0
    v_mfma_f32_16x16x32_bf16 v[152:155], a[232:235], a[136:139], 0
    buffer_load_dwordx4 v5, s[12:15], s30 offen offset:2048 nt lds
    v_mfma_f32_16x16x32_bf16 v[156:159], a[232:235], a[140:143], 0
    s_waitcnt lgkmcnt(8)
    v_mfma_f32_16x16x32_bf16 v[160:163], a[192:195], a[144:147], v[160:163]
    ds_read_b64_tr_b16 a[212:213], v12 offset:24640
    v_mfma_f32_16x16x32_bf16 v[164:167], a[192:195], a[148:151], v[164:167]
    v_mfma_f32_16x16x32_bf16 v[168:171], a[192:195], a[152:155], v[168:171]
    ds_read_b64_tr_b16 a[214:215], v12 offset:28736
    v_mfma_f32_16x16x32_bf16 v[172:175], a[192:195], a[156:159], v[172:175]
    s_waitcnt lgkmcnt(8)
    v_mfma_f32_16x16x32_bf16 v[176:179], a[196:199], a[144:147], v[176:179]
    s_add_u32 m0, s32, 0
    ds_read_b64_tr_b16 a[216:217], v12 offset:16480
    v_mfma_f32_16x16x32_bf16 v[180:183], a[196:199], a[148:151], v[180:183]
    ds_read_b64_tr_b16 a[218:219], v12 offset:20576
    v_mfma_f32_16x16x32_bf16 v[184:187], a[196:199], a[152:155], v[184:187]
    buffer_load_dwordx4 v6, s[12:15], s30 offen offset:3072 nt lds
    v_mfma_f32_16x16x32_bf16 v[188:191], a[196:199], a[156:159], v[188:191]
    s_add_u32 s30, s30, 229376
    s_waitcnt lgkmcnt(8)
    v_mfma_f32_16x16x32_bf16 v[192:195], a[200:203], a[144:147], v[192:195]
    ds_read_b64_tr_b16 a[192:193], v12 offset:24672
    v_mfma_f32_16x16x32_bf16 v[196:199], a[200:203], a[148:151], v[196:199]
    v_mfma_f32_16x16x32_bf16 v[200:203], a[200:203], a[152:155], v[200:203]
    ds_read_b64_tr_b16 a[194:195], v12 offset:28768
    v_mfma_f32_16x16x32_bf16 v[204:207], a[200:203], a[156:159], v[204:207]
    s_waitcnt lgkmcnt(8)
    v_mfma_f32_16x16x32_bf16 v[208:211], a[204:207], a[144:147], v[208:211]
    s_add_u32 m0, s34, 4096
    v_mfma_f32_16x16x32_bf16 v[212:215], a[204:207], a[148:151], v[212:215]
    ds_read_b64_tr_b16 a[196:197], v12 offset:16512
    v_mfma_f32_16x16x32_bf16 v[216:219], a[204:207], a[152:155], v[216:219]
    ds_read_b64_tr_b16 a[198:199], v12 offset:20608
    v_mfma_f32_16x16x32_bf16 v[220:223], a[204:207], a[156:159], v[220:223]
    buffer_load_dwordx4 v1, s[8:11], s29 offen offset:0  lds
    s_waitcnt lgkmcnt(8)
    v_mfma_f32_16x16x32_bf16 v[224:227], a[208:211], a[144:147], v[224:227]
    ds_read_b64_tr_b16 a[200:201], v12 offset:24704
    v_mfma_f32_16x16x32_bf16 v[228:231], a[208:211], a[148:151], v[228:231]
    v_mfma_f32_16x16x32_bf16 v[232:235], a[208:211], a[152:155], v[232:235]
    ds_read_b64_tr_b16 a[202:203], v12 offset:28800
    v_mfma_f32_16x16x32_bf16 v[236:239], a[208:211], a[156:159], v[236:239]
    s_waitcnt lgkmcnt(8)
    v_mfma_f32_16x16x32_bf16 v[240:243], a[212:215], a[144:147], v[240:243]
    s_add_u32 m0, s34, 4096
    v_mfma_f32_16x16x32_bf16 v[244:247], a[212:215], a[148:151], v[244:247]
    ds_read_b64_tr_b16 a[204:205], v12 offset:16544
    v_mfma_f32_16x16x32_bf16 v[248:251], a[212:215], a[152:155], v[248:251]
    ds_read_b64_tr_b16 a[206:207], v12 offset:20640
    v_mfma_f32_16x16x32_bf16 v[252:255], a[212:215], a[156:159], v[252:255]
    buffer_load_dwordx4 v2, s[8:11], s29 offen offset:1024  lds
    s_waitcnt lgkmcnt(8)
    v_mfma_f32_16x16x32_bf16 a[0:3], a[216:219], a[144:147], a[0:3]
    ds_read_b64_tr_b16 a[208:209], v12 offset:24736
    v_mfma_f32_16x16x32_bf16 a[4:7], a[216:219], a[148:151], a[4:7]
    v_mfma_f32_16x16x32_bf16 a[8:11], a[216:219], a[152:155], a[8:11]
    ds_read_b64_tr_b16 a[210:211], v12 offset:28832
    v_mfma_f32_16x16x32_bf16 a[12:15], a[216:219], a[156:159], a[12:15]
    s_waitcnt lgkmcnt(8)
    v_mfma_f32_16x16x32_bf16 a[16:19], a[192:195], a[144:147], a[16:19]
    s_add_u32 m0, s34, 4096
    v_mfma_f32_16x16x32_bf16 a[20:23], a[192:195], a[148:151], a[20:23]
    ds_read_b64_tr_b16 a[212:213], v12 offset:16576
    v_mfma_f32_16x16x32_bf16 a[24:27], a[192:195], a[152:155], a[24:27]
    ds_read_b64_tr_b16 a[214:215], v12 offset:20672
    v_mfma_f32_16x16x32_bf16 a[28:31], a[192:195], a[156:159], a[28:31]
    buffer_load_dwordx4 v1, s[8:11], s29 offen offset:2048  lds
    s_waitcnt lgkmcnt(8)
    v_mfma_f32_16x16x32_bf16 a[32:35], a[196:199], a[144:147], a[32:35]
    ds_read_b64_tr_b16 a[216:217], v12 offset:24768
    v_mfma_f32_16x16x32_bf16 a[36:39], a[196:199], a[148:151], a[36:39]
    v_mfma_f32_16x16x32_bf16 a[40:43], a[196:199], a[152:155], a[40:43]
    ds_read_b64_tr_b16 a[218:219], v12 offset:28864
    v_mfma_f32_16x16x32_bf16 a[44:47], a[196:199], a[156:159], a[44:47]
    s_waitcnt lgkmcnt(8)
    v_mfma_f32_16x16x32_bf16 a[48:51], a[200:203], a[144:147], a[48:51]
    s_add_u32 m0, s34, 4096
    s_waitcnt vmcnt(25)
    ds_read_b128 a[160:163], v7 offset:8192
    v_mfma_f32_16x16x32_bf16 a[52:55], a[200:203], a[148:151], a[52:55]
    ds_read_b128 a[164:167], v7 offset:10240
    buffer_load_dwordx4 v2, s[8:11], s29 offen offset:3072  lds
    v_mfma_f32_16x16x32_bf16 a[56:59], a[200:203], a[152:155], a[56:59]
    s_add_u32 s28, s28, 128
    s_cmp_lt_u32 s28, 2048
    v_mfma_f32_16x16x32_bf16 a[60:63], a[200:203], a[156:159], a[60:63]
    s_cselect_b32 s28, s28, s77
    s_add_u32 s29, s28, 4096
    s_waitcnt lgkmcnt(8)
    v_mfma_f32_16x16x32_bf16 a[64:67], a[204:207], a[144:147], a[64:67]
    ds_read_b128 a[168:171], v7 offset:12288
    v_mfma_f32_16x16x32_bf16 a[68:71], a[204:207], a[148:151], a[68:71]
    v_mfma_f32_16x16x32_bf16 a[72:75], a[204:207], a[152:155], a[72:75]
    ds_read_b128 a[172:175], v7 offset:14336
    v_mfma_f32_16x16x32_bf16 a[76:79], a[204:207], a[156:159], a[76:79]
    s_waitcnt lgkmcnt(8)
    v_mfma_f32_16x16x32_bf16 a[80:83], a[208:211], a[144:147], a[80:83]
    v_mfma_f32_16x16x32_bf16 a[84:87], a[208:211], a[148:151], a[84:87]
    v_mfma_f32_16x16x32_bf16 a[88:91], a[208:211], a[152:155], a[88:91]
    v_mfma_f32_16x16x32_bf16 a[92:95], a[208:211], a[156:159], a[92:95]
    s_waitcnt vmcnt(20)
    s_waitcnt lgkmcnt(0)
    s_barrier
    v_mfma_f32_16x16x32_bf16 a[96:99], a[212:215], a[144:147], a[96:99]
    ds_read_b64_tr_b16 a[192:193], v12 offset:32768
    v_mfma_f32_16x16x32_bf16 a[100:103], a[212:215], a[148:151], a[100:103]
    ds_read_b64_tr_b16 a[194:195], v12 offset:36864
    v_mfma_f32_16x16x32_bf16 a[104:107], a[212:215], a[152:155], a[104:107]
    ds_read_b128 a[220:223], v13 offset:8192
    v_mfma_f32_16x16x32_bf16 a[108:111], a[212:215], a[156:159], a[108:111]
    ds_read_b128 a[224:227], v13 offset:12288
    v_mfma_f32_16x16x32_bf16 a[112:115], a[216:219], a[144:147], a[112:115]
    s_add_u32 m0, s32, 16384
    ds_read_b64_tr_b16 a[196:197], v12 offset:40960
    v_mfma_f32_16x16x32_bf16 a[116:119], a[216:219], a[148:151], a[116:119]
    ds_read_b64_tr_b16 a[198:199], v12 offset:45056
    v_mfma_f32_16x16x32_bf16 a[120:123], a[216:219], a[152:155], a[120:123]
    ds_read_b128 a[228:231], v13 offset:10240
    ds_read_b128 a[232:235], v13 offset:14336
    v_mfma_f32_16x16x32_bf16 a[124:127], a[216:219], a[156:159], a[124:127]
    buffer_load_dwordx4 v3, s[12:15], s30 offen offset:0 nt lds
    v_mfma_f32_16x16x32_bf16 v[96:99], a[236:239], a[144:147], v[96:99]
    ds_read_b64_tr_b16 a[200:201], v12 offset:32800
    v_mfma_f32_16x16x32_bf16 v[100:103], a[236:239], a[148:151], v[100:103]
    ds_read_b64_tr_b16 a[202:203], v12 offset:36896
    v_mfma_f32_16x16x32_bf16 v[104:107], a[236:239], a[152:155], v[104:107]
    ds_read_b128 a[176:179], v8 offset:8192
    v_mfma_f32_16x16x32_bf16 v[108:111], a[236:239], a[156:159], v[108:111]
    v_mfma_f32_16x16x32_bf16 v[112:115], a[240:243], a[144:147], v[112:115]
    s_add_u32 m0, s32, 16384
    ds_read_b64_tr_b16 a[204:205], v12 offset:40992
    v_mfma_f32_16x16x32_bf16 v[116:119], a[240:243], a[148:151], v[116:119]
    ds_read_b64_tr_b16 a[206:207], v12 offset:45088
    v_mfma_f32_16x16x32_bf16 v[120:123], a[240:243], a[152:155], v[120:123]
    ds_read_b128 a[180:183], v8 offset:10240
    v_mfma_f32_16x16x32_bf16 v[124:127], a[240:243], a[156:159], v[124:127]
    buffer_load_dwordx4 v4, s[12:15], s30 offen offset:1024 nt lds
    v_mfma_f32_16x16x32_bf16 v[128:131], a[244:247], a[144:147], v[128:131]
    ds_read_b64_tr_b16 a[208:209], v12 offset:32832
    v_mfma_f32_16x16x32_bf16 v[132:135], a[244:247], a[148:151], v[132:135]
    ds_read_b64_tr_b16 a[210:211], v12 offset:36928
    v_mfma_f32_16x16x32_bf16 v[136:139], a[244:247], a[152:155], v[136:139]
    ds_read_b128 a[184:187], v8 offset:12288
    v_mfma_f32_16x16x32_bf16 v[140:143], a[244:247], a[156:159], v[140:143]
    v_mfma_f32_16x16x32_bf16 v[144:147], a[248:251], a[144:147], v[144:147]
    s_add_u32 m0, s32, 16384
    v_mfma_f32_16x16x32_bf16 v[148:151], a[248:251], a[148:151], v[148:151]
    ds_read_b128 a[188:191], v8 offset:14336
    v_mfma_f32_16x16x32_bf16 v[152:155], a[248:251], a[152:155], v[152:155]
    buffer_load_dwordx4 v5, s[12:15], s30 offen offset:2048 nt lds
    v_mfma_f32_16x16x32_bf16 v[156:159], a[248:251], a[156:159], v[156:159]
    s_waitcnt lgkmcnt(14)
    v_mfma_f32_16x16x32_bf16 v[160:163], a[192:195], a[160:163], v[160:163]
    ds_read_b64_tr_b16 a[212:213], v12 offset:41024
    v_mfma_f32_16x16x32_bf16 v[164:167], a[192:195], a[164:167], v[164:167]
    ds_read_b64_tr_b16 a[214:215], v12 offset:45120
    v_mfma_f32_16x16x32_bf16 v[168:171], a[192:195], a[168:171], v[168:171]
    ds_read_b128 a[236:239], v14 offset:8192
    v_mfma_f32_16x16x32_bf16 v[172:175], a[192:195], a[172:175], v[172:175]
    s_waitcnt lgkmcnt(14)
    v_mfma_f32_16x16x32_bf16 v[176:179], a[196:199], a[160:163], v[176:179]
    s_add_u32 m0, s32, 16384
    ds_read_b64_tr_b16 a[216:217], v12 offset:32864
    v_mfma_f32_16x16x32_bf16 v[180:183], a[196:199], a[164:167], v[180:183]
    ds_read_b64_tr_b16 a[218:219], v12 offset:36960
    v_mfma_f32_16x16x32_bf16 v[184:187], a[196:199], a[168:171], v[184:187]
    buffer_load_dwordx4 v6, s[12:15], s30 offen offset:3072 nt lds
    v_mfma_f32_16x16x32_bf16 v[188:191], a[196:199], a[172:175], v[188:191]
    s_add_u32 s30, s30, 229376
    s_waitcnt lgkmcnt(13)
    v_mfma_f32_16x16x32_bf16 v[192:195], a[200:203], a[160:163], v[192:195]
    ds_read_b64_tr_b16 a[192:193], v12 offset:41056
    v_mfma_f32_16x16x32_bf16 v[196:199], a[200:203], a[164:167], v[196:199]
    ds_read_b64_tr_b16 a[194:195], v12 offset:45152
    v_mfma_f32_16x16x32_bf16 v[200:203], a[200:203], a[168:171], v[200:203]
    ds_read_b128 a[240:243], v14 offset:12288
    v_mfma_f32_16x16x32_bf16 v[204:207], a[200:203], a[172:175], v[204:207]
    s_waitcnt lgkmcnt(13)
    v_mfma_f32_16x16x32_bf16 v[208:211], a[204:207], a[160:163], v[208:211]
    s_add_u32 m0, s34, 8192
    v_mfma_f32_16x16x32_bf16 v[212:215], a[204:207], a[164:167], v[212:215]
    ds_read_b64_tr_b16 a[196:197], v12 offset:32896
    v_mfma_f32_16x16x32_bf16 v[216:219], a[204:207], a[168:171], v[216:219]
    ds_read_b64_tr_b16 a[198:199], v12 offset:36992
    v_mfma_f32_16x16x32_bf16 v[220:223], a[204:207], a[172:175], v[220:223]
    buffer_load_dwordx4 v1, s[8:11], s28 offen offset:0  lds
    s_waitcnt lgkmcnt(12)
    v_mfma_f32_16x16x32_bf16 v[224:227], a[208:211], a[160:163], v[224:227]
    ds_read_b64_tr_b16 a[200:201], v12 offset:41088
    v_mfma_f32_16x16x32_bf16 v[228:231], a[208:211], a[164:167], v[228:231]
    ds_read_b64_tr_b16 a[202:203], v12 offset:45184
    v_mfma_f32_16x16x32_bf16 v[232:235], a[208:211], a[168:171], v[232:235]
    ds_read_b128 a[244:247], v14 offset:10240
    v_mfma_f32_16x16x32_bf16 v[236:239], a[208:211], a[172:175], v[236:239]
    s_waitcnt lgkmcnt(11)
    v_mfma_f32_16x16x32_bf16 v[240:243], a[212:215], a[160:163], v[240:243]
    s_add_u32 m0, s34, 8192
    v_mfma_f32_16x16x32_bf16 v[244:247], a[212:215], a[164:167], v[244:247]
    ds_read_b64_tr_b16 a[204:205], v12 offset:32928
    v_mfma_f32_16x16x32_bf16 v[248:251], a[212:215], a[168:171], v[248:251]
    ds_read_b64_tr_b16 a[206:207], v12 offset:37024
    v_mfma_f32_16x16x32_bf16 v[252:255], a[212:215], a[172:175], v[252:255]
    buffer_load_dwordx4 v2, s[8:11], s28 offen offset:1024  lds
    s_waitcnt lgkmcnt(10)
    v_mfma_f32_16x16x32_bf16 a[0:3], a[216:219], a[160:163], a[0:3]
    ds_read_b64_tr_b16 a[208:209], v12 offset:41120
    v_mfma_f32_16x16x32_bf16 a[4:7], a[216:219], a[164:167], a[4:7]
    ds_read_b64_tr_b16 a[210:211], v12 offset:45216
    v_mfma_f32_16x16x32_bf16 a[8:11], a[216:219], a[168:171], a[8:11]
    ds_read_b128 a[248:251], v14 offset:14336
    v_mfma_f32_16x16x32_bf16 a[12:15], a[216:219], a[172:175], a[12:15]
    s_waitcnt lgkmcnt(11)
    v_mfma_f32_16x16x32_bf16 a[16:19], a[192:195], a[160:163], a[16:19]
    s_add_u32 m0, s34, 8192
    v_mfma_f32_16x16x32_bf16 a[20:23], a[192:195], a[164:167], a[20:23]
    ds_read_b64_tr_b16 a[212:213], v12 offset:32960
    v_mfma_f32_16x16x32_bf16 a[24:27], a[192:195], a[168:171], a[24:27]
    ds_read_b64_tr_b16 a[214:215], v12 offset:37056
    v_mfma_f32_16x16x32_bf16 a[28:31], a[192:195], a[172:175], a[28:31]
    buffer_load_dwordx4 v1, s[8:11], s28 offen offset:2048  lds
    s_waitcnt lgkmcnt(10)
    v_mfma_f32_16x16x32_bf16 a[32:35], a[196:199], a[160:163], a[32:35]
    ds_read_b64_tr_b16 a[216:217], v12 offset:41152
    v_mfma_f32_16x16x32_bf16 a[36:39], a[196:199], a[164:167], a[36:39]
    v_mfma_f32_16x16x32_bf16 a[40:43], a[196:199], a[168:171], a[40:43]
    ds_read_b64_tr_b16 a[218:219], v12 offset:45248
    v_mfma_f32_16x16x32_bf16 a[44:47], a[196:199], a[172:175], a[44:47]
    s_waitcnt lgkmcnt(10)
    v_mfma_f32_16x16x32_bf16 a[48:51], a[200:203], a[160:163], a[48:51]
    s_add_u32 m0, s34, 8192
    v_mfma_f32_16x16x32_bf16 a[52:55], a[200:203], a[164:167], a[52:55]
    v_mfma_f32_16x16x32_bf16 a[56:59], a[200:203], a[168:171], a[56:59]
    buffer_load_dwordx4 v2, s[8:11], s28 offen offset:3072  lds
    v_mfma_f32_16x16x32_bf16 a[60:63], a[200:203], a[172:175], a[60:63]
    s_waitcnt lgkmcnt(7)
    v_mfma_f32_16x16x32_bf16 a[64:67], a[204:207], a[160:163], a[64:67]
    v_mfma_f32_16x16x32_bf16 a[68:71], a[204:207], a[164:167], a[68:71]
    v_mfma_f32_16x16x32_bf16 a[72:75], a[204:207], a[168:171], a[72:75]
    v_mfma_f32_16x16x32_bf16 a[76:79], a[204:207], a[172:175], a[76:79]
    s_waitcnt lgkmcnt(5)
    v_mfma_f32_16x16x32_bf16 a[80:83], a[208:211], a[160:163], a[80:83]
    v_mfma_f32_16x16x32_bf16 a[84:87], a[208:211], a[164:167], a[84:87]
    v_mfma_f32_16x16x32_bf16 a[88:91], a[208:211], a[168:171], a[88:91]
    v_mfma_f32_16x16x32_bf16 a[92:95], a[208:211], a[172:175], a[92:95]
    s_waitcnt vmcnt(22)
    s_waitcnt lgkmcnt(0)
    s_barrier
    v_mfma_f32_16x16x32_bf16 a[96:99], a[212:215], a[160:163], a[96:99]
    ds_read_b64_tr_b16 a[192:193], v12 offset:49152
    v_mfma_f32_16x16x32_bf16 a[100:103], a[212:215], a[164:167], a[100:103]
    v_mfma_f32_16x16x32_bf16 a[104:107], a[212:215], a[168:171], a[104:107]
    ds_read_b64_tr_b16 a[194:195], v12 offset:53248
    v_mfma_f32_16x16x32_bf16 a[108:111], a[212:215], a[172:175], a[108:111]
    v_mfma_f32_16x16x32_bf16 a[112:115], a[216:219], a[160:163], a[112:115]
    s_add_u32 m0, s32, 32768
    v_mfma_f32_16x16x32_bf16 a[116:119], a[216:219], a[164:167], a[116:119]
    ds_read_b64_tr_b16 a[196:197], v12 offset:57344
    v_mfma_f32_16x16x32_bf16 a[120:123], a[216:219], a[168:171], a[120:123]
    ds_read_b64_tr_b16 a[198:199], v12 offset:61440
    v_mfma_f32_16x16x32_bf16 a[124:127], a[216:219], a[172:175], a[124:127]
    buffer_load_dwordx4 v3, s[12:15], s30 offen offset:0 nt lds
    v_mfma_f32_16x16x32_bf16 v[96:99], a[220:223], a[160:163], v[96:99]
    s_add_u32 m0, s35, 8192
    v_mfma_f32_16x16x32_bf16 v[100:103], a[220:223], a[164:167], v[100:103]
    ds_read_b64_tr_b16 a[200:201], v12 offset:49184
    v_mfma_f32_16x16x32_bf16 v[104:107], a[220:223], a[168:171], v[104:107]
    ds_read_b64_tr_b16 a[202:203], v12 offset:53280
    v_mfma_f32_16x16x32_bf16 v[108:111], a[220:223], a[172:175], v[108:111]
    buffer_load_dwordx4 v10, s[16:19], s31 offen offset:0 nt lds
    v_mfma_f32_16x16x32_bf16 v[112:115], a[224:227], a[160:163], v[112:115]
    s_add_u32 m0, s32, 32768
    v_mfma_f32_16x16x32_bf16 v[116:119], a[224:227], a[164:167], v[116:119]
    ds_read_b64_tr_b16 a[204:205], v12 offset:57376
    v_mfma_f32_16x16x32_bf16 v[120:123], a[224:227], a[168:171], v[120:123]
    ds_read_b64_tr_b16 a[206:207], v12 offset:61472
    v_mfma_f32_16x16x32_bf16 v[124:127], a[224:227], a[172:175], v[124:127]
    buffer_load_dwordx4 v4, s[12:15], s30 offen offset:1024 nt lds
    v_mfma_f32_16x16x32_bf16 v[128:131], a[228:231], a[160:163], v[128:131]
    s_add_u32 m0, s35, 8192
    ds_read_b64_tr_b16 a[208:209], v12 offset:49216
    v_mfma_f32_16x16x32_bf16 v[132:135], a[228:231], a[164:167], v[132:135]
    ds_read_b64_tr_b16 a[210:211], v12 offset:53312
    buffer_load_dwordx4 v11, s[16:19], s31 offen offset:1024 nt lds
    v_mfma_f32_16x16x32_bf16 v[136:139], a[228:231], a[168:171], v[136:139]
    s_add_u32 s31, s31, 128
    s_cmp_lt_u32 s31, 2048
    v_mfma_f32_16x16x32_bf16 v[140:143], a[228:231], a[172:175], v[140:143]
    s_cselect_b32 s31, s31, s77
    v_mfma_f32_16x16x32_bf16 v[144:147], a[232:235], a[160:163], v[144:147]
    s_add_u32 m0, s32, 32768
    v_mfma_f32_16x16x32_bf16 v[148:151], a[232:235], a[164:167], v[148:151]
    v_mfma_f32_16x16x32_bf16 v[152:155], a[232:235], a[168:171], v[152:155]
    buffer_load_dwordx4 v5, s[12:15], s30 offen offset:2048 nt lds
    v_mfma_f32_16x16x32_bf16 v[156:159], a[232:235], a[172:175], v[156:159]
    s_waitcnt lgkmcnt(8)
    v_mfma_f32_16x16x32_bf16 v[160:163], a[192:195], a[176:179], v[160:163]
    ds_read_b64_tr_b16 a[212:213], v12 offset:57408
    v_mfma_f32_16x16x32_bf16 v[164:167], a[192:195], a[180:183], v[164:167]
    v_mfma_f32_16x16x32_bf16 v[168:171], a[192:195], a[184:187], v[168:171]
    ds_read_b64_tr_b16 a[214:215], v12 offset:61504
    v_mfma_f32_16x16x32_bf16 v[172:175], a[192:195], a[188:191], v[172:175]
    s_waitcnt lgkmcnt(8)
    v_mfma_f32_16x16x32_bf16 v[176:179], a[196:199], a[176:179], v[176:179]
    s_add_u32 m0, s32, 32768
    ds_read_b64_tr_b16 a[216:217], v12 offset:49248
    v_mfma_f32_16x16x32_bf16 v[180:183], a[196:199], a[180:183], v[180:183]
    ds_read_b64_tr_b16 a[218:219], v12 offset:53344
    v_mfma_f32_16x16x32_bf16 v[184:187], a[196:199], a[184:187], v[184:187]
    buffer_load_dwordx4 v6, s[12:15], s30 offen offset:3072 nt lds
    v_mfma_f32_16x16x32_bf16 v[188:191], a[196:199], a[188:191], v[188:191]
    s_add_u32 s30, s30, 229376
    s_waitcnt lgkmcnt(8)
    v_mfma_f32_16x16x32_bf16 v[192:195], a[200:203], a[176:179], v[192:195]
    ds_read_b64_tr_b16 a[192:193], v12 offset:57440
    v_mfma_f32_16x16x32_bf16 v[196:199], a[200:203], a[180:183], v[196:199]
    v_mfma_f32_16x16x32_bf16 v[200:203], a[200:203], a[184:187], v[200:203]
    ds_read_b64_tr_b16 a[194:195], v12 offset:61536
    v_mfma_f32_16x16x32_bf16 v[204:207], a[200:203], a[188:191], v[204:207]
    s_waitcnt lgkmcnt(8)
    v_mfma_f32_16x16x32_bf16 v[208:211], a[204:207], a[176:179], v[208:211]
    s_add_u32 m0, s34, 12288
    v_mfma_f32_16x16x32_bf16 v[212:215], a[204:207], a[180:183], v[212:215]
    ds_read_b64_tr_b16 a[196:197], v12 offset:49280
    v_mfma_f32_16x16x32_bf16 v[216:219], a[204:207], a[184:187], v[216:219]
    ds_read_b64_tr_b16 a[198:199], v12 offset:53376
    v_mfma_f32_16x16x32_bf16 v[220:223], a[204:207], a[188:191], v[220:223]
    buffer_load_dwordx4 v1, s[8:11], s29 offen offset:0  lds
    s_waitcnt lgkmcnt(8)
    v_mfma_f32_16x16x32_bf16 v[224:227], a[208:211], a[176:179], v[224:227]
    ds_read_b64_tr_b16 a[200:201], v12 offset:57472
    v_mfma_f32_16x16x32_bf16 v[228:231], a[208:211], a[180:183], v[228:231]
    v_mfma_f32_16x16x32_bf16 v[232:235], a[208:211], a[184:187], v[232:235]
    ds_read_b64_tr_b16 a[202:203], v12 offset:61568
    v_mfma_f32_16x16x32_bf16 v[236:239], a[208:211], a[188:191], v[236:239]
    s_waitcnt lgkmcnt(8)
    v_mfma_f32_16x16x32_bf16 v[240:243], a[212:215], a[176:179], v[240:243]
    s_add_u32 m0, s34, 12288
    v_mfma_f32_16x16x32_bf16 v[244:247], a[212:215], a[180:183], v[244:247]
    ds_read_b64_tr_b16 a[204:205], v12 offset:49312
    v_mfma_f32_16x16x32_bf16 v[248:251], a[212:215], a[184:187], v[248:251]
    ds_read_b64_tr_b16 a[206:207], v12 offset:53408
    v_mfma_f32_16x16x32_bf16 v[252:255], a[212:215], a[188:191], v[252:255]
    buffer_load_dwordx4 v2, s[8:11], s29 offen offset:1024  lds
    s_waitcnt lgkmcnt(8)
    v_mfma_f32_16x16x32_bf16 a[0:3], a[216:219], a[176:179], a[0:3]
    ds_read_b64_tr_b16 a[208:209], v12 offset:57504
    v_mfma_f32_16x16x32_bf16 a[4:7], a[216:219], a[180:183], a[4:7]
    v_mfma_f32_16x16x32_bf16 a[8:11], a[216:219], a[184:187], a[8:11]
    ds_read_b64_tr_b16 a[210:211], v12 offset:61600
    v_mfma_f32_16x16x32_bf16 a[12:15], a[216:219], a[188:191], a[12:15]
    s_waitcnt lgkmcnt(8)
    v_mfma_f32_16x16x32_bf16 a[16:19], a[192:195], a[176:179], a[16:19]
    s_add_u32 m0, s34, 12288
    v_mfma_f32_16x16x32_bf16 a[20:23], a[192:195], a[180:183], a[20:23]
    ds_read_b64_tr_b16 a[212:213], v12 offset:49344
    v_mfma_f32_16x16x32_bf16 a[24:27], a[192:195], a[184:187], a[24:27]
    ds_read_b64_tr_b16 a[214:215], v12 offset:53440
    v_mfma_f32_16x16x32_bf16 a[28:31], a[192:195], a[188:191], a[28:31]
    buffer_load_dwordx4 v1, s[8:11], s29 offen offset:2048  lds
    s_waitcnt lgkmcnt(8)
    v_mfma_f32_16x16x32_bf16 a[32:35], a[196:199], a[176:179], a[32:35]
    ds_read_b64_tr_b16 a[216:217], v12 offset:57536
    v_mfma_f32_16x16x32_bf16 a[36:39], a[196:199], a[180:183], a[36:39]
    v_mfma_f32_16x16x32_bf16 a[40:43], a[196:199], a[184:187], a[40:43]
    ds_read_b64_tr_b16 a[218:219], v12 offset:61632
    v_mfma_f32_16x16x32_bf16 a[44:47], a[196:199], a[188:191], a[44:47]
    s_waitcnt lgkmcnt(8)
    v_mfma_f32_16x16x32_bf16 a[48:51], a[200:203], a[176:179], a[48:51]
    s_add_u32 m0, s34, 12288
    s_waitcnt vmcnt(17)
    ds_read_b128 a[128:131], v7 offset:0
    v_mfma_f32_16x16x32_bf16 a[52:55], a[200:203], a[180:183], a[52:55]
    ds_read_b128 a[132:135], v7 offset:2048
    buffer_load_dwordx4 v2, s[8:11], s29 offen offset:3072  lds
    v_mfma_f32_16x16x32_bf16 a[56:59], a[200:203], a[184:187], a[56:59]
    s_add_u32 s28, s28, 128
    s_cmp_lt_u32 s28, 2048
    v_mfma_f32_16x16x32_bf16 a[60:63], a[200:203], a[188:191], a[60:63]
    s_cselect_b32 s28, s28, s77
    s_add_u32 s29, s28, 4096
    s_waitcnt lgkmcnt(8)
    v_mfma_f32_16x16x32_bf16 a[64:67], a[204:207], a[176:179], a[64:67]
    ds_read_b128 a[136:139], v7 offset:4096
    v_mfma_f32_16x16x32_bf16 a[68:71], a[204:207], a[180:183], a[68:71]
    v_mfma_f32_16x16x32_bf16 a[72:75], a[204:207], a[184:187], a[72:75]
    ds_read_b128 a[140:143], v7 offset:6144
    v_mfma_f32_16x16x32_bf16 a[76:79], a[204:207], a[188:191], a[76:79]
    s_waitcnt lgkmcnt(8)
    v_mfma_f32_16x16x32_bf16 a[80:83], a[208:211], a[176:179], a[80:83]
    v_mfma_f32_16x16x32_bf16 a[84:87], a[208:211], a[180:183], a[84:87]
    v_mfma_f32_16x16x32_bf16 a[88:91], a[208:211], a[184:187], a[88:91]
    v_mfma_f32_16x16x32_bf16 a[92:95], a[208:211], a[188:191], a[92:95]
    s_waitcnt vmcnt(22)
    s_waitcnt lgkmcnt(0)
    s_barrier
    v_mfma_f32_16x16x32_bf16 a[96:99], a[212:215], a[176:179], a[96:99]
    ds_read_b64_tr_b16 a[192:193], v12 offset:0
    v_mfma_f32_16x16x32_bf16 a[100:103], a[212:215], a[180:183], a[100:103]
    ds_read_b64_tr_b16 a[194:195], v12 offset:4096
    v_mfma_f32_16x16x32_bf16 a[104:107], a[212:215], a[184:187], a[104:107]
    ds_read_b128 a[220:223], v13 offset:0
    v_mfma_f32_16x16x32_bf16 a[108:111], a[212:215], a[188:191], a[108:111]
    ds_read_b128 a[224:227], v13 offset:4096
    v_mfma_f32_16x16x32_bf16 a[112:115], a[216:219], a[176:179], a[112:115]
    s_add_u32 m0, s32, 49152
    ds_read_b64_tr_b16 a[196:197], v12 offset:8192
    v_mfma_f32_16x16x32_bf16 a[116:119], a[216:219], a[180:183], a[116:119]
    ds_read_b64_tr_b16 a[198:199], v12 offset:12288
    v_mfma_f32_16x16x32_bf16 a[120:123], a[216:219], a[184:187], a[120:123]
    ds_read_b128 a[228:231], v13 offset:2048
    ds_read_b128 a[232:235], v13 offset:6144
    v_mfma_f32_16x16x32_bf16 a[124:127], a[216:219], a[188:191], a[124:127]
    buffer_load_dwordx4 v3, s[12:15], s30 offen offset:0 nt lds
    v_mfma_f32_16x16x32_bf16 v[96:99], a[236:239], a[176:179], v[96:99]
    ds_read_b64_tr_b16 a[200:201], v12 offset:32
    v_mfma_f32_16x16x32_bf16 v[100:103], a[236:239], a[180:183], v[100:103]
    ds_read_b64_tr_b16 a[202:203], v12 offset:4128
    v_mfma_f32_16x16x32_bf16 v[104:107], a[236:239], a[184:187], v[104:107]
    ds_read_b128 a[144:147], v8 offset:0
    v_mfma_f32_16x16x32_bf16 v[108:111], a[236:239], a[188:191], v[108:111]
    v_mfma_f32_16x16x32_bf16 v[112:115], a[240:243], a[176:179], v[112:115]
    s_add_u32 m0, s32, 49152
    ds_read_b64_tr_b16 a[204:205], v12 offset:8224
    v_mfma_f32_16x16x32_bf16 v[116:119], a[240:243], a[180:183], v[116:119]
    ds_read_b64_tr_b16 a[206:207], v12 offset:12320
    v_mfma_f32_16x16x32_bf16 v[120:123], a[240:243], a[184:187], v[120:123]
    ds_read_b128 a[148:151], v8 offset:2048
    v_mfma_f32_16x16x32_bf16 v[124:127], a[240:243], a[188:191], v[124:127]
    buffer_load_dwordx4 v4, s[12:15], s30 offen offset:1024 nt lds
    v_mfma_f32_16x16x32_bf16 v[128:131], a[244:247], a[176:179], v[128:131]
    ds_read_b64_tr_b16 a[208:209], v12 offset:64
    v_mfma_f32_16x16x32_bf16 v[132:135], a[244:247], a[180:183], v[132:135]
    ds_read_b64_tr_b16 a[210:211], v12 offset:4160
    v_mfma_f32_16x16x32_bf16 v[136:139], a[244:247], a[184:187], v[136:139]
    ds_read_b128 a[152:155], v8 offset:4096
    v_mfma_f32_16x16x32_bf16 v[140:143], a[244:247], a[188:191], v[140:143]
    v_mfma_f32_16x16x32_bf16 v[144:147], a[248:251], a[176:179], v[144:147]
    s_add_u32 m0, s32, 49152
    v_mfma_f32_16x16x32_bf16 v[148:151], a[248:251], a[180:183], v[148:151]
    ds_read_b128 a[156:159], v8 offset:6144
    v_mfma_f32_16x16x32_bf16 v[152:155], a[248:251], a[184:187], v[152:155]
    buffer_load_dwordx4 v5, s[12:15], s30 offen offset:2048 nt lds
    v_mfma_f32_16x16x32_bf16 v[156:159], a[248:251], a[188:191], v[156:159]
.p2align 6
K1_loop:
    s_cmp_eq_u32 s33, s93
    s_cbranch_scc1 K1_t1
K1_tback:
    s_cmp_lg_u32 s33, 1
    s_cbranch_scc1 K1_c0
    global_load_dwordx4 v[32:35], v9, s[86:87] nt
    v_add_u32 v9, 0x8000, v9
K1_c0:
    s_cmp_lg_u32 s33, 2
    s_cbranch_scc1 K1_c1
    global_load_dwordx4 v[36:39], v9, s[86:87] nt
    v_add_u32 v9, 0x8000, v9
K1_c1:
    s_cmp_lg_u32 s33, 3
    s_cbranch_scc1 K1_c2
    global_load_dwordx4 v[40:43], v9, s[86:87] nt
    v_add_u32 v9, 0x8000, v9
K1_c2:
    s_cmp_lg_u32 s33, 4
    s_cbranch_scc1 K1_c3
    global_load_dwordx4 v[44:47], v9, s[86:87] nt
    v_add_u32 v9, 0x8000, v9
    s_getpc_b64 s[84:85]
CT2:
    s_add_u32 s84, s84, CP_b-CT2
    s_addc_u32 s85, s85, 0
    v_lshlrev_b32 v26, 7, v0
    v_min_u32 v26, CP_c-CP_b-4, v26
    global_load_dword a255, v26, s[84:85]
K1_c3:
    s_waitcnt lgkmcnt(14)
    v_mfma_f32_16x16x32_bf16 v[160:163], a[192:195], a[128:131], v[160:163]
    ds_read_b64_tr_b16 a[212:213], v12 offset:8256
    v_mfma_f32_16x16x32_bf16 v[164:167], a[192:195], a[132:135], v[164:167]
    ds_read_b64_tr_b16 a[214:215], v12 offset:12352
    v_mfma_f32_16x16x32_bf16 v[168:171], a[192:195], a[136:139], v[168:171]
    ds_read_b128 a[236:239], v14 offset:0
    v_mfma_f32_16x16x32_bf16 v[172:175], a[192:195], a[140:143], v[172:175]
    s_waitcnt lgkmcnt(14)
    v_mfma_f32_16x16x32_bf16 v[176:179], a[196:199], a[128:131], v[176:179]
    s_add_u32 m0, s32, 49152
    ds_read_b64_tr_b16 a[216:217], v12 offset:96
    v_mfma_f32_16x16x32_bf16 v[180:183], a[196:199], a[132:135], v[180:183]
    ds_read_b64_tr_b16 a[218:219], v12 offset:4192
    v_mfma_f32_16x16x32_bf16 v[184:187], a[196:199], a[136:139], v[184:187]
    buffer_load_dwordx4 v6, s[12:15], s30 offen offset:3072 nt lds
    v_mfma_f32_16x16x32_bf16 v[188:191], a[196:199], a[140:143], v[188:191]
    s_add_u32 s30, s30, 229376
    s_waitcnt lgkmcnt(13)
    v_mfma_f32_16x16x32_bf16 v[192:195], a[200:203], a[128:131], v[192:195]
    ds_read_b64_tr_b16 a[192:193], v12 offset:8288
    v_mfma_f32_16x16x32_bf16 v[196:199], a[200:203], a[132:135], v[196:199]
    ds_read_b64_tr_b16 a[194:195], v12 offset:12384
    v_mfma_f32_16x16x32_bf16 v[200:203], a[200:203], a[136:139], v[200:203]
    ds_read_b128 a[240:243], v14 offset:4096
    v_mfma_f32_16x16x32_bf16 v[204:207], a[200:203], a[140:143], v[204:207]
    s_waitcnt lgkmcnt(13)
    v_mfma_f32_16x16x32_bf16 v[208:211], a[204:207], a[128:131], v[208:211]
    s_add_u32 m0, s34, 0
    v_mfma_f32_16x16x32_bf16 v[212:215], a[204:207], a[132:135], v[212:215]
    ds_read_b64_tr_b16 a[196:197], v12 offset:128
    v_mfma_f32_16x16x32_bf16 v[216:219], a[204:207], a[136:139], v[216:219]
    ds_read_b64_tr_b16 a[198:199], v12 offset:4224
    v_mfma_f32_16x16x32_bf16 v[220:223], a[204:207], a[140:143], v[220:223]
    buffer_load_dwordx4 v1, s[8:11], s28 offen offset:0  lds
    s_waitcnt lgkmcnt(12)
    v_mfma_f32_16x16x32_bf16 v[224:227], a[208:211], a[128:131], v[224:227]
    ds_read_b64_tr_b16 a[200:201], v12 offset:8320
    v_mfma_f32_16x16x32_bf16 v[228:231], a[208:211], a[132:135], v[228:231]
    ds_read_b64_tr_b16 a[202:203], v12 offset:12416
    v_mfma_f32_16x16x32_bf16 v[232:235], a[208:211], a[136:139], v[232:235]
    ds_read_b128 a[244:247], v14 offset:2048
    v_mfma_f32_16x16x32_bf16 v[236:239], a[208:211], a[140:143], v[236:239]
    s_waitcnt lgkmcnt(11)
    v_mfma_f32_16x16x32_bf16 v[240:243], a[212:215], a[128:131], v[240:243]
    s_add_u32 m0, s34, 0
    v_mfma_f32_16x16x32_bf16 v[244:247], a[212:215], a[132:135], v[244:247]
    ds_read_b64_tr_b16 a[204:205], v12 offset:160
    v_mfma_f32_16x16x32_bf16 v[248:251], a[212:215], a[136:139], v[248:251]
    ds_read_b64_tr_b16 a[206:207], v12 offset:4256
    v_mfma_f32_16x16x32_bf16 v[252:255], a[212:215], a[140:143], v[252:255]
    buffer_load_dwordx4 v2, s[8:11], s28 offen offset:1024  lds
    s_waitcnt lgkmcnt(10)
    v_mfma_f32_16x16x32_bf16 a[0:3], a[216:219], a[128:131], a[0:3]
    ds_read_b64_tr_b16 a[208:209], v12 offset:8352
    v_mfma_f32_16x16x32_bf16 a[4:7], a[216:219], a[132:135], a[4:7]
    ds_read_b64_tr_b16 a[210:211], v12 offset:12448
    v_mfma_f32_16x16x32_bf16 a[8:11], a[216:219], a[136:139], a[8:11]
    ds_read_b128 a[248:251], v14 offset:6144
    v_mfma_f32_16x16x32_bf16 a[12:15], a[216:219], a[140:143], a[12:15]
    s_waitcnt lgkmcnt(11)
    v_mfma_f32_16x16x32_bf16 a[16:19], a[192:195], a[128:131], a[16:19]
    s_add_u32 m0, s34, 0
    v_mfma_f32_16x16x32_bf16 a[20:23], a[192:195], a[132:135], a[20:23]
    ds_read_b64_tr_b16 a[212:213], v12 offset:192
    v_mfma_f32_16x16x32_bf16 a[24:27], a[192:195], a[136:139], a[24:27]
    ds_read_b64_tr_b16 a[214:215], v12 offset:4288
    v_mfma_f32_16x16x32_bf16 a[28:31], a[192:195], a[140:143], a[28:31]
    buffer_load_dwordx4 v1, s[8:11], s28 offen offset:2048  lds
    s_waitcnt lgkmcnt(10)
    v_mfma_f32_16x16x32_bf16 a[32:35], a[196:199], a[128:131], a[32:35]
    ds_read_b64_tr_b16 a[216:217], v12 offset:8384
    v_mfma_f32_16x16x32_bf16 a[36:39], a[196:199], a[132:135], a[36:39]
    v_mfma_f32_16x16x32_bf16 a[40:43], a[196:199], a[136:139], a[40:43]
    ds_read_b64_tr_b16 a[218:219], v12 offset:12480
    v_mfma_f32_16x16x32_bf16 a[44:47], a[196:199], a[140:143], a[44:47]
    s_waitcnt lgkmcnt(10)
    v_mfma_f32_16x16x32_bf16 a[48:51], a[200:203], a[128:131], a[48:51]
    s_add_u32 m0, s34, 0
    v_mfma_f32_16x16x32_bf16 a[52:55], a[200:203], a[132:135], a[52:55]
    v_mfma_f32_16x16x32_bf16 a[56:59], a[200:203], a[136:139], a[56:59]
    buffer_load_dwordx4 v2, s[8:11], s28 offen offset:3072  lds
    v_mfma_f32_16x16x32_bf16 a[60:63], a[200:203], a[140:143], a[60:63]
    s_waitcnt lgkmcnt(7)
    v_mfma_f32_16x16x32_bf16 a[64:67], a[204:207], a[128:131], a[64:67]
    s_mov_b64 exec, 0x3fff
    buffer_load_dword a255, v28, s[12:15], s95 offen
    s_mov_b64 exec, -1
    v_mfma_f32_16x16x32_bf16 a[68:71], a[204:207], a[132:135], a[68:71]
    v_mfma_f32_16x16x32_bf16 a[72:75], a[204:207], a[136:139], a[72:75]
    s_mov_b64 exec, 0xf
    buffer_load_dword a255, v29, s[16:19], s94 offen nt
    s_mov_b64 exec, -1
    v_mfma_f32_16x16x32_bf16 a[76:79], a[204:207], a[140:143], a[76:79]
    s_waitcnt lgkmcnt(5)
    v_mfma_f32_16x16x32_bf16 a[80:83], a[208:211], a[128:131], a[80:83]
    s_mov_b64 exec, 0xf
    buffer_load_dword a255, v30, s[8:11], s94 offen
    s_mov_b64 exec, -1
    v_mfma_f32_16x16x32_bf16 a[84:87], a[208:211], a[132:135], a[84:87]
    v_mfma_f32_16x16x32_bf16 a[88:91], a[208:211], a[136:139], a[88:91]
    s_mov_b64 exec, 0x7ffff
    buffer_load_dword a255, v31, s[88:91], s92 offen
    s_mov_b64 exec, -1
    v_mfma_f32_16x16x32_bf16 a[92:95], a[208:211], a[140:143], a[92:95]
    s_waitcnt vmcnt(26)
    s_waitcnt lgkmcnt(0)
    s_barrier
    v_mfma_f32_16x16x32_bf16 a[96:99], a[212:215], a[128:131], a[96:99]
    ds_read_b64_tr_b16 a[192:193], v12 offset:16384
    ds_read_b64_tr_b16 a[194:195], v12 offset:20480
    v_mfma_f32_16x16x32_bf16 a[100:103], a[212:215], a[132:135], a[100:103]
    s_add_u32 s92, s92, 2432
    v_mfma_f32_16x16x32_bf16 a[104:107], a[212:215], a[136:139], a[104:107]
    s_add_u32 s95, s95, 917504
    v_mfma_f32_16x16x32_bf16 a[108:111], a[212:215], a[140:143], a[108:111]
    s_add_u32 s94, s94, 256
    s_cmp_lt_u32 s94, 2048
    s_cselect_b32 s94, s94, s77
    v_mfma_f32_16x16x32_bf16 a[112:115], a[216:219], a[128:131], a[112:115]
    s_add_u32 m0, s32, 0
    v_mfma_f32_16x16x32_bf16 a[116:119], a[216:219], a[132:135], a[116:119]
    ds_read_b64_tr_b16 a[196:197], v12 offset:24576
    v_mfma_f32_16x16x32_bf16 a[120:123], a[216:219], a[136:139], a[120:123]
    ds_read_b64_tr_b16 a[198:199], v12 offset:28672
    v_mfma_f32_16x16x32_bf16 a[124:127], a[216:219], a[140:143], a[124:127]
    buffer_load_dwordx4 v3, s[12:15], s30 offen offset:0 nt lds
    v_mfma_f32_16x16x32_bf16 v[96:99], a[220:223], a[128:131], v[96:99]
    s_add_u32 m0, s35, 0
    v_mfma_f32_16x16x32_bf16 v[100:103], a[220:223], a[132:135], v[100:103]
    ds_read_b64_tr_b16 a[200:201], v12 offset:16416
    v_mfma_f32_16x16x32_bf16 v[104:107], a[220:223], a[136:139], v[104:107]
    ds_read_b64_tr_b16 a[202:203], v12 offset:20512
    v_mfma_f32_16x16x32_bf16 v[108:111], a[220:223], a[140:143], v[108:111]
    buffer_load_dwordx4 v10, s[16:19], s31 offen offset:0 nt lds
    v_mfma_f32_16x16x32_bf16 v[112:115], a[224:227], a[128:131], v[112:115]
    s_add_u32 m0, s32, 0
    v_mfma_f32_16x16x32_bf16 v[116:119], a[224:227], a[132:135], v[116:119]
    ds_read_b64_tr_b16 a[204:205], v12 offset:24608
    v_mfma_f32_16x16x32_bf16 v[120:123], a[224:227], a[136:139], v[120:123]
    ds_read_b64_tr_b16 a[206:207], v12 offset:28704
    v_mfma_f32_16x16x32_bf16 v[124:127], a[224:227], a[140:143], v[124:127]
    buffer_load_dwordx4 v4, s[12:15], s30 offen offset:1024 nt lds
    v_mfma_f32_16x16x32_bf16 v[128:131], a[228:231], a[128:131], v[128:131]
    s_add_u32 m0, s35, 0
    ds_read_b64_tr_b16 a[208:209], v12 offset:16448
    v_mfma_f32_16x16x32_bf16 v[132:135], a[228:231], a[132:135], v[132:135]
    ds_read_b64_tr_b16 a[210:211], v12 offset:20544
    buffer_load_dwordx4 v11, s[16:19], s31 offen offset:1024 nt lds
    v_mfma_f32_16x16x32_bf16 v[136:139], a[228:231], a[136:139], v[136:139]
    s_add_u32 s31, s31, 128
    s_cmp_lt_u32 s31, 2048
    v_mfma_f32_16x16x32_bf16 v[140:143], a[228:231], a[140:143], v[140:143]
    s_cselect_b32 s31, s31, s77
    v_mfma_f32_16x16x32_bf16 v[144:147], a[232:235], a[128:131], v[144:147]
    s_add_u32 m0, s32, 0
    v_mfma_f32_16x16x32_bf16 v[148:151], a[232:235], a[132:135], v[148:151]
    v_mfma_f32_16x16x32_bf16 v[152:155], a[232:235], a[136:139], v[152:155]
    buffer_load_dwordx4 v5, s[12:15], s30 offen offset:2048 nt lds
    v_mfma_f32_16x16x32_bf16 v[156:159], a[232:235], a[140:143], v[156:159]
    s_waitcnt lgkmcnt(8)
    v_mfma_f32_16x16x32_bf16 v[160:163], a[192:195], a[144:147], v[160:163]
    ds_read_b64_tr_b16 a[212:213], v12 offset:24640
    v_mfma_f32_16x16x32_bf16 v[164:167], a[192:195], a[148:151], v[164:167]
    v_mfma_f32_16x16x32_bf16 v[168:171], a[192:195], a[152:155], v[168:171]
    ds_read_b64_tr_b16 a[214:215], v12 offset:28736
    v_mfma_f32_16x16x32_bf16 v[172:175], a[192:195], a[156:159], v[172:175]
    s_waitcnt lgkmcnt(8)
    v_mfma_f32_16x16x32_bf16 v[176:179], a[196:199], a[144:147], v[176:179]
    s_add_u32 m0, s32, 0
    ds_read_b64_tr_b16 a[216:217], v12 offset:16480
    v_mfma_f32_16x16x32_bf16 v[180:183], a[196:199], a[148:151], v[180:183]
    ds_read_b64_tr_b16 a[218:219], v12 offset:20576
    v_mfma_f32_16x16x32_bf16 v[184:187], a[196:199], a[152:155], v[184:187]
    buffer_load_dwordx4 v6, s[12:15], s30 offen offset:3072 nt lds
    v_mfma_f32_16x16x32_bf16 v[188:191], a[196:199], a[156:159], v[188:191]
    s_add_u32 s30, s30, 229376
    s_waitcnt lgkmcnt(8)
    v_mfma_f32_16x16x32_bf16 v[192:195], a[200:203], a[144:147], v[192:195]
    ds_read_b64_tr_b16 a[192:193], v12 offset:24672
    v_mfma_f32_16x16x32_bf16 v[196:199], a[200:203], a[148:151], v[196:199]
    v_mfma_f32_16x16x32_bf16 v[200:203], a[200:203], a[152:155], v[200:203]
    ds_read_b64_tr_b16 a[194:195], v12 offset:28768
    v_mfma_f32_16x16x32_bf16 v[204:207], a[200:203], a[156:159], v[204:207]
    s_waitcnt lgkmcnt(8)
    v_mfma_f32_16x16x32_bf16 v[208:211], a[204:207], a[144:147], v[208:211]
    s_add_u32 m0, s34, 4096
    v_mfma_f32_16x16x32_bf16 v[212:215], a[204:207], a[148:151], v[212:215]
    ds_read_b64_tr_b16 a[196:197], v12 offset:16512
    v_mfma_f32_16x16x32_bf16 v[216:219], a[204:207], a[152:155], v[216:219]
    ds_read_b64_tr_b16 a[198:199], v12 offset:20608
    v_mfma_f32_16x16x32_bf16 v[220:223], a[204:207], a[156:159], v[220:223]
    buffer_load_dwordx4 v1, s[8:11], s29 offen offset:0  lds
    s_waitcnt lgkmcnt(8)
    v_mfma_f32_16x16x32_bf16 v[224:227], a[208:211], a[144:147], v[224:227]
    ds_read_b64_tr_b16 a[200:201], v12 offset:24704
    v_mfma_f32_16x16x32_bf16 v[228:231], a[208:211], a[148:151], v[228:231]
    v_mfma_f32_16x16x32_bf16 v[232:235], a[208:211], a[152:155], v[232:235]
    ds_read_b64_tr_b16 a[202:203], v12 offset:28800
    v_mfma_f32_16x16x32_bf16 v[236:239], a[208:211], a[156:159], v[236:239]
    s_waitcnt lgkmcnt(8)
    v_mfma_f32_16x16x32_bf16 v[240:243], a[212:215], a[144:147], v[240:243]
    s_add_u32 m0, s34, 4096
    v_mfma_f32_16x16x32_bf16 v[244:247], a[212:215], a[148:151], v[244:247]
    ds_read_b64_tr_b16 a[204:205], v12 offset:16544
    v_mfma_f32_16x16x32_bf16 v[248:251], a[212:215], a[152:155], v[248:251]
    ds_read_b64_tr_b16 a[206:207], v12 offset:20640
    v_mfma_f32_16x16x32_bf16 v[252:255], a[212:215], a[156:159], v[252:255]
    buffer_load_dwordx4 v2, s[8:11], s29 offen offset:1024  lds
    s_waitcnt lgkmcnt(8)
    v_mfma_f32_16x16x32_bf16 a[0:3], a[216:219], a[144:147], a[0:3]
    ds_read_b64_tr_b16 a[208:209], v12 offset:24736
    v_mfma_f32_16x16x32_bf16 a[4:7], a[216:219], a[148:151], a[4:7]
    v_mfma_f32_16x16x32_bf16 a[8:11], a[216:219], a[152:155], a[8:11]
    ds_read_b64_tr_b16 a[210:211], v12 offset:28832
    v_mfma_f32_16x16x32_bf16 a[12:15], a[216:219], a[156:159], a[12:15]
    s_waitcnt lgkmcnt(8)
    v_mfma_f32_16x16x32_bf16 a[16:19], a[192:195], a[144:147], a[16:19]
    s_add_u32 m0, s34, 4096
    v_mfma_f32_16x16x32_bf16 a[20:23], a[192:195], a[148:151], a[20:23]
    ds_read_b64_tr_b16 a[212:213], v12 offset:16576
    v_mfma_f32_16x16x32_bf16 a[24:27], a[192:195], a[152:155], a[24:27]
    ds_read_b64_tr_b16 a[214:215], v12 offset:20672
    v_mfma_f32_16x16x32_bf16 a[28:31], a[192:195], a[156:159], a[28:31]
    buffer_load_dwordx4 v1, s[8:11], s29 offen offset:2048  lds
    s_waitcnt lgkmcnt(8)
    v_mfma_f32_16x16x32_bf16 a[32:35], a[196:199], a[144:147], a[32:35]
    ds_read_b64_tr_b16 a[216:217], v12 offset:24768
    v_mfma_f32_16x16x32_bf16 a[36:39], a[196:199], a[148:151], a[36:39]
    v_mfma_f32_16x16x32_bf16 a[40:43], a[196:199], a[152:155], a[40:43]
    ds_read_b64_tr_b16 a[218:219], v12 offset:28864
    v_mfma_f32_16x16x32_bf16 a[44:47], a[196:199], a[156:159], a[44:47]
    s_waitcnt lgkmcnt(8)
    v_mfma_f32_16x16x32_bf16 a[48:51], a[200:203], a[144:147], a[48:51]
    s_add_u32 m0, s34, 4096
    s_waitcnt vmcnt(21)
    ds_read_b128 a[160:163], v7 offset:8192
    v_mfma_f32_16x16x32_bf16 a[52:55], a[200:203], a[148:151], a[52:55]
    ds_read_b128 a[164:167], v7 offset:10240
    buffer_load_dwordx4 v2, s[8:11], s29 offen offset:3072  lds
    v_mfma_f32_16x16x32_bf16 a[56:59], a[200:203], a[152:155], a[56:59]
    s_add_u32 s28, s28, 128
    s_cmp_lt_u32 s28, 2048
    v_mfma_f32_16x16x32_bf16 a[60:63], a[200:203], a[156:159], a[60:63]
    s_cselect_b32 s28, s28, s77
    s_add_u32 s29, s28, 4096
    s_waitcnt lgkmcnt(8)
    v_mfma_f32_16x16x32_bf16 a[64:67], a[204:207], a[144:147], a[64:67]
    ds_read_b128 a[168:171], v7 offset:12288
    v_mfma_f32_16x16x32_bf16 a[68:71], a[204:207], a[148:151], a[68:71]
    v_mfma_f32_16x16x32_bf16 a[72:75], a[204:207], a[152:155], a[72:75]
    ds_read_b128 a[172:175], v7 offset:14336
    v_mfma_f32_16x16x32_bf16 a[76:79], a[204:207], a[156:159], a[76:79]
    s_waitcnt lgkmcnt(8)
    v_mfma_f32_16x16x32_bf16 a[80:83], a[208:211], a[144:147], a[80:83]
    v_mfma_f32_16x16x32_bf16 a[84:87], a[208:211], a[148:151], a[84:87]
    v_mfma_f32_16x16x32_bf16 a[88:91], a[208:211], a[152:155], a[88:91]
    v_mfma_f32_16x16x32_bf16 a[92:95], a[208:211], a[156:159], a[92:95]
    s_waitcnt vmcnt(26)
    s_waitcnt lgkmcnt(0)
    s_barrier
    v_mfma_f32_16x16x32_bf16 a[96:99], a[212:215], a[144:147], a[96:99]
    ds_read_b64_tr_b16 a[192:193], v12 offset:32768
    v_mfma_f32_16x16x32_bf16 a[100:103], a[212:215], a[148:151], a[100:103]
    ds_read_b64_tr_b16 a[194:195], v12 offset:36864
    v_mfma_f32_16x16x32_bf16 a[104:107], a[212:215], a[152:155], a[104:107]
    ds_read_b128 a[220:223], v13 offset:8192
    v_mfma_f32_16x16x32_bf16 a[108:111], a[212:215], a[156:159], a[108:111]
    ds_read_b128 a[224:227], v13 offset:12288
    v_mfma_f32_16x16x32_bf16 a[112:115], a[216:219], a[144:147], a[112:115]
    s_add_u32 m0, s32, 16384
    ds_read_b64_tr_b16 a[196:197], v12 offset:40960
    v_mfma_f32_16x16x32_bf16 a[116:119], a[216:219], a[148:151], a[116:119]
    ds_read_b64_tr_b16 a[198:199], v12 offset:45056
    v_mfma_f32_16x16x32_bf16 a[120:123], a[216:219], a[152:155], a[120:123]
    ds_read_b128 a[228:231], v13 offset:10240
    ds_read_b128 a[232:235], v13 offset:14336
    v_mfma_f32_16x16x32_bf16 a[124:127], a[216:219], a[156:159], a[124:127]
    buffer_load_dwordx4 v3, s[12:15], s30 offen offset:0 nt lds
    v_mfma_f32_16x16x32_bf16 v[96:99], a[236:239], a[144:147], v[96:99]
    ds_read_b64_tr_b16 a[200:201], v12 offset:32800
    v_mfma_f32_16x16x32_bf16 v[100:103], a[236:239], a[148:151], v[100:103]
    ds_read_b64_tr_b16 a[202:203], v12 offset:36896
    v_mfma_f32_16x16x32_bf16 v[104:107], a[236:239], a[152:155], v[104:107]
    ds_read_b128 a[176:179], v8 offset:8192
    v_mfma_f32_16x16x32_bf16 v[108:111], a[236:239], a[156:159], v[108:111]
    v_mfma_f32_16x16x32_bf16 v[112:115], a[240:243], a[144:147], v[112:115]
    s_add_u32 m0, s32, 16384
    ds_read_b64_tr_b16 a[204:205], v12 offset:40992
    v_mfma_f32_16x16x32_bf16 v[116:119], a[240:243], a[148:151], v[116:119]
    ds_read_b64_tr_b16 a[206:207], v12 offset:45088
    v_mfma_f32_16x16x32_bf16 v[120:123], a[240:243], a[152:155], v[120:123]
    ds_read_b128 a[180:183], v8 offset:10240
    v_mfma_f32_16x16x32_bf16 v[124:127], a[240:243], a[156:159], v[124:127]
    buffer_load_dwordx4 v4, s[12:15], s30 offen offset:1024 nt lds
    v_mfma_f32_16x16x32_bf16 v[128:131], a[244:247], a[144:147], v[128:131]
    ds_read_b64_tr_b16 a[208:209], v12 offset:32832
    v_mfma_f32_16x16x32_bf16 v[132:135], a[244:247], a[148:151], v[132:135]
    ds_read_b64_tr_b16 a[210:211], v12 offset:36928
    v_mfma_f32_16x16x32_bf16 v[136:139], a[244:247], a[152:155], v[136:139]
    ds_read_b128 a[184:187], v8 offset:12288
    v_mfma_f32_16x16x32_bf16 v[140:143], a[244:247], a[156:159], v[140:143]
    v_mfma_f32_16x16x32_bf16 v[144:147], a[248:251], a[144:147], v[144:147]
    s_add_u32 m0, s32, 16384
    v_mfma_f32_16x16x32_bf16 v[148:151], a[248:251], a[148:151], v[148:151]
    ds_read_b128 a[188:191], v8 offset:14336
    v_mfma_f32_16x16x32_bf16 v[152:155], a[248:251], a[152:155], v[152:155]
    buffer_load_dwordx4 v5, s[12:15], s30 offen offset:2048 nt lds
    v_mfma_f32_16x16x32_bf16 v[156:159], a[248:251], a[156:159], v[156:159]
    s_waitcnt lgkmcnt(14)
    v_mfma_f32_16x16x32_bf16 v[160:163], a[192:195], a[160:163], v[160:163]
    ds_read_b64_tr_b16 a[212:213], v12 offset:41024
    v_mfma_f32_16x16x32_bf16 v[164:167], a[192:195], a[164:167], v[164:167]
    ds_read_b64_tr_b16 a[214:215], v12 offset:45120
    v_mfma_f32_16x16x32_bf16 v[168:171], a[192:195], a[168:171], v[168:171]
    ds_read_b128 a[236:239], v14 offset:8192
    v_mfma_f32_16x16x32_bf16 v[172:175], a[192:195], a[172:175], v[172:175]
    s_waitcnt lgkmcnt(14)
    v_mfma_f32_16x16x32_bf16 v[176:179], a[196:199], a[160:163], v[176:179]
    s_add_u32 m0, s32, 16384
    ds_read_b64_tr_b16 a[216:217], v12 offset:32864
    v_mfma_f32_16x16x32_bf16 v[180:183], a[196:199], a[164:167], v[180:183]
    ds_read_b64_tr_b16 a[218:219], v12 offset:36960
    v_mfma_f32_16x16x32_bf16 v[184:187], a[196:199], a[168:171], v[184:187]
    buffer_load_dwordx4 v6, s[12:15], s30 offen offset:3072 nt lds
    v_mfma_f32_16x16x32_bf16 v[188:191], a[196:199], a[172:175], v[188:191]
    s_add_u32 s30, s30, 229376
    s_waitcnt lgkmcnt(13)
    v_mfma_f32_16x16x32_bf16 v[192:195], a[200:203], a[160:163], v[192:195]
    ds_read_b64_tr_b16 a[192:193], v12 offset:41056
    v_mfma_f32_16x16x32_bf16 v[196:199], a[200:203], a[164:167], v[196:199]
    ds_read_b64_tr_b16 a[194:195], v12 offset:45152
    v_mfma_f32_16x16x32_bf16 v[200:203], a[200:203], a[168:171], v[200:203]
    ds_read_b128 a[240:243], v14 offset:12288
    v_mfma_f32_16x16x32_bf16 v[204:207], a[200:203], a[172:175], v[204:207]
    s_waitcnt lgkmcnt(13)
    v_mfma_f32_16x16x32_bf16 v[208:211], a[204:207], a[160:163], v[208:211]
    s_add_u32 m0, s34, 8192
    v_mfma_f32_16x16x32_bf16 v[212:215], a[204:207], a[164:167], v[212:215]
    ds_read_b64_tr_b16 a[196:197], v12 offset:32896
    v_mfma_f32_16x16x32_bf16 v[216:219], a[204:207], a[168:171], v[216:219]
    ds_read_b64_tr_b16 a[198:199], v12 offset:36992
    v_mfma_f32_16x16x32_bf16 v[220:223], a[204:207], a[172:175], v[220:223]
    buffer_load_dwordx4 v1, s[8:11], s28 offen offset:0  lds
    s_waitcnt lgkmcnt(12)
    v_mfma_f32_16x16x32_bf16 v[224:227], a[208:211], a[160:163], v[224:227]
    ds_read_b64_tr_b16 a[200:201], v12 offset:41088
    v_mfma_f32_16x16x32_bf16 v[228:231], a[208:211], a[164:167], v[228:231]
    ds_read_b64_tr_b16 a[202:203], v12 offset:45184
    v_mfma_f32_16x16x32_bf16 v[232:235], a[208:211], a[168:171], v[232:235]
    ds_read_b128 a[244:247], v14 offset:10240
    v_mfma_f32_16x16x32_bf16 v[236:239], a[208:211], a[172:175], v[236:239]
    s_waitcnt lgkmcnt(11)
    v_mfma_f32_16x16x32_bf16 v[240:243], a[212:215], a[160:163], v[240:243]
    s_add_u32 m0, s34, 8192
    v_mfma_f32_16x16x32_bf16 v[244:247], a[212:215], a[164:167], v[244:247]
    ds_read_b64_tr_b16 a[204:205], v12 offset:32928
    v_mfma_f32_16x16x32_bf16 v[248:251], a[212:215], a[168:171], v[248:251]
    ds_read_b64_tr_b16 a[206:207], v12 offset:37024
    v_mfma_f32_16x16x32_bf16 v[252:255], a[212:215], a[172:175], v[252:255]
    buffer_load_dwordx4 v2, s[8:11], s28 offen offset:1024  lds
    s_waitcnt lgkmcnt(10)
    v_mfma_f32_16x16x32_bf16 a[0:3], a[216:219], a[160:163], a[0:3]
    ds_read_b64_tr_b16 a[208:209], v12 offset:41120
    v_mfma_f32_16x16x32_bf16 a[4:7], a[216:219], a[164:167], a[4:7]
    ds_read_b64_tr_b16 a[210:211], v12 offset:45216
    v_mfma_f32_16x16x32_bf16 a[8:11], a[216:219], a[168:171], a[8:11]
    ds_read_b128 a[248:251], v14 offset:14336
    v_mfma_f32_16x16x32_bf16 a[12:15], a[216:219], a[172:175], a[12:15]
    s_waitcnt lgkmcnt(11)
    v_mfma_f32_16x16x32_bf16 a[16:19], a[192:195], a[160:163], a[16:19]
    s_add_u32 m0, s34, 8192
    v_mfma_f32_16x16x32_bf16 a[20:23], a[192:195], a[164:167], a[20:23]
    ds_read_b64_tr_b16 a[212:213], v12 offset:32960
    v_mfma_f32_16x16x32_bf16 a[24:27], a[192:195], a[168:171], a[24:27]
    ds_read_b64_tr_b16 a[214:215], v12 offset:37056
    v_mfma_f32_16x16x32_bf16 a[28:31], a[192:195], a[172:175], a[28:31]
    buffer_load_dwordx4 v1, s[8:11], s28 offen offset:2048  lds
    s_waitcnt lgkmcnt(10)
    v_mfma_f32_16x16x32_bf16 a[32:35], a[196:199], a[160:163], a[32:35]
    ds_read_b64_tr_b16 a[216:217], v12 offset:41152
    v_mfma_f32_16x16x32_bf16 a[36:39], a[196:199], a[164:167], a[36:39]
    v_mfma_f32_16x16x32_bf16 a[40:43], a[196:199], a[168:171], a[40:43]
    ds_read_b64_tr_b16 a[218:219], v12 offset:45248
    v_mfma_f32_16x16x32_bf16 a[44:47], a[196:199], a[172:175], a[44:47]
    s_waitcnt lgkmcnt(10)
    v_mfma_f32_16x16x32_bf16 a[48:51], a[200:203], a[160:163], a[48:51]
    s_add_u32 m0, s34, 8192
    v_mfma_f32_16x16x32_bf16 a[52:55], a[200:203], a[164:167], a[52:55]
    v_mfma_f32_16x16x32_bf16 a[56:59], a[200:203], a[168:171], a[56:59]
    buffer_load_dwordx4 v2, s[8:11], s28 offen offset:3072  lds
    v_mfma_f32_16x16x32_bf16 a[60:63], a[200:203], a[172:175], a[60:63]
    s_waitcnt lgkmcnt(7)
    v_mfma_f32_16x16x32_bf16 a[64:67], a[204:207], a[160:163], a[64:67]
    v_mfma_f32_16x16x32_bf16 a[68:71], a[204:207], a[164:167], a[68:71]
    v_mfma_f32_16x16x32_bf16 a[72:75], a[204:207], a[168:171], a[72:75]
    v_mfma_f32_16x16x32_bf16 a[76:79], a[204:207], a[172:175], a[76:79]
    s_waitcnt lgkmcnt(5)
    v_mfma_f32_16x16x32_bf16 a[80:83], a[208:211], a[160:163], a[80:83]
    v_mfma_f32_16x16x32_bf16 a[84:87], a[208:211], a[164:167], a[84:87]
    v_mfma_f32_16x16x32_bf16 a[88:91], a[208:211], a[168:171], a[88:91]
    v_mfma_f32_16x16x32_bf16 a[92:95], a[208:211], a[172:175], a[92:95]
    s_waitcnt vmcnt(26)
    s_waitcnt lgkmcnt(0)
    s_barrier
    v_mfma_f32_16x16x32_bf16 a[96:99], a[212:215], a[160:163], a[96:99]
    ds_read_b64_tr_b16 a[192:193], v12 offset:49152
    v_mfma_f32_16x16x32_bf16 a[100:103], a[212:215], a[164:167], a[100:103]
    v_mfma_f32_16x16x32_bf16 a[104:107], a[212:215], a[168:171], a[104:107]
    ds_read_b64_tr_b16 a[194:195], v12 offset:53248
    v_mfma_f32_16x16x32_bf16 a[108:111], a[212:215], a[172:175], a[108:111]
    v_mfma_f32_16x16x32_bf16 a[112:115], a[216:219], a[160:163], a[112:115]
    s_add_u32 m0, s32, 32768
    v_mfma_f32_16x16x32_bf16 a[116:119], a[216:219], a[164:167], a[116:119]
    ds_read_b64_tr_b16 a[196:197], v12 offset:57344
    v_mfma_f32_16x16x32_bf16 a[120:123], a[216:219], a[168:171], a[120:123]
    ds_read_b64_tr_b16 a[198:199], v12 offset:61440
    v_mfma_f32_16x16x32_bf16 a[124:127], a[216:219], a[172:175], a[124:127]
    buffer_load_dwordx4 v3, s[12:15], s30 offen offset:0 nt lds
    v_mfma_f32_16x16x32_bf16 v[96:99], a[220:223], a[160:163], v[96:99]
    s_add_u32 m0, s35, 8192
    v_mfma_f32_16x16x32_bf16 v[100:103], a[220:223], a[164:167], v[100:103]
    ds_read_b64_tr_b16 a[200:201], v12 offset:49184
    v_mfma_f32_16x16x32_bf16 v[104:107], a[220:223], a[168:171], v[104:107]
    ds_read_b64_tr_b16 a[202:203], v12 offset:53280
    v_mfma_f32_16x16x32_bf16 v[108:111], a[220:223], a[172:175], v[108:111]
    buffer_load_dwordx4 v10, s[16:19], s31 offen offset:0 nt lds
    v_mfma_f32_16x16x32_bf16 v[112:115], a[224:227], a[160:163], v[112:115]
    s_add_u32 m0, s32, 32768
    v_mfma_f32_16x16x32_bf16 v[116:119], a[224:227], a[164:167], v[116:119]
    ds_read_b64_tr_b16 a[204:205], v12 offset:57376
    v_mfma_f32_16x16x32_bf16 v[120:123], a[224:227], a[168:171], v[120:123]
    ds_read_b64_tr_b16 a[206:207], v12 offset:61472
    v_mfma_f32_16x16x32_bf16 v[124:127], a[224:227], a[172:175], v[124:127]
    buffer_load_dwordx4 v4, s[12:15], s30 offen offset:1024 nt lds
    v_mfma_f32_16x16x32_bf16 v[128:131], a[228:231], a[160:163], v[128:131]
    s_add_u32 m0, s35, 8192
    ds_read_b64_tr_b16 a[208:209], v12 offset:49216
    v_mfma_f32_16x16x32_bf16 v[132:135], a[228:231], a[164:167], v[132:135]
    ds_read_b64_tr_b16 a[210:211], v12 offset:53312
    buffer_load_dwordx4 v11, s[16:19], s31 offen offset:1024 nt lds
    v_mfma_f32_16x16x32_bf16 v[136:139], a[228:231], a[168:171], v[136:139]
    s_add_u32 s31, s31, 128
    s_cmp_lt_u32 s31, 2048
    v_mfma_f32_16x16x32_bf16 v[140:143], a[228:231], a[172:175], v[140:143]
    s_cselect_b32 s31, s31, s77
    v_mfma_f32_16x16x32_bf16 v[144:147], a[232:235], a[160:163], v[144:147]
    s_add_u32 m0, s32, 32768
    v_mfma_f32_16x16x32_bf16 v[148:151], a[232:235], a[164:167], v[148:151]
    v_mfma_f32_16x16x32_bf16 v[152:155], a[232:235], a[168:171], v[152:155]
    buffer_load_dwordx4 v5, s[12:15], s30 offen offset:2048 nt lds
    v_mfma_f32_16x16x32_bf16 v[156:159], a[232:235], a[172:175], v[156:159]
    s_waitcnt lgkmcnt(8)
    v_mfma_f32_16x16x32_bf16 v[160:163], a[192:195], a[176:179], v[160:163]
    ds_read_b64_tr_b16 a[212:213], v12 offset:57408
    v_mfma_f32_16x16x32_bf16 v[164:167], a[192:195], a[180:183], v[164:167]
    v_mfma_f32_16x16x32_bf16 v[168:171], a[192:195], a[184:187], v[168:171]
    ds_read_b64_tr_b16 a[214:215], v12 offset:61504
    v_mfma_f32_16x16x32_bf16 v[172:175], a[192:195], a[188:191], v[172:175]
    s_waitcnt lgkmcnt(8)
    v_mfma_f32_16x16x32_bf16 v[176:179], a[196:199], a[176:179], v[176:179]
    s_add_u32 m0, s32, 32768
    ds_read_b64_tr_b16 a[216:217], v12 offset:49248
    v_mfma_f32_16x16x32_bf16 v[180:183], a[196:199], a[180:183], v[180:183]
    ds_read_b64_tr_b16 a[218:219], v12 offset:53344
    v_mfma_f32_16x16x32_bf16 v[184:187], a[196:199], a[184:187], v[184:187]
    buffer_load_dwordx4 v6, s[12:15], s30 offen offset:3072 nt lds
    v_mfma_f32_16x16x32_bf16 v[188:191], a[196:199], a[188:191], v[188:191]
    s_add_u32 s30, s30, 229376
    s_waitcnt lgkmcnt(8)
    v_mfma_f32_16x16x32_bf16 v[192:195], a[200:203], a[176:179], v[192:195]
    ds_read_b64_tr_b16 a[192:193], v12 offset:57440
    v_mfma_f32_16x16x32_bf16 v[196:199], a[200:203], a[180:183], v[196:199]
    v_mfma_f32_16x16x32_bf16 v[200:203], a[200:203], a[184:187], v[200:203]
    ds_read_b64_tr_b16 a[194:195], v12 offset:61536
    v_mfma_f32_16x16x32_bf16 v[204:207], a[200:203], a[188:191], v[204:207]
    s_waitcnt lgkmcnt(8)
    v_mfma_f32_16x16x32_bf16 v[208:211], a[204:207], a[176:179], v[208:211]
    s_add_u32 m0, s34, 12288
    v_mfma_f32_16x16x32_bf16 v[212:215], a[204:207], a[180:183], v[212:215]
    ds_read_b64_tr_b16 a[196:197], v12 offset:49280
    v_mfma_f32_16x16x32_bf16 v[216:219], a[204:207], a[184:187], v[216:219]
    ds_read_b64_tr_b16 a[198:199], v12 offset:53376
    v_mfma_f32_16x16x32_bf16 v[220:223], a[204:207], a[188:191], v[220:223]
    buffer_load_dwordx4 v1, s[8:11], s29 offen offset:0  lds
    s_waitcnt lgkmcnt(8)
    v_mfma_f32_16x16x32_bf16 v[224:227], a[208:211], a[176:179], v[224:227]
    ds_read_b64_tr_b16 a[200:201], v12 offset:57472
    v_mfma_f32_16x16x32_bf16 v[228:231], a[208:211], a[180:183], v[228:231]
    v_mfma_f32_16x16x32_bf16 v[232:235], a[208:211], a[184:187], v[232:235]
    ds_read_b64_tr_b16 a[202:203], v12 offset:61568
    v_mfma_f32_16x16x32_bf16 v[236:239], a[208:211], a[188:191], v[236:239]
    s_waitcnt lgkmcnt(8)
    v_mfma_f32_16x16x32_bf16 v[240:243], a[212:215], a[176:179], v[240:243]
    s_add_u32 m0, s34, 12288
    v_mfma_f32_16x16x32_bf16 v[244:247], a[212:215], a[180:183], v[244:247]
    ds_read_b64_tr_b16 a[204:205], v12 offset:49312
    v_mfma_f32_16x16x32_bf16 v[248:251], a[212:215], a[184:187], v[248:251]
    ds_read_b64_tr_b16 a[206:207], v12 offset:53408
    v_mfma_f32_16x16x32_bf16 v[252:255], a[212:215], a[188:191], v[252:255]
    buffer_load_dwordx4 v2, s[8:11], s29 offen offset:1024  lds
    s_waitcnt lgkmcnt(8)
    v_mfma_f32_16x16x32_bf16 a[0:3], a[216:219], a[176:179], a[0:3]
    ds_read_b64_tr_b16 a[208:209], v12 offset:57504
    v_mfma_f32_16x16x32_bf16 a[4:7], a[216:219], a[180:183], a[4:7]
    v_mfma_f32_16x16x32_bf16 a[8:11], a[216:219], a[184:187], a[8:11]
    ds_read_b64_tr_b16 a[210:211], v12 offset:61600
    v_mfma_f32_16x16x32_bf16 a[12:15], a[216:219], a[188:191], a[12:15]
    s_waitcnt lgkmcnt(8)
    v_mfma_f32_16x16x32_bf16 a[16:19], a[192:195], a[176:179], a[16:19]
    s_add_u32 m0, s34, 12288
    v_mfma_f32_16x16x32_bf16 a[20:23], a[192:195], a[180:183], a[20:23]
    ds_read_b64_tr_b16 a[212:213], v12 offset:49344
    v_mfma_f32_16x16x32_bf16 a[24:27], a[192:195], a[184:187], a[24:27]
    ds_read_b64_tr_b16 a[214:215], v12 offset:53440
    v_mfma_f32_16x16x32_bf16 a[28:31], a[192:195], a[188:191], a[28:31]
    buffer_load_dwordx4 v1, s[8:11], s29 offen offset:2048  lds
    s_waitcnt lgkmcnt(8)
    v_mfma_f32_16x16x32_bf16 a[32:35], a[196:199], a[176:179], a[32:35]
    ds_read_b64_tr_b16 a[216:217], v12 offset:57536
    v_mfma_f32_16x16x32_bf16 a[36:39], a[196:199], a[180:183], a[36:39]
    v_mfma_f32_16x16x32_bf16 a[40:43], a[196:199], a[184:187], a[40:43]
    ds_read_b64_tr_b16 a[218:219], v12 offset:61632
    v_mfma_f32_16x16x32_bf16 a[44:47], a[196:199], a[188:191], a[44:47]
    s_waitcnt lgkmcnt(8)
    v_mfma_f32_16x16x32_bf16 a[48:51], a[200:203], a[176:179], a[48:51]
    s_add_u32 m0, s34, 12288
    s_waitcnt vmcnt(17)
    ds_read_b128 a[128:131], v7 offset:0
    v_mfma_f32_16x16x32_bf16 a[52:55], a[200:203], a[180:183], a[52:55]
    ds_read_b128 a[132:135], v7 offset:2048
    buffer_load_dwordx4 v2, s[8:11], s29 offen offset:3072  lds
    v_mfma_f32_16x16x32_bf16 a[56:59], a[200:203], a[184:187], a[56:59]
    s_add_u32 s28, s28, 128
    s_cmp_lt_u32 s28, 2048
    v_mfma_f32_16x16x32_bf16 a[60:63], a[200:203], a[188:191], a[60:63]
    s_cselect_b32 s28, s28, s77
    s_add_u32 s29, s28, 4096
    s_waitcnt lgkmcnt(8)
    v_mfma_f32_16x16x32_bf16 a[64:67], a[204:207], a[176:179], a[64:67]
    ds_read_b128 a[136:139], v7 offset:4096
    v_mfma_f32_16x16x32_bf16 a[68:71], a[204:207], a[180:183], a[68:71]
    v_mfma_f32_16x16x32_bf16 a[72:75], a[204:207], a[184:187], a[72:75]
    ds_read_b128 a[140:143], v7 offset:6144
    v_mfma_f32_16x16x32_bf16 a[76:79], a[204:207], a[188:191], a[76:79]
    s_waitcnt lgkmcnt(8)
    v_mfma_f32_16x16x32_bf16 a[80:83], a[208:211], a[176:179], a[80:83]
    v_mfma_f32_16x16x32_bf16 a[84:87], a[208:211], a[180:183], a[84:87]
    v_mfma_f32_16x16x32_bf16 a[88:91], a[208:211], a[184:187], a[88:91]
    v_mfma_f32_16x16x32_bf16 a[92:95], a[208:211], a[188:191], a[92:95]
    s_waitcnt vmcnt(22)
    s_waitcnt lgkmcnt(0)
    s_barrier
    v_mfma_f32_16x16x32_bf16 a[96:99], a[212:215], a[176:179], a[96:99]
    ds_read_b64_tr_b16 a[192:193], v12 offset:0
    v_mfma_f32_16x16x32_bf16 a[100:103], a[212:215], a[180:183], a[100:103]
    ds_read_b64_tr_b16 a[194:195], v12 offset:4096
    v_mfma_f32_16x16x32_bf16 a[104:107], a[212:215], a[184:187], a[104:107]
    ds_read_b128 a[220:223], v13 offset:0
    v_mfma_f32_16x16x32_bf16 a[108:111], a[212:215], a[188:191], a[108:111]
    ds_read_b128 a[224:227], v13 offset:4096
    v_mfma_f32_16x16x32_bf16 a[112:115], a[216:219], a[176:179], a[112:115]
    s_add_u32 m0, s32, 49152
    ds_read_b64_tr_b16 a[196:197], v12 offset:8192
    v_mfma_f32_16x16x32_bf16 a[116:119], a[216:219], a[180:183], a[116:119]
    ds_read_b64_tr_b16 a[198:199], v12 offset:12288
    v_mfma_f32_16x16x32_bf16 a[120:123], a[216:219], a[184:187], a[120:123]
    ds_read_b128 a[228:231], v13 offset:2048
    ds_read_b128 a[232:235], v13 offset:6144
    v_mfma_f32_16x16x32_bf16 a[124:127], a[216:219], a[188:191], a[124:127]
    buffer_load_dwordx4 v3, s[12:15], s30 offen offset:0 nt lds
    v_mfma_f32_16x16x32_bf16 v[96:99], a[236:239], a[176:179], v[96:99]
    ds_read_b64_tr_b16 a[200:201], v12 offset:32
    v_mfma_f32_16x16x32_bf16 v[100:103], a[236:239], a[180:183], v[100:103]
    ds_read_b64_tr_b16 a[202:203], v12 offset:4128
    v_mfma_f32_16x16x32_bf16 v[104:107], a[236:239], a[184:187], v[104:107]
    ds_read_b128 a[144:147], v8 offset:0
    v_mfma_f32_16x16x32_bf16 v[108:111], a[236:239], a[188:191], v[108:111]
    v_mfma_f32_16x16x32_bf16 v[112:115], a[240:243], a[176:179], v[112:115]
    s_add_u32 m0, s32, 49152
    ds_read_b64_tr_b16 a[204:205], v12 offset:8224
    v_mfma_f32_16x16x32_bf16 v[116:119], a[240:243], a[180:183], v[116:119]
    ds_read_b64_tr_b16 a[206:207], v12 offset:12320
    v_mfma_f32_16x16x32_bf16 v[120:123], a[240:243], a[184:187], v[120:123]
    ds_read_b128 a[148:151], v8 offset:2048
    v_mfma_f32_16x16x32_bf16 v[124:127], a[240:243], a[188:191], v[124:127]
    buffer_load_dwordx4 v4, s[12:15], s30 offen offset:1024 nt lds
    v_mfma_f32_16x16x32_bf16 v[128:131], a[244:247], a[176:179], v[128:131]
    ds_read_b64_tr_b16 a[208:209], v12 offset:64
    v_mfma_f32_16x16x32_bf16 v[132:135], a[244:247], a[180:183], v[132:135]
    ds_read_b64_tr_b16 a[210:211], v12 offset:4160
    v_mfma_f32_16x16x32_bf16 v[136:139], a[244:247], a[184:187], v[136:139]
    ds_read_b128 a[152:155], v8 offset:4096
    v_mfma_f32_16x16x32_bf16 v[140:143], a[244:247], a[188:191], v[140:143]
    v_mfma_f32_16x16x32_bf16 v[144:147], a[248:251], a[176:179], v[144:147]
    s_add_u32 m0, s32, 49152
    v_mfma_f32_16x16x32_bf16 v[148:151], a[248:251], a[180:183], v[148:151]
    ds_read_b128 a[156:159], v8 offset:6144
    v_mfma_f32_16x16x32_bf16 v[152:155], a[248:251], a[184:187], v[152:155]
    buffer_load_dwordx4 v5, s[12:15], s30 offen offset:2048 nt lds
    v_mfma_f32_16x16x32_bf16 v[156:159], a[248:251], a[188:191], v[156:159]
    s_add_u32 s33, s33, 1
    s_cmp_lt_u32 s33, 6
    s_cbranch_scc1 K1_loop
CP_b:
    v_and_b32 v26, 31, v17
    v_lshlrev_b32 v26, 2, v26
    buffer_load_dword v25, v26, s[24:27], 0 offen offset:128 sc1
    s_waitcnt lgkmcnt(10)
    v_mfma_f32_16x16x32_bf16 v[96:99], a[220:223], a[128:131], v[96:99]
    s_add_u32 m0, s32, 49152
    s_nop 0
    buffer_load_dwordx4 v6, s[12:15], s30 offen offset:3072 nt lds
    v_mfma_f32_16x16x32_bf16 v[100:103], a[220:223], a[132:135], v[100:103]
    ds_read_b128 a[236:239], v14 offset:0
    s_lshl_b32 s6, s4, 6
    v_mfma_f32_16x16x32_bf16 v[104:107], a[220:223], a[136:139], v[104:107]
    s_lshr_b32 s7, s3, 1
    s_lshl_b32 s7, s7, 5
    v_mfma_f32_16x16x32_bf16 v[108:111], a[220:223], a[140:143], v[108:111]
    s_add_u32 s6, s6, s7
    v_mfma_f32_16x16x32_bf16 v[112:115], a[224:227], a[128:131], v[112:115]
    ds_read_b128 a[240:243], v14 offset:4096
    s_add_u32 s6, s6, s5
    v_mfma_f32_16x16x32_bf16 v[116:119], a[224:227], a[132:135], v[116:119]
    s_lshl_b32 s6, s6, 13
    v_mfma_f32_16x16x32_bf16 v[120:123], a[224:227], a[136:139], v[120:123]
    s_and_b32 s7, s3, 1
    v_mfma_f32_16x16x32_bf16 v[124:127], a[224:227], a[140:143], v[124:127]
    s_lshl_b32 s7, s7, 12
    v_mfma_f32_16x16x32_bf16 v[128:131], a[228:231], a[128:131], v[128:131]
    ds_read_b128 a[244:247], v14 offset:2048
    s_add_u32 s6, s6, s7
    v_mfma_f32_16x16x32_bf16 v[132:135], a[228:231], a[132:135], v[132:135]
    s_add_u32 s6, s6, 25165824
    v_mfma_f32_16x16x32_bf16 v[136:139], a[228:231], a[136:139], v[136:139]
    v_lshlrev_b32 v20, 4, v17
    v_mfma_f32_16x16x32_bf16 v[140:143], a[228:231], a[140:143], v[140:143]
    buffer_store_dwordx4 v[32:35], v20, s[20:23], s6 offen offset:0 sc1
    v_mfma_f32_16x16x32_bf16 v[144:147], a[232:235], a[128:131], v[144:147]
    ds_read_b128 a[248:251], v14 offset:6144
    buffer_store_dwordx4 v[36:39], v20, s[20:23], s6 offen offset:1024 sc1
    v_mfma_f32_16x16x32_bf16 v[148:151], a[232:235], a[132:135], v[148:151]
    buffer_store_dwordx4 v[40:43], v20, s[20:23], s6 offen offset:2048 sc1
    v_mfma_f32_16x16x32_bf16 v[152:155], a[232:235], a[136:139], v[152:155]
    buffer_store_dwordx4 v[44:47], v20, s[20:23], s6 offen offset:3072 sc1
    v_mfma_f32_16x16x32_bf16 v[156:159], a[232:235], a[140:143], v[156:159]
    v_lshlrev_b32 v20, 5, v19
    s_waitcnt lgkmcnt(0)
    v_mfma_f32_16x16x32_bf16 v[96:99], a[236:239], a[144:147], v[96:99]
    s_waitcnt vmcnt(9)
    ds_read_b128 a[160:163], v7 offset:8192
    v_mfma_f32_16x16x32_bf16 v[100:103], a[236:239], a[148:151], v[100:103]
    ds_read_b128 a[164:167], v7 offset:10240
    v_add_u32 v20, 147456, v20
    v_mfma_f32_16x16x32_bf16 v[104:107], a[236:239], a[152:155], v[104:107]
    ds_read_b128 v[32:35], v20 offset:0
    ds_read_b128 v[36:39], v20 offset:16
    v_mfma_f32_16x16x32_bf16 v[108:111], a[236:239], a[156:159], v[108:111]
    ds_read_b128 v[40:43], v20 offset:128
    v_mfma_f32_16x16x32_bf16 v[112:115], a[240:243], a[144:147], v[112:115]
    ds_read_b128 a[168:171], v7 offset:12288
    ds_read_b128 a[172:175], v7 offset:14336
    v_mfma_f32_16x16x32_bf16 v[116:119], a[240:243], a[148:151], v[116:119]
    ds_read_b128 v[44:47], v20 offset:144
    v_mfma_f32_16x16x32_bf16 v[120:123], a[240:243], a[152:155], v[120:123]
    ds_read_b128 v[48:51], v20 offset:256
    ds_read_b128 v[52:55], v20 offset:272
    v_mfma_f32_16x16x32_bf16 v[124:127], a[240:243], a[156:159], v[124:127]
    ds_read_b128 v[56:59], v20 offset:384
    v_mfma_f32_16x16x32_bf16 v[128:131], a[244:247], a[144:147], v[128:131]
    ds_read_b128 a[176:179], v8 offset:8192
    ds_read_b128 a[180:183], v8 offset:10240
    v_mfma_f32_16x16x32_bf16 v[132:135], a[244:247], a[148:151], v[132:135]
    ds_read_b128 v[60:63], v20 offset:400
    v_mfma_f32_16x16x32_bf16 v[136:139], a[244:247], a[152:155], v[136:139]
    s_lshl_b32 s78, s4, 2
    s_add_u32 s78, s78, s3
    v_mfma_f32_16x16x32_bf16 v[140:143], a[244:247], a[156:159], v[140:143]
    s_lshl_b32 s79, s5, 13
    v_mfma_f32_16x16x32_bf16 v[144:147], a[248:251], a[144:147], v[144:147]
    ds_read_b128 a[184:187], v8 offset:12288
    ds_read_b128 a[188:191], v8 offset:14336
    v_mfma_f32_16x16x32_bf16 v[148:151], a[248:251], a[148:151], v[148:151]
    s_add_u32 s79, s79, 23076864
    v_mfma_f32_16x16x32_bf16 v[152:155], a[248:251], a[152:155], v[152:155]
    s_lshl_b32 s80, s78, 8
    s_add_u32 s80, s80, s79
    v_mfma_f32_16x16x32_bf16 v[156:159], a[248:251], a[156:159], v[156:159]
    v_lshlrev_b32 v21, 6, v19
    s_waitcnt vmcnt(13)
    s_barrier
    s_waitcnt lgkmcnt(14)
    v_mfma_f32_16x16x32_bf16 v[160:163], a[192:195], a[128:131], v[160:163]
    ds_read_b128 a[220:223], v13 offset:8192
    ds_read_b128 a[224:227], v13 offset:12288
    ds_read_b64_tr_b16 a[208:209], v12 offset:16384
    v_mfma_f32_16x16x32_bf16 v[164:167], a[192:195], a[132:135], v[164:167]
    ds_read_b64_tr_b16 a[210:211], v12 offset:20480
    ds_read_b64_tr_b16 a[212:213], v12 offset:24576
    v_mfma_f32_16x16x32_bf16 v[168:171], a[192:195], a[136:139], v[168:171]
    ds_read_b64_tr_b16 a[214:215], v12 offset:28672
    s_sub_u32 s81, s78, 1
    v_sub_u32 v22, s81, v18
    v_mfma_f32_16x16x32_bf16 v[172:175], a[192:195], a[140:143], v[172:175]
    v_subrev_u32 v23, 16, v22
    v_cmp_gt_u32 vcc, 32, v22
    s_waitcnt lgkmcnt(14)
    v_mfma_f32_16x16x32_bf16 v[176:179], a[196:199], a[128:131], v[176:179]
    ds_read_b128 a[228:231], v13 offset:10240
    ds_read_b128 a[232:235], v13 offset:14336
    v_mfma_f32_16x16x32_bf16 v[180:183], a[196:199], a[132:135], v[180:183]
    ds_read_b64_tr_b16 a[216:217], v12 offset:16416
    ds_read_b64_tr_b16 a[218:219], v12 offset:20512
    v_mfma_f32_16x16x32_bf16 v[184:187], a[196:199], a[136:139], v[184:187]
    v_lshl_add_u32 v22, v22, 8, v21
    v_mov_b32 v24, s77
    v_mfma_f32_16x16x32_bf16 v[188:191], a[196:199], a[140:143], v[188:191]
    v_cndmask_b32 v22, v24, v22, vcc
    v_cmp_gt_u32 vcc, 32, v23
    s_waitcnt lgkmcnt(14)
    v_mfma_f32_16x16x32_bf16 v[192:195], a[200:203], a[128:131], v[192:195]
    ds_read_b128 a[236:239], v14 offset:8192
    ds_read_b128 a[240:243], v14 offset:12288
    v_mfma_f32_16x16x32_bf16 v[196:199], a[200:203], a[132:135], v[196:199]
    ds_read_b64_tr_b16 a[192:193], v12 offset:24608
    ds_read_b64_tr_b16 a[194:195], v12 offset:28704
    v_mfma_f32_16x16x32_bf16 v[200:203], a[200:203], a[136:139], v[200:203]
    v_lshl_add_u32 v23, v23, 8, v21
    s_lshl_b32 s7, s5, 2
    v_mfma_f32_16x16x32_bf16 v[204:207], a[200:203], a[140:143], v[204:207]
    v_cndmask_b32 v23, v24, v23, vcc
    v_cmp_eq_u32 s[82:83], 15, v18
    s_waitcnt lgkmcnt(14)
    v_mfma_f32_16x16x32_bf16 v[208:211], a[204:207], a[128:131], v[208:211]
    ds_read_b128 a[244:247], v14 offset:10240
    ds_read_b128 a[248:251], v14 offset:14336
    v_mfma_f32_16x16x32_bf16 v[212:215], a[204:207], a[132:135], v[212:215]
    ds_read_b64_tr_b16 a[196:197], v12 offset:32768
    ds_read_b64_tr_b16 a[198:199], v12 offset:36864
    v_mfma_f32_16x16x32_bf16 v[216:219], a[204:207], a[136:139], v[216:219]
    s_lshl_b32 s6, s4, 1
    s_lshr_b32 s7, s3, 1
    v_mfma_f32_16x16x32_bf16 v[220:223], a[204:207], a[140:143], v[220:223]
    s_add_u32 s6, s6, s7
    s_mul_i32 s6, s6, 1441792
    s_waitcnt lgkmcnt(10)
    v_mfma_f32_16x16x32_bf16 v[96:99], a[220:223], a[160:163], v[96:99]
    s_and_b32 s7, s3, 1
    v_mfma_f32_16x16x32_bf16 v[100:103], a[220:223], a[164:167], v[100:103]
    s_lshl_b32 s7, s7, 12
    v_mfma_f32_16x16x32_bf16 v[104:107], a[220:223], a[168:171], v[104:107]
    s_add_u32 s6, s6, s7
    v_mfma_f32_16x16x32_bf16 v[108:111], a[220:223], a[172:175], v[108:111]
    v_lshl_add_u32 v15, v17, 4, s6
    v_mfma_f32_16x16x32_bf16 v[112:115], a[224:227], a[160:163], v[112:115]
    s_mul_i32 s70, s5, 7
    v_mfma_f32_16x16x32_bf16 v[116:119], a[224:227], a[164:167], v[116:119]
    s_add_u32 s70, s70, 1
    v_mfma_f32_16x16x32_bf16 v[120:123], a[224:227], a[168:171], v[120:123]
    s_lshr_b32 s70, s70, 1
    v_mfma_f32_16x16x32_bf16 v[124:127], a[224:227], a[172:175], v[124:127]
    s_lshl_b32 s70, s70, 13
    v_mfma_f32_16x16x32_bf16 v[128:131], a[228:231], a[160:163], v[128:131]
    s_add_u32 s71, s70, 8192
    v_mfma_f32_16x16x32_bf16 v[132:135], a[228:231], a[164:167], v[132:135]
    s_add_u32 s72, s70, 16384
    v_mfma_f32_16x16x32_bf16 v[136:139], a[228:231], a[168:171], v[136:139]
    s_add_u32 s73, s70, 24576
    v_mfma_f32_16x16x32_bf16 v[140:143], a[228:231], a[172:175], v[140:143]
    s_sub_u32 s74, s70, 7680
    v_mfma_f32_16x16x32_bf16 v[144:147], a[232:235], a[160:163], v[144:147]
    s_bitcmp1_b32 s5, 0
    v_mfma_f32_16x16x32_bf16 v[148:151], a[232:235], a[164:167], v[148:151]
    s_cselect_b32 s73, s74, s73
    v_mfma_f32_16x16x32_bf16 v[152:155], a[232:235], a[168:171], v[152:155]
    v_and_b32 v27, 31, v17
    v_mfma_f32_16x16x32_bf16 v[156:159], a[232:235], a[172:175], v[156:159]
    v_lshrrev_b32 v9, 5, v17
    s_waitcnt lgkmcnt(2)
    v_mfma_f32_16x16x32_bf16 v[96:99], a[236:239], a[176:179], v[96:99]
    v_lshl_add_u32 v27, v27, 4, s6
    v_mfma_f32_16x16x32_bf16 v[100:103], a[236:239], a[180:183], v[100:103]
    v_mfma_f32_16x16x32_bf16 v[104:107], a[236:239], a[184:187], v[104:107]
    v_lshl_add_u32 v27, v9, 10, v27
    v_mfma_f32_16x16x32_bf16 v[108:111], a[236:239], a[188:191], v[108:111]
    v_mfma_f32_16x16x32_bf16 v[112:115], a[240:243], a[176:179], v[112:115]
    v_mfma_f32_16x16x32_bf16 v[116:119], a[240:243], a[180:183], v[116:119]
    v_mfma_f32_16x16x32_bf16 v[120:123], a[240:243], a[184:187], v[120:123]
    v_mfma_f32_16x16x32_bf16 v[124:127], a[240:243], a[188:191], v[124:127]
    v_mfma_f32_16x16x32_bf16 v[128:131], a[244:247], a[176:179], v[128:131]
    v_mfma_f32_16x16x32_bf16 v[132:135], a[244:247], a[180:183], v[132:135]
    v_mfma_f32_16x16x32_bf16 v[136:139], a[244:247], a[184:187], v[136:139]
    v_mfma_f32_16x16x32_bf16 v[140:143], a[244:247], a[188:191], v[140:143]
    v_mfma_f32_16x16x32_bf16 v[144:147], a[248:251], a[176:179], v[144:147]
    v_mfma_f32_16x16x32_bf16 v[148:151], a[248:251], a[180:183], v[148:151]
    v_mfma_f32_16x16x32_bf16 v[152:155], a[248:251], a[184:187], v[152:155]
    v_mfma_f32_16x16x32_bf16 v[156:159], a[248:251], a[188:191], v[156:159]
    s_waitcnt lgkmcnt(14)
    v_mfma_f32_16x16x32_bf16 v[160:163], a[208:211], a[144:147], v[160:163]
    ds_read_b64_tr_b16 a[200:201], v12 offset:40960
    v_mfma_f32_16x16x32_bf16 v[164:167], a[208:211], a[148:151], v[164:167]
    v_mfma_f32_16x16x32_bf16 v[168:171], a[208:211], a[152:155], v[168:171]
    ds_read_b64_tr_b16 a[202:203], v12 offset:45056
    v_mfma_f32_16x16x32_bf16 v[172:175], a[208:211], a[156:159], v[172:175]
    s_waitcnt lgkmcnt(14)
    v_mfma_f32_16x16x32_bf16 v[176:179], a[212:215], a[144:147], v[176:179]
    ds_read_b64_tr_b16 a[204:205], v12 offset:32800
    v_mfma_f32_16x16x32_bf16 v[180:183], a[212:215], a[148:151], v[180:183]
    v_mfma_f32_16x16x32_bf16 v[184:187], a[212:215], a[152:155], v[184:187]
    ds_read_b64_tr_b16 a[206:207], v12 offset:36896
    v_mfma_f32_16x16x32_bf16 v[188:191], a[212:215], a[156:159], v[188:191]
    s_waitcnt vmcnt(4)
    s_barrier
    s_waitcnt vmcnt(5)
    s_mov_b32 s75, 0
K1_ichk:
    v_cmp_ne_u32 vcc, 0xff, v25
    s_add_u32 s75, s75, 1
    s_nop 0
    s_cmp_eq_u64 vcc, 0
    s_cbranch_scc1 K1_ichkok
    s_cmp_ge_u32 s75, 0x4000
    s_cbranch_scc1 K1_ichkok
    s_sleep 4
    buffer_load_dword v25, v26, s[24:27], 0 offen offset:128 sc1
    s_waitcnt vmcnt(0)
    s_branch K1_ichk
K1_ichkok:
    s_lshl_b32 s6, s4, 8
    s_lshl_b32 s7, s3, 6
    s_add_u32 s6, s6, s7
    s_lshl_b32 s6, s6, 2
    s_add_u32 s6, s6, 23068672
    v_lshlrev_b32 v24, 4, v18
    buffer_load_dwordx4 v[28:31], v24, s[20:23], s6 offen sc1
    s_waitcnt lgkmcnt(12)
    v_mfma_f32_16x16x32_bf16 v[192:195], a[216:219], a[144:147], v[192:195]
    ds_read_b64_tr_b16 a[208:209], v12 offset:40992
    ds_read_b64_tr_b16 a[210:211], v12 offset:45088
    s_waitcnt lgkmcnt(14)
    v_fma_f32 v80, v32, v96, v100
    v_mfma_f32_16x16x32_bf16 v[196:199], a[216:219], a[148:151], v[196:199]
    v_fma_f32 v81, v33, v97, v101
    v_fma_f32 v88, v32, v112, v116
    v_fma_f32 v89, v33, v113, v117
    v_fma_f32 v80, -v40, v112, v80
    v_mfma_f32_16x16x32_bf16 v[200:203], a[216:219], a[152:155], v[200:203]
    v_fma_f32 v81, -v41, v113, v81
    v_fmac_f32 v88, v40, v96
    v_fmac_f32 v89, v41, v97
    v_fma_f32 v82, v34, v98, v102
    v_mfma_f32_16x16x32_bf16 v[204:207], a[216:219], a[156:159], v[204:207]
    v_fma_f32 v83, v35, v99, v103
    v_fma_f32 v90, v34, v114, v118
    v_fma_f32 v91, v35, v115, v119
    v_fma_f32 v82, -v42, v114, v82
    s_waitcnt lgkmcnt(10)
    v_mfma_f32_16x16x32_bf16 v[208:211], a[192:195], a[144:147], v[208:211]
    ds_read_b64_tr_b16 a[212:213], v12 offset:49152
    ds_read_b64_tr_b16 a[214:215], v12 offset:53248
    v_fma_f32 v83, -v43, v115, v83
    v_fmac_f32 v90, v42, v98
    v_mfma_f32_16x16x32_bf16 v[212:215], a[192:195], a[148:151], v[212:215]
    v_fmac_f32 v91, v43, v99
    v_fma_f32 v84, v36, v128, v132
    v_fma_f32 v85, v37, v129, v133
    v_fma_f32 v92, v36, v144, v148
    v_mfma_f32_16x16x32_bf16 v[216:219], a[192:195], a[152:155], v[216:219]
    v_fma_f32 v93, v37, v145, v149
    v_fma_f32 v84, -v44, v144, v84
    v_fma_f32 v85, -v45, v145, v85
    v_fmac_f32 v92, v44, v128
    v_mfma_f32_16x16x32_bf16 v[220:223], a[192:195], a[156:159], v[220:223]
    v_fmac_f32 v93, v45, v129
    v_fma_f32 v86, v38, v130, v134
    v_fma_f32 v87, v39, v131, v135
    v_fma_f32 v94, v38, v146, v150
    s_waitcnt lgkmcnt(8)
    v_mfma_f32_16x16x32_bf16 v[160:163], a[196:199], a[160:163], v[160:163]
    ds_read_b64_tr_b16 a[216:217], v12 offset:57344
    ds_read_b64_tr_b16 a[218:219], v12 offset:61440
    v_fma_f32 v95, v39, v147, v151
    v_fma_f32 v86, -v46, v146, v86
    v_mfma_f32_16x16x32_bf16 v[164:167], a[196:199], a[164:167], v[164:167]
    v_fma_f32 v87, -v47, v147, v87
    v_fmac_f32 v94, v46, v130
    v_fmac_f32 v95, v47, v131
    v_fma_f32 v64, v32, v80, v104
    v_mfma_f32_16x16x32_bf16 v[168:171], a[196:199], a[168:171], v[168:171]
    v_fma_f32 v65, v33, v81, v105
    v_fma_f32 v72, v32, v88, v120
    v_fma_f32 v73, v33, v89, v121
    v_fma_f32 v64, -v40, v88, v64
    v_mfma_f32_16x16x32_bf16 v[172:175], a[196:199], a[172:175], v[172:175]
    v_fma_f32 v65, -v41, v89, v65
    v_fmac_f32 v72, v40, v80
    v_fmac_f32 v73, v41, v81
    v_fma_f32 v66, v34, v82, v106
    s_waitcnt lgkmcnt(8)
    v_mfma_f32_16x16x32_bf16 v[176:179], a[200:203], a[160:163], v[176:179]
    ds_read_b64_tr_b16 a[192:193], v12 offset:49184
    ds_read_b64_tr_b16 a[194:195], v12 offset:53280
    v_fma_f32 v67, v35, v83, v107
    v_fma_f32 v74, v34, v90, v122
    v_mfma_f32_16x16x32_bf16 v[180:183], a[200:203], a[164:167], v[180:183]
    v_fma_f32 v75, v35, v91, v123
    v_fma_f32 v66, -v42, v90, v66
    v_fma_f32 v67, -v43, v91, v67
    v_fmac_f32 v74, v42, v82
    v_mfma_f32_16x16x32_bf16 v[184:187], a[200:203], a[168:171], v[184:187]
    v_fmac_f32 v75, v43, v83
    v_fma_f32 v68, v36, v84, v136
    v_fma_f32 v69, v37, v85, v137
    v_fma_f32 v76, v36, v92, v152
    v_mfma_f32_16x16x32_bf16 v[188:191], a[200:203], a[172:175], v[188:191]
    v_fma_f32 v77, v37, v93, v153
    v_fma_f32 v68, -v44, v92, v68
    v_fma_f32 v69, -v45, v93, v69
    v_fmac_f32 v76, v44, v84
    s_waitcnt lgkmcnt(8)
    v_mfma_f32_16x16x32_bf16 v[192:195], a[204:207], a[160:163], v[192:195]
    ds_read_b64_tr_b16 a[196:197], v12 offset:57376
    ds_read_b64_tr_b16 a[198:199], v12 offset:61472
    v_fmac_f32 v77, v45, v85
    v_fma_f32 v70, v38, v86, v138
    v_mfma_f32_16x16x32_bf16 v[196:199], a[204:207], a[164:167], v[196:199]
    v_fma_f32 v71, v39, v87, v139
    v_fma_f32 v78, v38, v94, v154
    v_fma_f32 v79, v39, v95, v155
    v_fma_f32 v70, -v46, v94, v70
    v_mfma_f32_16x16x32_bf16 v[200:203], a[204:207], a[168:171], v[200:203]
    v_fma_f32 v71, -v47, v95, v71
    v_fmac_f32 v78, v46, v86
    v_fmac_f32 v79, v47, v87
    v_fma_f32 v80, v32, v64, v108
    v_mfma_f32_16x16x32_bf16 v[204:207], a[204:207], a[172:175], v[204:207]
    v_fma_f32 v81, v33, v65, v109
    v_fma_f32 v88, v32, v72, v124
    v_fma_f32 v89, v33, v73, v125
    v_fma_f32 v80, -v40, v72, v80
    s_waitcnt lgkmcnt(8)
    v_mfma_f32_16x16x32_bf16 v[208:211], a[208:211], a[160:163], v[208:211]
    ds_read_b64_tr_b16 a[200:201], v12 offset:64
    ds_read_b64_tr_b16 a[202:203], v12 offset:4160
    v_fma_f32 v81, -v41, v73, v81
    v_fmac_f32 v88, v40, v64
    v_mfma_f32_16x16x32_bf16 v[212:215], a[208:211], a[164:167], v[212:215]
    v_fmac_f32 v89, v41, v65
    v_fma_f32 v82, v34, v66, v110
    v_fma_f32 v83, v35, v67, v111
    v_fma_f32 v90, v34, v74, v126
    v_mfma_f32_16x16x32_bf16 v[216:219], a[208:211], a[168:171], v[216:219]
    v_fma_f32 v91, v35, v75, v127
    v_fma_f32 v82, -v42, v74, v82
    v_fma_f32 v83, -v43, v75, v83
    v_fmac_f32 v90, v42, v66
    v_mfma_f32_16x16x32_bf16 v[220:223], a[208:211], a[172:175], v[220:223]
    v_fmac_f32 v91, v43, v67
    v_fma_f32 v84, v36, v68, v140
    v_fma_f32 v85, v37, v69, v141
    v_fma_f32 v92, v36, v76, v156
    s_waitcnt lgkmcnt(8)
    v_mfma_f32_16x16x32_bf16 v[160:163], a[212:215], a[176:179], v[160:163]
    ds_read_b64_tr_b16 a[204:205], v12 offset:8256
    ds_read_b64_tr_b16 a[206:207], v12 offset:12352
    v_fma_f32 v93, v37, v77, v157
    v_fma_f32 v84, -v44, v76, v84
    v_mfma_f32_16x16x32_bf16 v[164:167], a[212:215], a[180:183], v[164:167]
    v_fma_f32 v85, -v45, v77, v85
    v_fmac_f32 v92, v44, v68
    v_fmac_f32 v93, v45, v69
    v_fma_f32 v86, v38, v70, v142
    v_mfma_f32_16x16x32_bf16 v[168:171], a[212:215], a[184:187], v[168:171]
    v_fma_f32 v87, v39, v71, v143
    v_fma_f32 v94, v38, v78, v158
    v_fma_f32 v95, v39, v79, v159
    v_fma_f32 v86, -v46, v78, v86
    v_mfma_f32_16x16x32_bf16 v[172:175], a[212:215], a[188:191], v[172:175]
    v_fma_f32 v87, -v47, v79, v87
    v_fmac_f32 v94, v46, v70
    v_fmac_f32 v95, v47, v71
    v_mov_b32_dpp v64, v80 row_shr:1 row_mask:0xf bank_mask:0xf bound_ctrl:0
    s_waitcnt lgkmcnt(8)
    v_mfma_f32_16x16x32_bf16 v[176:179], a[216:219], a[176:179], v[176:179]
    ds_read_b64_tr_b16 a[208:209], v12 offset:96
    ds_read_b64_tr_b16 a[210:211], v12 offset:4192
    v_mov_b32_dpp v65, v81 row_shr:1 row_mask:0xf bank_mask:0xf bound_ctrl:0
    v_mov_b32_dpp v66, v82 row_shr:1 row_mask:0xf bank_mask:0xf bound_ctrl:0
    v_mfma_f32_16x16x32_bf16 v[180:183], a[216:219], a[180:183], v[180:183]
    v_mov_b32_dpp v67, v83 row_shr:1 row_mask:0xf bank_mask:0xf bound_ctrl:0
    v_mov_b32_dpp v68, v84 row_shr:1 row_mask:0xf bank_mask:0xf bound_ctrl:0
    v_mov_b32_dpp v69, v85 row_shr:1 row_mask:0xf bank_mask:0xf bound_ctrl:0
    v_mov_b32_dpp v70, v86 row_shr:1 row_mask:0xf bank_mask:0xf bound_ctrl:0
    v_mfma_f32_16x16x32_bf16 v[184:187], a[216:219], a[184:187], v[184:187]
    v_mov_b32_dpp v71, v87 row_shr:1 row_mask:0xf bank_mask:0xf bound_ctrl:0
    v_mov_b32_dpp v72, v88 row_shr:1 row_mask:0xf bank_mask:0xf bound_ctrl:0
    v_mov_b32_dpp v73, v89 row_shr:1 row_mask:0xf bank_mask:0xf bound_ctrl:0
    v_mov_b32_dpp v74, v90 row_shr:1 row_mask:0xf bank_mask:0xf bound_ctrl:0
    v_mfma_f32_16x16x32_bf16 v[188:191], a[216:219], a[188:191], v[188:191]
    v_mov_b32_dpp v75, v91 row_shr:1 row_mask:0xf bank_mask:0xf bound_ctrl:0
    v_mov_b32_dpp v76, v92 row_shr:1 row_mask:0xf bank_mask:0xf bound_ctrl:0
    v_mov_b32_dpp v77, v93 row_shr:1 row_mask:0xf bank_mask:0xf bound_ctrl:0
    v_mov_b32_dpp v78, v94 row_shr:1 row_mask:0xf bank_mask:0xf bound_ctrl:0
    s_waitcnt lgkmcnt(8)
    v_mfma_f32_16x16x32_bf16 v[192:195], a[192:195], a[176:179], v[192:195]
    ds_read_b64_tr_b16 a[212:213], v12 offset:8288
    ds_read_b64_tr_b16 a[214:215], v12 offset:12384
    v_mov_b32_dpp v79, v95 row_shr:1 row_mask:0xf bank_mask:0xf bound_ctrl:0
    s_waitcnt lgkmcnt(14)
    v_mfma_f32_16x16x32_bf16 v[196:199], a[192:195], a[180:183], v[196:199]
    v_fma_f32 v80, v48, v64, v80
    v_fma_f32 v81, v49, v65, v81
    v_fma_f32 v88, v48, v72, v88
    v_fma_f32 v89, v49, v73, v89
    v_mfma_f32_16x16x32_bf16 v[200:203], a[192:195], a[184:187], v[200:203]
    v_fma_f32 v80, -v56, v72, v80
    v_fma_f32 v81, -v57, v73, v81
    v_fmac_f32 v88, v56, v64
    v_fmac_f32 v89, v57, v65
    v_mfma_f32_16x16x32_bf16 v[204:207], a[192:195], a[188:191], v[204:207]
    v_fma_f32 v82, v50, v66, v82
    v_fma_f32 v83, v51, v67, v83
    v_fma_f32 v90, v50, v74, v90
    v_fma_f32 v91, v51, v75, v91
    s_waitcnt lgkmcnt(8)
    v_mfma_f32_16x16x32_bf16 v[208:211], a[196:199], a[176:179], v[208:211]
    ds_read_b64_tr_b16 a[216:217], v12 offset:16448
    ds_read_b64_tr_b16 a[218:219], v12 offset:20544
    v_fma_f32 v82, -v58, v74, v82
    v_fma_f32 v83, -v59, v75, v83
    v_mfma_f32_16x16x32_bf16 v[212:215], a[196:199], a[180:183], v[212:215]
    v_fmac_f32 v90, v58, v66
    v_fmac_f32 v91, v59, v67
    v_fma_f32 v84, v52, v68, v84
    v_fma_f32 v85, v53, v69, v85
    v_mfma_f32_16x16x32_bf16 v[216:219], a[196:199], a[184:187], v[216:219]
    v_fma_f32 v92, v52, v76, v92
    v_fma_f32 v93, v53, v77, v93
    v_fma_f32 v84, -v60, v76, v84
    v_fma_f32 v85, -v61, v77, v85
    v_mfma_f32_16x16x32_bf16 v[220:223], a[196:199], a[188:191], v[220:223]
    v_fmac_f32 v92, v60, v68
    v_fmac_f32 v93, v61, v69
    v_fma_f32 v86, v54, v70, v86
    v_fma_f32 v87, v55, v71, v87
    s_waitcnt lgkmcnt(8)
    v_mfma_f32_16x16x32_bf16 v[224:227], a[200:203], a[128:131], v[224:227]
    ds_read_b64_tr_b16 a[192:193], v12 offset:24640
    ds_read_b64_tr_b16 a[194:195], v12 offset:28736
    v_fma_f32 v94, v54, v78, v94
    v_fma_f32 v95, v55, v79, v95
    v_mfma_f32_16x16x32_bf16 v[228:231], a[200:203], a[132:135], v[228:231]
    v_fma_f32 v86, -v62, v78, v86
    v_fma_f32 v87, -v63, v79, v87
    v_fmac_f32 v94, v62, v70
    v_fmac_f32 v95, v63, v71
    v_mfma_f32_16x16x32_bf16 v[232:235], a[200:203], a[136:139], v[232:235]
    ds_read_b128 v[48:51], v20 offset:512
    ds_read_b128 v[52:55], v20 offset:528
    ds_read_b128 v[56:59], v20 offset:640
    ds_read_b128 v[60:63], v20 offset:656
    v_mfma_f32_16x16x32_bf16 v[236:239], a[200:203], a[140:143], v[236:239]
    v_mov_b32_dpp v64, v80 row_shr:2 row_mask:0xf bank_mask:0xf bound_ctrl:0
    v_mov_b32_dpp v65, v81 row_shr:2 row_mask:0xf bank_mask:0xf bound_ctrl:0
    v_mov_b32_dpp v66, v82 row_shr:2 row_mask:0xf bank_mask:0xf bound_ctrl:0
    v_mov_b32_dpp v67, v83 row_shr:2 row_mask:0xf bank_mask:0xf bound_ctrl:0
    s_waitcnt lgkmcnt(12)
    v_mfma_f32_16x16x32_bf16 v[240:243], a[204:207], a[128:131], v[240:243]
    ds_read_b64_tr_b16 a[196:197], v12 offset:16480
    ds_read_b64_tr_b16 a[198:199], v12 offset:20576
    v_mov_b32_dpp v68, v84 row_shr:2 row_mask:0xf bank_mask:0xf bound_ctrl:0
    v_mov_b32_dpp v69, v85 row_shr:2 row_mask:0xf bank_mask:0xf bound_ctrl:0
    v_mfma_f32_16x16x32_bf16 v[244:247], a[204:207], a[132:135], v[244:247]
    v_mov_b32_dpp v70, v86 row_shr:2 row_mask:0xf bank_mask:0xf bound_ctrl:0
    v_mov_b32_dpp v71, v87 row_shr:2 row_mask:0xf bank_mask:0xf bound_ctrl:0
    v_mov_b32_dpp v72, v88 row_shr:2 row_mask:0xf bank_mask:0xf bound_ctrl:0
    v_mov_b32_dpp v73, v89 row_shr:2 row_mask:0xf bank_mask:0xf bound_ctrl:0
    v_mfma_f32_16x16x32_bf16 v[248:251], a[204:207], a[136:139], v[248:251]
    v_mov_b32_dpp v74, v90 row_shr:2 row_mask:0xf bank_mask:0xf bound_ctrl:0
    v_mov_b32_dpp v75, v91 row_shr:2 row_mask:0xf bank_mask:0xf bound_ctrl:0
    v_mov_b32_dpp v76, v92 row_shr:2 row_mask:0xf bank_mask:0xf bound_ctrl:0
    v_mov_b32_dpp v77, v93 row_shr:2 row_mask:0xf bank_mask:0xf bound_ctrl:0
    v_mfma_f32_16x16x32_bf16 v[252:255], a[204:207], a[140:143], v[252:255]
    v_mov_b32_dpp v78, v94 row_shr:2 row_mask:0xf bank_mask:0xf bound_ctrl:0
    v_mov_b32_dpp v79, v95 row_shr:2 row_mask:0xf bank_mask:0xf bound_ctrl:0
    s_waitcnt lgkmcnt(2)
    v_fma_f32 v80, v48, v64, v80
    s_waitcnt lgkmcnt(12)
    v_mfma_f32_16x16x32_bf16 a[0:3], a[208:211], a[128:131], a[0:3]
    ds_read_b64_tr_b16 a[200:201], v12 offset:24672
    ds_read_b64_tr_b16 a[202:203], v12 offset:28768
    v_fma_f32 v81, v49, v65, v81
    v_fma_f32 v88, v48, v72, v88
    v_mfma_f32_16x16x32_bf16 a[4:7], a[208:211], a[132:135], a[4:7]
    v_fma_f32 v89, v49, v73, v89
    v_fma_f32 v80, -v56, v72, v80
    v_fma_f32 v81, -v57, v73, v81
    v_fmac_f32 v88, v56, v64
    v_mfma_f32_16x16x32_bf16 a[8:11], a[208:211], a[136:139], a[8:11]
    v_fmac_f32 v89, v57, v65
    v_fma_f32 v82, v50, v66, v82
    v_fma_f32 v83, v51, v67, v83
    v_fma_f32 v90, v50, v74, v90
    v_mfma_f32_16x16x32_bf16 a[12:15], a[208:211], a[140:143], a[12:15]
    v_fma_f32 v91, v51, v75, v91
    v_fma_f32 v82, -v58, v74, v82
    v_fma_f32 v83, -v59, v75, v83
    v_fmac_f32 v90, v58, v66
    s_waitcnt lgkmcnt(12)
    v_mfma_f32_16x16x32_bf16 a[16:19], a[212:215], a[128:131], a[16:19]
    ds_read_b64_tr_b16 a[204:205], v12 offset:32832
    ds_read_b64_tr_b16 a[206:207], v12 offset:36928
    v_fmac_f32 v91, v59, v67
    v_fma_f32 v84, v52, v68, v84
    v_mfma_f32_16x16x32_bf16 a[20:23], a[212:215], a[132:135], a[20:23]
    v_fma_f32 v85, v53, v69, v85
    v_fma_f32 v92, v52, v76, v92
    v_fma_f32 v93, v53, v77, v93
    v_fma_f32 v84, -v60, v76, v84
    v_mfma_f32_16x16x32_bf16 a[24:27], a[212:215], a[136:139], a[24:27]
    v_fma_f32 v85, -v61, v77, v85
    v_fmac_f32 v92, v60, v68
    v_fmac_f32 v93, v61, v69
    v_fma_f32 v86, v54, v70, v86
    v_mfma_f32_16x16x32_bf16 a[28:31], a[212:215], a[140:143], a[28:31]
    v_fma_f32 v87, v55, v71, v87
    v_fma_f32 v94, v54, v78, v94
    v_fma_f32 v95, v55, v79, v95
    v_fma_f32 v86, -v62, v78, v86
    s_waitcnt lgkmcnt(12)
    v_mfma_f32_16x16x32_bf16 v[224:227], a[216:219], a[144:147], v[224:227]
    ds_read_b64_tr_b16 a[208:209], v12 offset:41024
    ds_read_b64_tr_b16 a[210:211], v12 offset:45120
    v_fma_f32 v87, -v63, v79, v87
    v_fmac_f32 v94, v62, v70
    v_mfma_f32_16x16x32_bf16 v[228:231], a[216:219], a[148:151], v[228:231]
    v_fmac_f32 v95, v63, v71
    ds_read_b128 v[48:51], v20 offset:768
    ds_read_b128 v[52:55], v20 offset:784
    ds_read_b128 v[56:59], v20 offset:896
    v_mfma_f32_16x16x32_bf16 v[232:235], a[216:219], a[152:155], v[232:235]
    ds_read_b128 v[60:63], v20 offset:912
    v_mov_b32_dpp v64, v80 row_shr:4 row_mask:0xf bank_mask:0xf bound_ctrl:0
    v_mov_b32_dpp v65, v81 row_shr:4 row_mask:0xf bank_mask:0xf bound_ctrl:0
    v_mov_b32_dpp v66, v82 row_shr:4 row_mask:0xf bank_mask:0xf bound_ctrl:0
    v_mfma_f32_16x16x32_bf16 v[236:239], a[216:219], a[156:159], v[236:239]
    v_mov_b32_dpp v67, v83 row_shr:4 row_mask:0xf bank_mask:0xf bound_ctrl:0
    v_mov_b32_dpp v68, v84 row_shr:4 row_mask:0xf bank_mask:0xf bound_ctrl:0
    v_mov_b32_dpp v69, v85 row_shr:4 row_mask:0xf bank_mask:0xf bound_ctrl:0
    v_mov_b32_dpp v70, v86 row_shr:4 row_mask:0xf bank_mask:0xf bound_ctrl:0
    s_waitcnt lgkmcnt(14)
    v_mfma_f32_16x16x32_bf16 v[240:243], a[192:195], a[144:147], v[240:243]
    ds_read_b64_tr_b16 a[212:213], v12 offset:32864
    ds_read_b64_tr_b16 a[214:215], v12 offset:36960
    v_mov_b32_dpp v71, v87 row_shr:4 row_mask:0xf bank_mask:0xf bound_ctrl:0
    v_mov_b32_dpp v72, v88 row_shr:4 row_mask:0xf bank_mask:0xf bound_ctrl:0
    v_mfma_f32_16x16x32_bf16 v[244:247], a[192:195], a[148:151], v[244:247]
    v_mov_b32_dpp v73, v89 row_shr:4 row_mask:0xf bank_mask:0xf bound_ctrl:0
    v_mov_b32_dpp v74, v90 row_shr:4 row_mask:0xf bank_mask:0xf bound_ctrl:0
    v_mov_b32_dpp v75, v91 row_shr:4 row_mask:0xf bank_mask:0xf bound_ctrl:0
    v_mov_b32_dpp v76, v92 row_shr:4 row_mask:0xf bank_mask:0xf bound_ctrl:0
    v_mfma_f32_16x16x32_bf16 v[248:251], a[192:195], a[152:155], v[248:251]
    v_mov_b32_dpp v77, v93 row_shr:4 row_mask:0xf bank_mask:0xf bound_ctrl:0
    v_mov_b32_dpp v78, v94 row_shr:4 row_mask:0xf bank_mask:0xf bound_ctrl:0
    v_mov_b32_dpp v79, v95 row_shr:4 row_mask:0xf bank_mask:0xf bound_ctrl:0
    s_waitcnt lgkmcnt(2)
    v_mfma_f32_16x16x32_bf16 v[252:255], a[192:195], a[156:159], v[252:255]
    v_fma_f32 v80, v48, v64, v80
    v_fma_f32 v81, v49, v65, v81
    v_fma_f32 v88, v48, v72, v88
    v_fma_f32 v89, v49, v73, v89
    s_waitcnt lgkmcnt(12)
    v_mfma_f32_16x16x32_bf16 a[0:3], a[196:199], a[144:147], a[0:3]
    ds_read_b64_tr_b16 a[216:217], v12 offset:41056
    ds_read_b64_tr_b16 a[218:219], v12 offset:45152
    v_fma_f32 v80, -v56, v72, v80
    v_fma_f32 v81, -v57, v73, v81
    v_mfma_f32_16x16x32_bf16 a[4:7], a[196:199], a[148:151], a[4:7]
    v_fmac_f32 v88, v56, v64
    v_fmac_f32 v89, v57, v65
    v_fma_f32 v82, v50, v66, v82
    v_fma_f32 v83, v51, v67, v83
    v_mfma_f32_16x16x32_bf16 a[8:11], a[196:199], a[152:155], a[8:11]
    v_fma_f32 v90, v50, v74, v90
    v_fma_f32 v91, v51, v75, v91
    v_fma_f32 v82, -v58, v74, v82
    v_fma_f32 v83, -v59, v75, v83
    v_mfma_f32_16x16x32_bf16 a[12:15], a[196:199], a[156:159], a[12:15]
    v_fmac_f32 v90, v58, v66
    v_fmac_f32 v91, v59, v67
    v_fma_f32 v84, v52, v68, v84
    v_fma_f32 v85, v53, v69, v85
    s_waitcnt lgkmcnt(12)
    v_mfma_f32_16x16x32_bf16 a[16:19], a[200:203], a[144:147], a[16:19]
    ds_read_b64_tr_b16 a[192:193], v12 offset:49216
    ds_read_b64_tr_b16 a[194:195], v12 offset:53312
    v_fma_f32 v92, v52, v76, v92
    v_fma_f32 v93, v53, v77, v93
    v_mfma_f32_16x16x32_bf16 a[20:23], a[200:203], a[148:151], a[20:23]
    v_fma_f32 v84, -v60, v76, v84
    v_fma_f32 v85, -v61, v77, v85
    v_fmac_f32 v92, v60, v68
    v_fmac_f32 v93, v61, v69
    v_mfma_f32_16x16x32_bf16 a[24:27], a[200:203], a[152:155], a[24:27]
    v_fma_f32 v86, v54, v70, v86
    v_fma_f32 v87, v55, v71, v87
    v_fma_f32 v94, v54, v78, v94
    v_fma_f32 v95, v55, v79, v95
    v_mfma_f32_16x16x32_bf16 a[28:31], a[200:203], a[156:159], a[28:31]
    v_fma_f32 v86, -v62, v78, v86
    v_fma_f32 v87, -v63, v79, v87
    v_fmac_f32 v94, v62, v70
    v_fmac_f32 v95, v63, v71
    s_waitcnt lgkmcnt(12)
    v_mfma_f32_16x16x32_bf16 v[224:227], a[204:207], a[160:163], v[224:227]
    ds_read_b64_tr_b16 a[196:197], v12 offset:57408
    ds_read_b64_tr_b16 a[198:199], v12 offset:61504
    ds_read_b128 v[48:51], v20 offset:1024
    ds_read_b128 v[52:55], v20 offset:1040
    v_mfma_f32_16x16x32_bf16 v[228:231], a[204:207], a[164:167], v[228:231]
    ds_read_b128 v[56:59], v20 offset:1152
    ds_read_b128 v[60:63], v20 offset:1168
    v_mov_b32_dpp v64, v80 row_shr:8 row_mask:0xf bank_mask:0xf bound_ctrl:0
    v_mov_b32_dpp v65, v81 row_shr:8 row_mask:0xf bank_mask:0xf bound_ctrl:0
    v_mfma_f32_16x16x32_bf16 v[232:235], a[204:207], a[168:171], v[232:235]
    v_mov_b32_dpp v66, v82 row_shr:8 row_mask:0xf bank_mask:0xf bound_ctrl:0
    v_mov_b32_dpp v67, v83 row_shr:8 row_mask:0xf bank_mask:0xf bound_ctrl:0
    v_mov_b32_dpp v68, v84 row_shr:8 row_mask:0xf bank_mask:0xf bound_ctrl:0
    v_mov_b32_dpp v69, v85 row_shr:8 row_mask:0xf bank_mask:0xf bound_ctrl:0
    v_mfma_f32_16x16x32_bf16 v[236:239], a[204:207], a[172:175], v[236:239]
    v_mov_b32_dpp v70, v86 row_shr:8 row_mask:0xf bank_mask:0xf bound_ctrl:0
    v_mov_b32_dpp v71, v87 row_shr:8 row_mask:0xf bank_mask:0xf bound_ctrl:0
    v_mov_b32_dpp v72, v88 row_shr:8 row_mask:0xf bank_mask:0xf bound_ctrl:0
    v_mov_b32_dpp v73, v89 row_shr:8 row_mask:0xf bank_mask:0xf bound_ctrl:0
    s_waitcnt lgkmcnt(14)
    v_mfma_f32_16x16x32_bf16 v[240:243], a[208:211], a[160:163], v[240:243]
    ds_read_b64_tr_b16 a[200:201], v12 offset:49248
    ds_read_b64_tr_b16 a[202:203], v12 offset:53344
    v_mov_b32_dpp v74, v90 row_shr:8 row_mask:0xf bank_mask:0xf bound_ctrl:0
    v_mov_b32_dpp v75, v91 row_shr:8 row_mask:0xf bank_mask:0xf bound_ctrl:0
    v_mfma_f32_16x16x32_bf16 v[244:247], a[208:211], a[164:167], v[244:247]
    v_mov_b32_dpp v76, v92 row_shr:8 row_mask:0xf bank_mask:0xf bound_ctrl:0
    v_mov_b32_dpp v77, v93 row_shr:8 row_mask:0xf bank_mask:0xf bound_ctrl:0
    v_mov_b32_dpp v78, v94 row_shr:8 row_mask:0xf bank_mask:0xf bound_ctrl:0
    v_mov_b32_dpp v79, v95 row_shr:8 row_mask:0xf bank_mask:0xf bound_ctrl:0
    v_mfma_f32_16x16x32_bf16 v[248:251], a[208:211], a[168:171], v[248:251]
    s_waitcnt lgkmcnt(2)
    v_fma_f32 v80, v48, v64, v80
    v_fma_f32 v81, v49, v65, v81
    v_fma_f32 v88, v48, v72, v88
    v_mfma_f32_16x16x32_bf16 v[252:255], a[208:211], a[172:175], v[252:255]
    v_fma_f32 v89, v49, v73, v89
    v_fma_f32 v80, -v56, v72, v80
    v_fma_f32 v81, -v57, v73, v81
    v_fmac_f32 v88, v56, v64
    s_waitcnt lgkmcnt(12)
    v_mfma_f32_16x16x32_bf16 a[0:3], a[212:215], a[160:163], a[0:3]
    ds_read_b64_tr_b16 a[204:205], v12 offset:57440
    ds_read_b64_tr_b16 a[206:207], v12 offset:61536
    v_fmac_f32 v89, v57, v65
    v_fma_f32 v82, v50, v66, v82
    v_mfma_f32_16x16x32_bf16 a[4:7], a[212:215], a[164:167], a[4:7]
    v_fma_f32 v83, v51, v67, v83
    v_fma_f32 v90, v50, v74, v90
    v_fma_f32 v91, v51, v75, v91
    v_fma_f32 v82, -v58, v74, v82
    v_mfma_f32_16x16x32_bf16 a[8:11], a[212:215], a[168:171], a[8:11]
    v_fma_f32 v83, -v59, v75, v83
    v_fmac_f32 v90, v58, v66
    v_fmac_f32 v91, v59, v67
    v_fma_f32 v84, v52, v68, v84
    v_mfma_f32_16x16x32_bf16 a[12:15], a[212:215], a[172:175], a[12:15]
    v_fma_f32 v85, v53, v69, v85
    v_fma_f32 v92, v52, v76, v92
    v_fma_f32 v93, v53, v77, v93
    v_fma_f32 v84, -v60, v76, v84
    s_waitcnt lgkmcnt(12)
    v_mfma_f32_16x16x32_bf16 a[16:19], a[216:219], a[160:163], a[16:19]
    ds_read_b64_tr_b16 a[208:209], v12 offset:128
    ds_read_b64_tr_b16 a[210:211], v12 offset:4224
    v_fma_f32 v85, -v61, v77, v85
    v_fmac_f32 v92, v60, v68
    v_mfma_f32_16x16x32_bf16 a[20:23], a[216:219], a[164:167], a[20:23]
    v_fmac_f32 v93, v61, v69
    v_fma_f32 v86, v54, v70, v86
    v_fma_f32 v87, v55, v71, v87
    v_fma_f32 v94, v54, v78, v94
    v_mfma_f32_16x16x32_bf16 a[24:27], a[216:219], a[168:171], a[24:27]
    v_fma_f32 v95, v55, v79, v95
    v_fma_f32 v86, -v62, v78, v86
    v_fma_f32 v87, -v63, v79, v87
    v_fmac_f32 v94, v62, v70
    v_mfma_f32_16x16x32_bf16 a[28:31], a[216:219], a[172:175], a[28:31]
    v_fmac_f32 v95, v63, v71
    s_mov_b64 exec, s[82:83]
    buffer_store_dwordx4 v[80:83], v21, s[20:23], s80 offen offset:0 sc1
    buffer_store_dwordx4 v[84:87], v21, s[20:23], s80 offen offset:16 sc1
    buffer_store_dwordx4 v[88:91], v21, s[20:23], s80 offen offset:32 sc1
    buffer_store_dwordx4 v[92:95], v21, s[20:23], s80 offen offset:48 sc1
    s_mov_b64 exec, -1
    v_mov_b32_dpp v64, v80 row_shr:1 row_mask:0xf bank_mask:0xf bound_ctrl:0
    v_mov_b32_dpp v65, v81 row_shr:1 row_mask:0xf bank_mask:0xf bound_ctrl:0
    s_waitcnt lgkmcnt(12)
    v_mfma_f32_16x16x32_bf16 v[224:227], a[192:195], a[176:179], v[224:227]
    ds_read_b64_tr_b16 a[212:213], v12 offset:8320
    ds_read_b64_tr_b16 a[214:215], v12 offset:12416
    v_mov_b32_dpp v66, v82 row_shr:1 row_mask:0xf bank_mask:0xf bound_ctrl:0
    v_mov_b32_dpp v67, v83 row_shr:1 row_mask:0xf bank_mask:0xf bound_ctrl:0
    v_mfma_f32_16x16x32_bf16 v[228:231], a[192:195], a[180:183], v[228:231]
    v_mov_b32_dpp v68, v84 row_shr:1 row_mask:0xf bank_mask:0xf bound_ctrl:0
    v_mov_b32_dpp v69, v85 row_shr:1 row_mask:0xf bank_mask:0xf bound_ctrl:0
    v_mov_b32_dpp v70, v86 row_shr:1 row_mask:0xf bank_mask:0xf bound_ctrl:0
    v_mov_b32_dpp v71, v87 row_shr:1 row_mask:0xf bank_mask:0xf bound_ctrl:0
    v_mfma_f32_16x16x32_bf16 v[232:235], a[192:195], a[184:187], v[232:235]
    v_mov_b32_dpp v72, v88 row_shr:1 row_mask:0xf bank_mask:0xf bound_ctrl:0
    v_mov_b32_dpp v73, v89 row_shr:1 row_mask:0xf bank_mask:0xf bound_ctrl:0
    v_mov_b32_dpp v74, v90 row_shr:1 row_mask:0xf bank_mask:0xf bound_ctrl:0
    v_mov_b32_dpp v75, v91 row_shr:1 row_mask:0xf bank_mask:0xf bound_ctrl:0
    v_mfma_f32_16x16x32_bf16 v[236:239], a[192:195], a[188:191], v[236:239]
    v_mov_b32_dpp v76, v92 row_shr:1 row_mask:0xf bank_mask:0xf bound_ctrl:0
    v_mov_b32_dpp v77, v93 row_shr:1 row_mask:0xf bank_mask:0xf bound_ctrl:0
    v_mov_b32_dpp v78, v94 row_shr:1 row_mask:0xf bank_mask:0xf bound_ctrl:0
    v_mov_b32_dpp v79, v95 row_shr:1 row_mask:0xf bank_mask:0xf bound_ctrl:0
    s_waitcnt lgkmcnt(12)
    v_mfma_f32_16x16x32_bf16 v[240:243], a[196:199], a[176:179], v[240:243]
    ds_read_b64_tr_b16 a[216:217], v12 offset:160
    ds_read_b64_tr_b16 a[218:219], v12 offset:4256
    s_waitcnt vmcnt(4)
    v_sub_f32 v60, 1.0, v28
    v_mfma_f32_16x16x32_bf16 v[244:247], a[196:199], a[180:183], v[244:247]
    v_sub_f32 v61, 1.0, v29
    v_sub_f32 v62, 1.0, v30
    v_sub_f32 v63, 1.0, v31
    v_cvt_pk_bf16_f32 v60, v60, v61
    v_mfma_f32_16x16x32_bf16 v[248:251], a[196:199], a[184:187], v[248:251]
    v_cvt_pk_bf16_f32 v62, v62, v63
    v_and_b32 v61, 0xffff0000, v60
    v_and_b32 v63, 0xffff0000, v62
    v_lshlrev_b32 v60, 16, v60
    v_mfma_f32_16x16x32_bf16 v[252:255], a[196:199], a[188:191], v[252:255]
    v_lshlrev_b32 v62, 16, v62
    v_lshl_add_u32 v21, v18, 8, v20
    v_max_f32 v80, 0, v160
    v_max_f32 v84, 0, v162
    s_waitcnt lgkmcnt(8)
    v_mfma_f32_16x16x32_bf16 a[0:3], a[200:203], a[176:179], a[0:3]
    ds_read_b64_tr_b16 a[192:193], v12 offset:8352
    ds_read_b64_tr_b16 a[194:195], v12 offset:12448
    v_max_f32 v88, 0, v192
    v_max_f32 v92, 0, v194
    v_mfma_f32_16x16x32_bf16 a[4:7], a[200:203], a[180:183], a[4:7]
    v_max_f32 v81, 0, v161
    v_max_f32 v85, 0, v163
    v_max_f32 v89, 0, v193
    v_max_f32 v93, 0, v195
    v_mfma_f32_16x16x32_bf16 a[8:11], a[200:203], a[184:187], a[8:11]
    v_mul_f32 v80, v80, v176
    v_mul_f32 v84, v84, v178
    v_mul_f32 v88, v88, v208
    v_mul_f32 v92, v92, v210
    v_mfma_f32_16x16x32_bf16 a[12:15], a[200:203], a[188:191], a[12:15]
    v_mul_f32 v81, v81, v177
    v_mul_f32 v85, v85, v179
    v_mul_f32 v89, v89, v209
    v_mul_f32 v93, v93, v211
    s_waitcnt lgkmcnt(8)
    v_mfma_f32_16x16x32_bf16 a[16:19], a[204:207], a[176:179], a[16:19]
    ds_read_b64_tr_b16 a[196:197], v12 offset:16512
    ds_read_b64_tr_b16 a[198:199], v12 offset:20608
    v_mul_f32 v80, v80, v60
    v_mul_f32 v84, v84, v60
    v_mfma_f32_16x16x32_bf16 a[20:23], a[204:207], a[180:183], a[20:23]
    v_mul_f32 v88, v88, v60
    v_mul_f32 v92, v92, v60
    v_mul_f32 v81, v81, v60
    v_mul_f32 v85, v85, v60
    v_mfma_f32_16x16x32_bf16 a[24:27], a[204:207], a[184:187], a[24:27]
    v_mul_f32 v89, v89, v60
    v_mul_f32 v93, v93, v60
    v_cvt_pk_bf16_f32 v52, v80, v81
    v_cvt_pk_bf16_f32 v53, v84, v85
    v_mfma_f32_16x16x32_bf16 a[28:31], a[204:207], a[188:191], a[28:31]
    v_cvt_pk_bf16_f32 v54, v88, v89
    v_cvt_pk_bf16_f32 v55, v92, v93
    s_nop 0
    v_permlane32_swap_b32 v52, v54
    v_permlane32_swap_b32 v53, v55
    s_waitcnt lgkmcnt(8)
    v_mfma_f32_16x16x32_bf16 a[32:35], a[208:211], a[128:131], a[32:35]
    ds_read_b64_tr_b16 a[200:201], v12 offset:24704
    ds_read_b64_tr_b16 a[202:203], v12 offset:28800
    buffer_store_dwordx4 v[52:55], v15, s[20:23], s70 offen offset:0 sc1
    v_max_f32 v80, 0, v164
    v_mfma_f32_16x16x32_bf16 a[36:39], a[208:211], a[132:135], a[36:39]
    v_max_f32 v84, 0, v166
    v_max_f32 v88, 0, v196
    v_max_f32 v92, 0, v198
    v_max_f32 v81, 0, v165
    v_mfma_f32_16x16x32_bf16 a[40:43], a[208:211], a[136:139], a[40:43]
    v_max_f32 v85, 0, v167
    v_max_f32 v89, 0, v197
    v_max_f32 v93, 0, v199
    v_mul_f32 v80, v80, v180
    v_mfma_f32_16x16x32_bf16 a[44:47], a[208:211], a[140:143], a[44:47]
    v_mul_f32 v84, v84, v182
    v_mul_f32 v88, v88, v212
    v_mul_f32 v92, v92, v214
    v_mul_f32 v81, v81, v181
    s_waitcnt lgkmcnt(8)
    v_mfma_f32_16x16x32_bf16 a[48:51], a[212:215], a[128:131], a[48:51]
    ds_read_b64_tr_b16 a[204:205], v12 offset:16544
    ds_read_b64_tr_b16 a[206:207], v12 offset:20640
    v_mul_f32 v85, v85, v183
    v_mul_f32 v89, v89, v213
    v_mfma_f32_16x16x32_bf16 a[52:55], a[212:215], a[132:135], a[52:55]
    v_mul_f32 v93, v93, v215
    v_mul_f32 v80, v80, v61
    v_mul_f32 v84, v84, v61
    v_mul_f32 v88, v88, v61
    v_mfma_f32_16x16x32_bf16 a[56:59], a[212:215], a[136:139], a[56:59]
    v_mul_f32 v92, v92, v61
    v_mul_f32 v81, v81, v61
    v_mul_f32 v85, v85, v61
    v_mul_f32 v89, v89, v61
    v_mfma_f32_16x16x32_bf16 a[60:63], a[212:215], a[140:143], a[60:63]
    v_mul_f32 v93, v93, v61
    v_cvt_pk_bf16_f32 v56, v80, v81
    v_cvt_pk_bf16_f32 v57, v84, v85
    v_cvt_pk_bf16_f32 v58, v88, v89
    s_waitcnt lgkmcnt(8)
    v_mfma_f32_16x16x32_bf16 a[64:67], a[216:219], a[128:131], a[64:67]
    ds_read_b64_tr_b16 a[208:209], v12 offset:24736
    ds_read_b64_tr_b16 a[210:211], v12 offset:28832
    v_cvt_pk_bf16_f32 v59, v92, v93
    v_permlane32_swap_b32 v56, v58
    v_mfma_f32_16x16x32_bf16 a[68:71], a[216:219], a[132:135], a[68:71]
    v_permlane32_swap_b32 v57, v59
    buffer_store_dwordx4 v[56:59], v15, s[20:23], s70 offen offset:1024 sc1
    v_max_f32 v80, 0, v168
    v_max_f32 v84, 0, v170
    v_mfma_f32_16x16x32_bf16 a[72:75], a[216:219], a[136:139], a[72:75]
    v_max_f32 v88, 0, v200
    v_max_f32 v92, 0, v202
    v_max_f32 v81, 0, v169
    v_max_f32 v85, 0, v171
    v_mfma_f32_16x16x32_bf16 a[76:79], a[216:219], a[140:143], a[76:79]
    v_max_f32 v89, 0, v201
    v_max_f32 v93, 0, v203
    v_mul_f32 v80, v80, v184
    v_mul_f32 v84, v84, v186
    s_waitcnt lgkmcnt(8)
    v_mfma_f32_16x16x32_bf16 a[80:83], a[192:195], a[128:131], a[80:83]
    ds_read_b64_tr_b16 a[212:213], v12 offset:32896
    ds_read_b64_tr_b16 a[214:215], v12 offset:36992
    v_mul_f32 v88, v88, v216
    v_mul_f32 v92, v92, v218
    v_mfma_f32_16x16x32_bf16 a[84:87], a[192:195], a[132:135], a[84:87]
    v_mul_f32 v81, v81, v185
    v_mul_f32 v85, v85, v187
    v_mul_f32 v89, v89, v217
    v_mul_f32 v93, v93, v219
    v_mfma_f32_16x16x32_bf16 a[88:91], a[192:195], a[136:139], a[88:91]
    v_mul_f32 v80, v80, v62
    v_mul_f32 v84, v84, v62
    v_mul_f32 v88, v88, v62
    v_mul_f32 v92, v92, v62
    v_mfma_f32_16x16x32_bf16 a[92:95], a[192:195], a[140:143], a[92:95]
    v_mul_f32 v81, v81, v62
    v_mul_f32 v85, v85, v62
    v_mul_f32 v89, v89, v62
    v_mul_f32 v93, v93, v62
    s_waitcnt lgkmcnt(8)
    v_mfma_f32_16x16x32_bf16 a[32:35], a[196:199], a[144:147], a[32:35]
    ds_read_b64_tr_b16 a[216:217], v12 offset:41088
    ds_read_b64_tr_b16 a[218:219], v12 offset:45184
    v_cvt_pk_bf16_f32 v48, v80, v81
    v_cvt_pk_bf16_f32 v49, v84, v85
    v_mfma_f32_16x16x32_bf16 a[36:39], a[196:199], a[148:151], a[36:39]
    v_cvt_pk_bf16_f32 v50, v88, v89
    v_cvt_pk_bf16_f32 v51, v92, v93
    s_nop 0
    v_permlane32_swap_b32 v48, v50
    v_permlane32_swap_b32 v49, v51
    v_mfma_f32_16x16x32_bf16 a[40:43], a[196:199], a[152:155], a[40:43]
    buffer_store_dwordx4 v[48:51], v15, s[20:23], s70 offen offset:2048 sc1
    v_max_f32 v80, 0, v172
    v_max_f32 v84, 0, v174
    v_max_f32 v88, 0, v204
    v_mfma_f32_16x16x32_bf16 a[44:47], a[196:199], a[156:159], a[44:47]
    v_max_f32 v92, 0, v206
    v_max_f32 v81, 0, v173
    v_max_f32 v85, 0, v175
    v_max_f32 v89, 0, v205
    s_waitcnt lgkmcnt(8)
    v_mfma_f32_16x16x32_bf16 a[48:51], a[200:203], a[144:147], a[48:51]
    ds_read_b64_tr_b16 a[192:193], v12 offset:32928
    ds_read_b64_tr_b16 a[194:195], v12 offset:37024
    v_max_f32 v93, 0, v207
    v_mul_f32 v80, v80, v188
    v_mfma_f32_16x16x32_bf16 a[52:55], a[200:203], a[148:151], a[52:55]
    v_mul_f32 v84, v84, v190
    v_mul_f32 v88, v88, v220
    v_mul_f32 v92, v92, v222
    v_mul_f32 v81, v81, v189
    v_mfma_f32_16x16x32_bf16 a[56:59], a[200:203], a[152:155], a[56:59]
    v_mul_f32 v85, v85, v191
    v_mul_f32 v89, v89, v221
    v_mul_f32 v93, v93, v223
    v_mul_f32 v80, v80, v63
    v_mfma_f32_16x16x32_bf16 a[60:63], a[200:203], a[156:159], a[60:63]
    v_mul_f32 v84, v84, v63
    v_mul_f32 v88, v88, v63
    v_mul_f32 v92, v92, v63
    v_mul_f32 v81, v81, v63
    s_waitcnt lgkmcnt(8)
    v_mfma_f32_16x16x32_bf16 a[64:67], a[204:207], a[144:147], a[64:67]
    ds_read_b64_tr_b16 a[196:197], v12 offset:41120
    ds_read_b64_tr_b16 a[198:199], v12 offset:45216
    v_mul_f32 v85, v85, v63
    v_mul_f32 v89, v89, v63
    v_mfma_f32_16x16x32_bf16 a[68:71], a[204:207], a[148:151], a[68:71]
    v_mul_f32 v93, v93, v63
    v_cvt_pk_bf16_f32 v52, v80, v81
    v_cvt_pk_bf16_f32 v53, v84, v85
    v_cvt_pk_bf16_f32 v54, v88, v89
    v_mfma_f32_16x16x32_bf16 a[72:75], a[204:207], a[152:155], a[72:75]
    v_cvt_pk_bf16_f32 v55, v92, v93
    v_permlane32_swap_b32 v52, v54
    s_nop 0
    v_permlane32_swap_b32 v53, v55
    buffer_store_dwordx4 v[52:55], v15, s[20:23], s70 offen offset:3072 sc1
    v_mfma_f32_16x16x32_bf16 a[76:79], a[204:207], a[156:159], a[76:79]
    v_accvgpr_read_b32 v88, a0
    v_accvgpr_read_b32 v92, a2
    v_accvgpr_read_b32 v89, a1
    v_accvgpr_read_b32 v93, a3
    s_waitcnt lgkmcnt(8)
    v_mfma_f32_16x16x32_bf16 a[80:83], a[208:211], a[144:147], a[80:83]
    ds_read_b64_tr_b16 a[200:201], v12 offset:49280
    ds_read_b64_tr_b16 a[202:203], v12 offset:53376
    v_accvgpr_read_b32 v90, a16
    v_accvgpr_read_b32 v94, a18
    v_mfma_f32_16x16x32_bf16 a[84:87], a[208:211], a[148:151], a[84:87]
    v_accvgpr_read_b32 v91, a17
    v_accvgpr_read_b32 v95, a19
    v_max_f32 v80, 0, v224
    v_max_f32 v84, 0, v226
    v_mfma_f32_16x16x32_bf16 a[88:91], a[208:211], a[152:155], a[88:91]
    v_max_f32 v88, 0, v88
    v_max_f32 v92, 0, v92
    v_max_f32 v81, 0, v225
    v_max_f32 v85, 0, v227
    v_mfma_f32_16x16x32_bf16 a[92:95], a[208:211], a[156:159], a[92:95]
    v_max_f32 v89, 0, v89
    v_max_f32 v93, 0, v93
    v_mul_f32 v80, v80, v240
    v_mul_f32 v84, v84, v242
    s_waitcnt lgkmcnt(8)
    v_mfma_f32_16x16x32_bf16 a[32:35], a[212:215], a[160:163], a[32:35]
    ds_read_b64_tr_b16 a[204:205], v12 offset:57472
    ds_read_b64_tr_b16 a[206:207], v12 offset:61568
    v_mul_f32 v88, v88, v90
    v_mul_f32 v92, v92, v94
    v_mfma_f32_16x16x32_bf16 a[36:39], a[212:215], a[164:167], a[36:39]
    v_mul_f32 v81, v81, v241
    v_mul_f32 v85, v85, v243
    v_mul_f32 v89, v89, v91
    v_mul_f32 v93, v93, v95
    v_mfma_f32_16x16x32_bf16 a[40:43], a[212:215], a[168:171], a[40:43]
    v_mul_f32 v80, v80, v60
    v_mul_f32 v84, v84, v60
    v_mul_f32 v88, v88, v60
    v_mul_f32 v92, v92, v60
    v_mfma_f32_16x16x32_bf16 a[44:47], a[212:215], a[172:175], a[44:47]
    v_mul_f32 v81, v81, v60
    v_mul_f32 v85, v85, v60
    v_mul_f32 v89, v89, v60
    v_mul_f32 v93, v93, v60
    s_waitcnt lgkmcnt(8)
    v_mfma_f32_16x16x32_bf16 a[48:51], a[216:219], a[160:163], a[48:51]
    ds_read_b64_tr_b16 a[208:209], v12 offset:49312
    ds_read_b64_tr_b16 a[210:211], v12 offset:53408
    v_cvt_pk_bf16_f32 v56, v80, v81
    v_cvt_pk_bf16_f32 v57, v84, v85
    v_mfma_f32_16x16x32_bf16 a[52:55], a[216:219], a[164:167], a[52:55]
    v_cvt_pk_bf16_f32 v58, v88, v89
    v_cvt_pk_bf16_f32 v59, v92, v93
    s_nop 0
    v_permlane32_swap_b32 v56, v58
    v_permlane32_swap_b32 v57, v59
    v_mfma_f32_16x16x32_bf16 a[56:59], a[216:219], a[168:171], a[56:59]
    buffer_store_dwordx4 v[56:59], v15, s[20:23], s71 offen offset:0 sc1
    v_accvgpr_read_b32 v88, a4
    v_accvgpr_read_b32 v92, a6
    v_accvgpr_read_b32 v89, a5
    v_mfma_f32_16x16x32_bf16 a[60:63], a[216:219], a[172:175], a[60:63]
    v_accvgpr_read_b32 v93, a7
    v_accvgpr_read_b32 v90, a20
    v_accvgpr_read_b32 v94, a22
    v_accvgpr_read_b32 v91, a21
    s_waitcnt lgkmcnt(8)
    v_mfma_f32_16x16x32_bf16 a[64:67], a[192:195], a[160:163], a[64:67]
    ds_read_b64_tr_b16 a[212:213], v12 offset:57504
    ds_read_b64_tr_b16 a[214:215], v12 offset:61600
    v_accvgpr_read_b32 v95, a23
    v_max_f32 v80, 0, v228
    v_mfma_f32_16x16x32_bf16 a[68:71], a[192:195], a[164:167], a[68:71]
    v_max_f32 v84, 0, v230
    v_max_f32 v88, 0, v88
    v_max_f32 v92, 0, v92
    v_max_f32 v81, 0, v229
    v_mfma_f32_16x16x32_bf16 a[72:75], a[192:195], a[168:171], a[72:75]
    v_max_f32 v85, 0, v231
    v_max_f32 v89, 0, v89
    v_max_f32 v93, 0, v93
    v_mul_f32 v80, v80, v244
    v_mfma_f32_16x16x32_bf16 a[76:79], a[192:195], a[172:175], a[76:79]
    v_mul_f32 v84, v84, v246
    v_mul_f32 v88, v88, v90
    v_mul_f32 v92, v92, v94
    v_mul_f32 v81, v81, v245
    s_waitcnt lgkmcnt(8)
    v_mfma_f32_16x16x32_bf16 a[80:83], a[196:199], a[160:163], a[80:83]
    ds_read_b64_tr_b16 a[216:217], v12 offset:192
    ds_read_b64_tr_b16 a[218:219], v12 offset:4288
    v_mul_f32 v85, v85, v247
    v_mul_f32 v89, v89, v91
    v_mfma_f32_16x16x32_bf16 a[84:87], a[196:199], a[164:167], a[84:87]
    v_mul_f32 v93, v93, v95
    v_mul_f32 v80, v80, v61
    v_mul_f32 v84, v84, v61
    v_mul_f32 v88, v88, v61
    v_mfma_f32_16x16x32_bf16 a[88:91], a[196:199], a[168:171], a[88:91]
    v_mul_f32 v92, v92, v61
    v_mul_f32 v81, v81, v61
    v_mul_f32 v85, v85, v61
    v_mul_f32 v89, v89, v61
    v_mfma_f32_16x16x32_bf16 a[92:95], a[196:199], a[172:175], a[92:95]
    v_mul_f32 v93, v93, v61
    v_cvt_pk_bf16_f32 v48, v80, v81
    v_cvt_pk_bf16_f32 v49, v84, v85
    v_cvt_pk_bf16_f32 v50, v88, v89
    s_waitcnt lgkmcnt(8)
    v_mfma_f32_16x16x32_bf16 a[32:35], a[200:203], a[176:179], a[32:35]
    ds_read_b64_tr_b16 a[192:193], v12 offset:8384
    ds_read_b64_tr_b16 a[194:195], v12 offset:12480
    v_cvt_pk_bf16_f32 v51, v92, v93
    v_permlane32_swap_b32 v48, v50
    v_mfma_f32_16x16x32_bf16 a[36:39], a[200:203], a[180:183], a[36:39]
    v_permlane32_swap_b32 v49, v51
    buffer_store_dwordx4 v[48:51], v15, s[20:23], s71 offen offset:1024 sc1
    v_accvgpr_read_b32 v88, a8
    v_accvgpr_read_b32 v92, a10
    v_mfma_f32_16x16x32_bf16 a[40:43], a[200:203], a[184:187], a[40:43]
    v_accvgpr_read_b32 v89, a9
    v_accvgpr_read_b32 v93, a11
    v_accvgpr_read_b32 v90, a24
    v_accvgpr_read_b32 v94, a26
    v_mfma_f32_16x16x32_bf16 a[44:47], a[200:203], a[188:191], a[44:47]
    v_accvgpr_read_b32 v91, a25
    v_accvgpr_read_b32 v95, a27
    v_max_f32 v80, 0, v232
    v_max_f32 v84, 0, v234
    s_waitcnt lgkmcnt(8)
    v_mfma_f32_16x16x32_bf16 a[48:51], a[204:207], a[176:179], a[48:51]
    ds_read_b64_tr_b16 a[196:197], v12 offset:16576
    ds_read_b64_tr_b16 a[198:199], v12 offset:20672
    v_max_f32 v88, 0, v88
    v_max_f32 v92, 0, v92
    v_mfma_f32_16x16x32_bf16 a[52:55], a[204:207], a[180:183], a[52:55]
    v_max_f32 v81, 0, v233
    v_max_f32 v85, 0, v235
    v_max_f32 v89, 0, v89
    v_max_f32 v93, 0, v93
    v_mfma_f32_16x16x32_bf16 a[56:59], a[204:207], a[184:187], a[56:59]
    v_mul_f32 v80, v80, v248
    v_mul_f32 v84, v84, v250
    v_mul_f32 v88, v88, v90
    v_mul_f32 v92, v92, v94
    v_mfma_f32_16x16x32_bf16 a[60:63], a[204:207], a[188:191], a[60:63]
    v_mul_f32 v81, v81, v249
    v_mul_f32 v85, v85, v251
    v_mul_f32 v89, v89, v91
    v_mul_f32 v93, v93, v95
    s_waitcnt lgkmcnt(8)
    v_mfma_f32_16x16x32_bf16 a[64:67], a[208:211], a[176:179], a[64:67]
    ds_read_b64_tr_b16 a[200:201], v12 offset:24768
    ds_read_b64_tr_b16 a[202:203], v12 offset:28864
    v_mul_f32 v80, v80, v62
    v_mul_f32 v84, v84, v62
    v_mfma_f32_16x16x32_bf16 a[68:71], a[208:211], a[180:183], a[68:71]
    v_mul_f32 v88, v88, v62
    v_mul_f32 v92, v92, v62
    v_mul_f32 v81, v81, v62
    v_mul_f32 v85, v85, v62
    v_mfma_f32_16x16x32_bf16 a[72:75], a[208:211], a[184:187], a[72:75]
    v_mul_f32 v89, v89, v62
    v_mul_f32 v93, v93, v62
    v_cvt_pk_bf16_f32 v52, v80, v81
    v_cvt_pk_bf16_f32 v53, v84, v85
    v_mfma_f32_16x16x32_bf16 a[76:79], a[208:211], a[188:191], a[76:79]
    v_cvt_pk_bf16_f32 v54, v88, v89
    v_cvt_pk_bf16_f32 v55, v92, v93
    s_nop 0
    v_permlane32_swap_b32 v52, v54
    v_permlane32_swap_b32 v53, v55
    s_waitcnt lgkmcnt(8)
    v_mfma_f32_16x16x32_bf16 a[80:83], a[212:215], a[176:179], a[80:83]
    ds_read_b64_tr_b16 a[204:205], v12 offset:32960
    ds_read_b64_tr_b16 a[206:207], v12 offset:37056
    buffer_store_dwordx4 v[52:55], v15, s[20:23], s71 offen offset:2048 sc1
    v_accvgpr_read_b32 v88, a12
    v_mfma_f32_16x16x32_bf16 a[84:87], a[212:215], a[180:183], a[84:87]
    v_accvgpr_read_b32 v92, a14
    v_accvgpr_read_b32 v89, a13
    v_accvgpr_read_b32 v93, a15
    v_accvgpr_read_b32 v90, a28
    v_mfma_f32_16x16x32_bf16 a[88:91], a[212:215], a[184:187], a[88:91]
    v_accvgpr_read_b32 v94, a30
    v_accvgpr_read_b32 v91, a29
    v_accvgpr_read_b32 v95, a31
    v_max_f32 v80, 0, v236
    v_mfma_f32_16x16x32_bf16 a[92:95], a[212:215], a[188:191], a[92:95]
    v_max_f32 v84, 0, v238
    v_max_f32 v88, 0, v88
    v_max_f32 v92, 0, v92
    v_max_f32 v81, 0, v237
    s_waitcnt lgkmcnt(8)
    v_mfma_f32_16x16x32_bf16 a[96:99], a[216:219], a[128:131], a[96:99]
    ds_read_b64_tr_b16 a[208:209], v12 offset:41152
    ds_read_b64_tr_b16 a[210:211], v12 offset:45248
    v_max_f32 v85, 0, v239
    v_max_f32 v89, 0, v89
    v_mfma_f32_16x16x32_bf16 a[100:103], a[216:219], a[132:135], a[100:103]
    v_max_f32 v93, 0, v93
    v_mul_f32 v80, v80, v252
    v_mul_f32 v84, v84, v254
    v_mul_f32 v88, v88, v90
    v_mfma_f32_16x16x32_bf16 a[104:107], a[216:219], a[136:139], a[104:107]
    v_mul_f32 v92, v92, v94
    v_mul_f32 v81, v81, v253
    v_mul_f32 v85, v85, v255
    v_mul_f32 v89, v89, v91
    v_mfma_f32_16x16x32_bf16 a[108:111], a[216:219], a[140:143], a[108:111]
    v_mul_f32 v93, v93, v95
    v_mul_f32 v80, v80, v63
    v_mul_f32 v84, v84, v63
    v_mul_f32 v88, v88, v63
    s_waitcnt lgkmcnt(8)
    v_mfma_f32_16x16x32_bf16 a[112:115], a[192:195], a[128:131], a[112:115]
    ds_read_b64_tr_b16 a[212:213], v12 offset:49344
    ds_read_b64_tr_b16 a[214:215], v12 offset:53440
    v_mul_f32 v92, v92, v63
    v_mul_f32 v81, v81, v63
    v_mfma_f32_16x16x32_bf16 a[116:119], a[192:195], a[132:135], a[116:119]
    v_mul_f32 v85, v85, v63
    v_mul_f32 v89, v89, v63
    v_mul_f32 v93, v93, v63
    v_cvt_pk_bf16_f32 v56, v80, v81
    v_mfma_f32_16x16x32_bf16 a[120:123], a[192:195], a[136:139], a[120:123]
    v_cvt_pk_bf16_f32 v57, v84, v85
    v_cvt_pk_bf16_f32 v58, v88, v89
    v_cvt_pk_bf16_f32 v59, v92, v93
    s_nop 0
    v_permlane32_swap_b32 v56, v58
    v_mfma_f32_16x16x32_bf16 a[124:127], a[192:195], a[140:143], a[124:127]
    v_permlane32_swap_b32 v57, v59
    buffer_store_dwordx4 v[56:59], v15, s[20:23], s71 offen offset:3072 sc1
    buffer_load_dwordx4 v[160:163], v22, s[20:23], s79 offen offset:0 sc1
    buffer_load_dwordx4 v[164:167], v22, s[20:23], s79 offen offset:16 sc1
    s_waitcnt lgkmcnt(8)
    v_mfma_f32_16x16x32_bf16 a[96:99], a[196:199], a[144:147], a[96:99]
    ds_read_b64_tr_b16 a[216:217], v12 offset:57536
    ds_read_b64_tr_b16 a[218:219], v12 offset:61632
    buffer_load_dwordx4 v[168:171], v22, s[20:23], s79 offen offset:32 sc1
    buffer_load_dwordx4 v[172:175], v22, s[20:23], s79 offen offset:48 sc1
    v_mfma_f32_16x16x32_bf16 a[100:103], a[196:199], a[148:151], a[100:103]
    buffer_load_dwordx4 v[176:179], v23, s[20:23], s79 offen offset:0 sc1
    buffer_load_dwordx4 v[180:183], v23, s[20:23], s79 offen offset:16 sc1
    buffer_load_dwordx4 v[184:187], v23, s[20:23], s79 offen offset:32 sc1
    buffer_load_dwordx4 v[188:191], v23, s[20:23], s79 offen offset:48 sc1
    v_mfma_f32_16x16x32_bf16 a[104:107], a[196:199], a[152:155], a[104:107]
    ds_read_b128 v[192:195], v21 offset:6144
    ds_read_b128 v[196:199], v21 offset:6160
    ds_read_b128 v[200:203], v21 offset:6272
    ds_read_b128 v[204:207], v21 offset:6288
    v_mfma_f32_16x16x32_bf16 a[108:111], a[196:199], a[156:159], a[108:111]
    ds_read_b128 v[208:211], v21 offset:10240
    ds_read_b128 v[212:215], v21 offset:10256
    ds_read_b128 v[216:219], v21 offset:10368
    ds_read_b128 v[220:223], v21 offset:10384
    s_waitcnt lgkmcnt(14)
    v_mfma_f32_16x16x32_bf16 a[112:115], a[200:203], a[144:147], a[112:115]
    v_accvgpr_read_b32 v80, a32
    v_accvgpr_read_b32 v84, a34
    v_accvgpr_read_b32 v88, a64
    v_accvgpr_read_b32 v92, a66
    v_mfma_f32_16x16x32_bf16 a[116:119], a[200:203], a[148:151], a[116:119]
    v_accvgpr_read_b32 v81, a33
    v_accvgpr_read_b32 v85, a35
    v_accvgpr_read_b32 v89, a65
    v_mfma_f32_16x16x32_bf16 a[120:123], a[200:203], a[152:155], a[120:123]
    v_accvgpr_read_b32 v93, a67
    v_accvgpr_read_b32 v82, a48
    v_accvgpr_read_b32 v86, a50
    v_accvgpr_read_b32 v90, a80
    v_mfma_f32_16x16x32_bf16 a[124:127], a[200:203], a[156:159], a[124:127]
    v_accvgpr_read_b32 v94, a82
    v_accvgpr_read_b32 v83, a49
    v_accvgpr_read_b32 v87, a51
    s_waitcnt lgkmcnt(14)
    v_mfma_f32_16x16x32_bf16 a[96:99], a[204:207], a[160:163], a[96:99]
    v_accvgpr_read_b32 v91, a81
    v_accvgpr_read_b32 v95, a83
    v_max_f32 v80, 0, v80
    v_max_f32 v84, 0, v84
    v_mfma_f32_16x16x32_bf16 a[100:103], a[204:207], a[164:167], a[100:103]
    v_max_f32 v88, 0, v88
    v_max_f32 v92, 0, v92
    v_max_f32 v81, 0, v81
    v_mfma_f32_16x16x32_bf16 a[104:107], a[204:207], a[168:171], a[104:107]
    v_max_f32 v85, 0, v85
    v_max_f32 v89, 0, v89
    v_max_f32 v93, 0, v93
    v_pk_mul_f32 v[80:81], v[80:81], v[82:83]
    s_nop 0
    v_mfma_f32_16x16x32_bf16 a[108:111], a[204:207], a[172:175], a[108:111]
    v_pk_mul_f32 v[84:85], v[84:85], v[86:87]
    v_pk_mul_f32 v[88:89], v[88:89], v[90:91]
    v_pk_mul_f32 v[92:93], v[92:93], v[94:95]
    s_waitcnt lgkmcnt(12)
    v_mfma_f32_16x16x32_bf16 a[112:115], a[208:211], a[160:163], a[112:115]
    v_pk_mul_f32 v[80:81], v[80:81], v[60:61] op_sel:[0,0] op_sel_hi:[1,0]
    v_pk_mul_f32 v[84:85], v[84:85], v[60:61] op_sel:[0,0] op_sel_hi:[1,0]
    v_pk_mul_f32 v[88:89], v[88:89], v[60:61] op_sel:[0,0] op_sel_hi:[1,0]
    v_pk_mul_f32 v[92:93], v[92:93], v[60:61] op_sel:[0,0] op_sel_hi:[1,0]
    s_nop 0
    v_mfma_f32_16x16x32_bf16 a[116:119], a[208:211], a[164:167], a[116:119]
    v_cvt_pk_bf16_f32 v48, v80, v81
    v_cvt_pk_bf16_f32 v49, v84, v85
    v_cvt_pk_bf16_f32 v50, v88, v89
    v_mfma_f32_16x16x32_bf16 a[120:123], a[208:211], a[168:171], a[120:123]
    v_cvt_pk_bf16_f32 v51, v92, v93
    v_permlane32_swap_b32 v48, v50
    s_nop 0
    v_permlane32_swap_b32 v49, v51
    buffer_store_dwordx4 v[48:51], v15, s[20:23], s72 offen offset:0 sc1
    v_mfma_f32_16x16x32_bf16 a[124:127], a[208:211], a[172:175], a[124:127]
    v_accvgpr_read_b32 v80, a36
    v_accvgpr_read_b32 v84, a38
    v_accvgpr_read_b32 v88, a68
    s_waitcnt lgkmcnt(10)
    v_mfma_f32_16x16x32_bf16 a[96:99], a[212:215], a[176:179], a[96:99]
    v_accvgpr_read_b32 v92, a70
    v_accvgpr_read_b32 v81, a37
    v_accvgpr_read_b32 v85, a39
    v_accvgpr_read_b32 v89, a69
    v_mfma_f32_16x16x32_bf16 a[100:103], a[212:215], a[180:183], a[100:103]
    v_accvgpr_read_b32 v93, a71
    v_accvgpr_read_b32 v82, a52
    v_accvgpr_read_b32 v86, a54
    v_mfma_f32_16x16x32_bf16 a[104:107], a[212:215], a[184:187], a[104:107]
    v_accvgpr_read_b32 v90, a84
    v_accvgpr_read_b32 v94, a86
    v_accvgpr_read_b32 v83, a53
    v_accvgpr_read_b32 v87, a55
    v_mfma_f32_16x16x32_bf16 a[108:111], a[212:215], a[188:191], a[108:111]
    v_accvgpr_read_b32 v91, a85
    v_accvgpr_read_b32 v95, a87
    v_max_f32 v80, 0, v80
    s_waitcnt lgkmcnt(8)
    v_mfma_f32_16x16x32_bf16 a[112:115], a[216:219], a[176:179], a[112:115]
    v_max_f32 v84, 0, v84
    v_max_f32 v88, 0, v88
    v_max_f32 v92, 0, v92
    v_max_f32 v81, 0, v81
    v_mfma_f32_16x16x32_bf16 a[116:119], a[216:219], a[180:183], a[116:119]
    v_max_f32 v85, 0, v85
    v_max_f32 v89, 0, v89
    v_max_f32 v93, 0, v93
    v_mfma_f32_16x16x32_bf16 a[120:123], a[216:219], a[184:187], a[120:123]
    v_pk_mul_f32 v[80:81], v[80:81], v[82:83]
    v_pk_mul_f32 v[84:85], v[84:85], v[86:87]
    v_pk_mul_f32 v[88:89], v[88:89], v[90:91]
    v_pk_mul_f32 v[92:93], v[92:93], v[94:95]
    s_nop 0
    v_mfma_f32_16x16x32_bf16 a[124:127], a[216:219], a[188:191], a[124:127]
    v_pk_mul_f32 v[80:81], v[80:81], v[60:61] op_sel:[0,1] op_sel_hi:[1,1]
    v_pk_mul_f32 v[84:85], v[84:85], v[60:61] op_sel:[0,1] op_sel_hi:[1,1]
    v_pk_mul_f32 v[88:89], v[88:89], v[60:61] op_sel:[0,1] op_sel_hi:[1,1]
    s_getpc_b64 s[84:85]
CT3:
    s_add_u32 s84, s84, CP_c-CT3
    s_addc_u32 s85, s85, 0
    v_lshlrev_b32 v9, 7, v0
    v_min_u32 v9, CP_end-CP_c-4, v9
    global_load_dword a255, v9, s[84:85]
    v_pk_mul_f32 v[92:93], v[92:93], v[60:61] op_sel:[0,1] op_sel_hi:[1,1]
    v_cvt_pk_bf16_f32 v52, v80, v81
    v_cvt_pk_bf16_f32 v53, v84, v85
    v_cvt_pk_bf16_f32 v54, v88, v89
    v_cvt_pk_bf16_f32 v55, v92, v93
    s_nop 0
    v_permlane32_swap_b32 v52, v54
    v_permlane32_swap_b32 v53, v55
    buffer_store_dwordx4 v[52:55], v15, s[20:23], s72 offen offset:1024 sc1
    v_accvgpr_read_b32 v80, a40
    v_accvgpr_read_b32 v84, a42
    v_accvgpr_read_b32 v88, a72
    v_accvgpr_read_b32 v92, a74
    v_accvgpr_read_b32 v81, a41
    v_accvgpr_read_b32 v85, a43
    v_accvgpr_read_b32 v89, a73
    v_accvgpr_read_b32 v93, a75
    v_accvgpr_read_b32 v82, a56
    v_accvgpr_read_b32 v86, a58
    v_accvgpr_read_b32 v90, a88
    v_accvgpr_read_b32 v94, a90
    v_accvgpr_read_b32 v83, a57
    v_accvgpr_read_b32 v87, a59
    v_accvgpr_read_b32 v91, a89
    v_accvgpr_read_b32 v95, a91
    v_max_f32 v80, 0, v80
    v_max_f32 v84, 0, v84
    v_max_f32 v88, 0, v88
    v_max_f32 v92, 0, v92
    v_max_f32 v81, 0, v81
    v_max_f32 v85, 0, v85
    v_max_f32 v89, 0, v89
    v_max_f32 v93, 0, v93
    v_pk_mul_f32 v[80:81], v[80:81], v[82:83]
    v_pk_mul_f32 v[84:85], v[84:85], v[86:87]
    v_pk_mul_f32 v[88:89], v[88:89], v[90:91]
    v_pk_mul_f32 v[92:93], v[92:93], v[94:95]
    v_pk_mul_f32 v[80:81], v[80:81], v[62:63] op_sel:[0,0] op_sel_hi:[1,0]
    v_pk_mul_f32 v[84:85], v[84:85], v[62:63] op_sel:[0,0] op_sel_hi:[1,0]
    v_pk_mul_f32 v[88:89], v[88:89], v[62:63] op_sel:[0,0] op_sel_hi:[1,0]
    v_pk_mul_f32 v[92:93], v[92:93], v[62:63] op_sel:[0,0] op_sel_hi:[1,0]
    v_cvt_pk_bf16_f32 v56, v80, v81
    v_cvt_pk_bf16_f32 v57, v84, v85
    v_cvt_pk_bf16_f32 v58, v88, v89
    v_cvt_pk_bf16_f32 v59, v92, v93
    s_nop 0
    v_permlane32_swap_b32 v56, v58
    v_permlane32_swap_b32 v57, v59
    buffer_store_dwordx4 v[56:59], v15, s[20:23], s72 offen offset:2048 sc1
    v_accvgpr_read_b32 v80, a44
    v_accvgpr_read_b32 v84, a46
    v_accvgpr_read_b32 v88, a76
    v_accvgpr_read_b32 v92, a78
    v_accvgpr_read_b32 v81, a45
    v_accvgpr_read_b32 v85, a47
    v_accvgpr_read_b32 v89, a77
    v_accvgpr_read_b32 v93, a79
    v_accvgpr_read_b32 v82, a60
    v_accvgpr_read_b32 v86, a62
    v_accvgpr_read_b32 v90, a92
    v_accvgpr_read_b32 v94, a94
    v_accvgpr_read_b32 v83, a61
    v_accvgpr_read_b32 v87, a63
    v_accvgpr_read_b32 v91, a93
    v_accvgpr_read_b32 v95, a95
    v_max_f32 v80, 0, v80
    v_max_f32 v84, 0, v84
    v_max_f32 v88, 0, v88
    v_max_f32 v92, 0, v92
    v_max_f32 v81, 0, v81
    v_max_f32 v85, 0, v85
    v_max_f32 v89, 0, v89
    v_max_f32 v93, 0, v93
    v_pk_mul_f32 v[80:81], v[80:81], v[82:83]
    v_pk_mul_f32 v[84:85], v[84:85], v[86:87]
    v_pk_mul_f32 v[88:89], v[88:89], v[90:91]
    v_pk_mul_f32 v[92:93], v[92:93], v[94:95]
    v_pk_mul_f32 v[80:81], v[80:81], v[62:63] op_sel:[0,1] op_sel_hi:[1,1]
    v_pk_mul_f32 v[84:85], v[84:85], v[62:63] op_sel:[0,1] op_sel_hi:[1,1]
    v_pk_mul_f32 v[88:89], v[88:89], v[62:63] op_sel:[0,1] op_sel_hi:[1,1]
    v_pk_mul_f32 v[92:93], v[92:93], v[62:63] op_sel:[0,1] op_sel_hi:[1,1]
    v_cvt_pk_bf16_f32 v48, v80, v81
    v_cvt_pk_bf16_f32 v49, v84, v85
    v_cvt_pk_bf16_f32 v50, v88, v89
    v_cvt_pk_bf16_f32 v51, v92, v93
    s_nop 0
    v_permlane32_swap_b32 v48, v50
    v_permlane32_swap_b32 v49, v51
    buffer_store_dwordx4 v[48:51], v15, s[20:23], s72 offen offset:3072 sc1
    v_accvgpr_read_b32 v80, a96
    v_accvgpr_read_b32 v84, a98
    v_accvgpr_read_b32 v88, a100
    v_accvgpr_read_b32 v92, a102
    v_accvgpr_read_b32 v81, a97
    v_accvgpr_read_b32 v85, a99
    v_accvgpr_read_b32 v89, a101
    v_accvgpr_read_b32 v93, a103
    v_accvgpr_read_b32 v82, a112
    v_accvgpr_read_b32 v86, a114
    v_accvgpr_read_b32 v90, a116
    v_accvgpr_read_b32 v94, a118
    v_accvgpr_read_b32 v83, a113
    v_accvgpr_read_b32 v87, a115
    v_accvgpr_read_b32 v91, a117
    v_accvgpr_read_b32 v95, a119
    v_max_f32 v80, 0, v80
    v_max_f32 v84, 0, v84
    v_max_f32 v88, 0, v88
    v_max_f32 v92, 0, v92
    v_max_f32 v81, 0, v81
    v_max_f32 v85, 0, v85
    v_max_f32 v89, 0, v89
    v_max_f32 v93, 0, v93
    v_pk_mul_f32 v[80:81], v[80:81], v[82:83]
    v_pk_mul_f32 v[84:85], v[84:85], v[86:87]
    v_pk_mul_f32 v[88:89], v[88:89], v[90:91]
    v_pk_mul_f32 v[92:93], v[92:93], v[94:95]
    v_pk_mul_f32 v[80:81], v[80:81], v[60:61] op_sel:[0,0] op_sel_hi:[1,0]
    v_pk_mul_f32 v[84:85], v[84:85], v[60:61] op_sel:[0,0] op_sel_hi:[1,0]
    v_pk_mul_f32 v[88:89], v[88:89], v[60:61] op_sel:[0,1] op_sel_hi:[1,1]
    v_pk_mul_f32 v[92:93], v[92:93], v[60:61] op_sel:[0,1] op_sel_hi:[1,1]
    v_cvt_pk_bf16_f32 v52, v80, v81
    v_cvt_pk_bf16_f32 v53, v84, v85
    v_cvt_pk_bf16_f32 v54, v88, v89
    v_cvt_pk_bf16_f32 v55, v92, v93
    s_nop 0
    v_permlane32_swap_b32 v52, v54
    v_permlane32_swap_b32 v53, v55
    buffer_store_dwordx4 v[52:55], v27, s[20:23], s73 offen offset:0 sc1
    v_accvgpr_read_b32 v80, a104
    v_accvgpr_read_b32 v84, a106
    v_accvgpr_read_b32 v88, a108
    v_accvgpr_read_b32 v92, a110
    v_accvgpr_read_b32 v81, a105
    v_accvgpr_read_b32 v85, a107
    v_accvgpr_read_b32 v89, a109
    v_accvgpr_read_b32 v93, a111
    v_accvgpr_read_b32 v82, a120
    v_accvgpr_read_b32 v86, a122
    v_accvgpr_read_b32 v90, a124
    v_accvgpr_read_b32 v94, a126
    v_accvgpr_read_b32 v83, a121
    v_accvgpr_read_b32 v87, a123
    v_accvgpr_read_b32 v91, a125
    v_accvgpr_read_b32 v95, a127
    v_max_f32 v80, 0, v80
    v_max_f32 v84, 0, v84
    v_max_f32 v88, 0, v88
    v_max_f32 v92, 0, v92
    v_max_f32 v81, 0, v81
    v_max_f32 v85, 0, v85
    v_max_f32 v89, 0, v89
    v_max_f32 v93, 0, v93
    v_pk_mul_f32 v[80:81], v[80:81], v[82:83]
    v_pk_mul_f32 v[84:85], v[84:85], v[86:87]
    v_pk_mul_f32 v[88:89], v[88:89], v[90:91]
    v_pk_mul_f32 v[92:93], v[92:93], v[94:95]
    v_pk_mul_f32 v[80:81], v[80:81], v[62:63] op_sel:[0,0] op_sel_hi:[1,0]
    v_pk_mul_f32 v[84:85], v[84:85], v[62:63] op_sel:[0,0] op_sel_hi:[1,0]
    v_pk_mul_f32 v[88:89], v[88:89], v[62:63] op_sel:[0,1] op_sel_hi:[1,1]
    v_pk_mul_f32 v[92:93], v[92:93], v[62:63] op_sel:[0,1] op_sel_hi:[1,1]
    v_cvt_pk_bf16_f32 v56, v80, v81
    v_cvt_pk_bf16_f32 v57, v84, v85
    v_cvt_pk_bf16_f32 v58, v88, v89
    v_cvt_pk_bf16_f32 v59, v92, v93
    s_nop 0
    v_permlane32_swap_b32 v56, v58
    v_permlane32_swap_b32 v57, v59
    buffer_store_dwordx4 v[56:59], v27, s[20:23], s73 offen offset:2048 sc1
    v_mov_b32 v26, 1
    s_waitcnt vmcnt(14)
    s_mov_b64 exec, 1
    buffer_store_dword v26, off, s[20:23], s76 sc1
    s_mov_b64 exec, -1
    s_mov_b32 s86, 0xcb875410
    s_mov_b32 s87, 0xa3d962
    s_mov_b32 s88, 0x76543210
    s_bfe_u32 s92, s2, 0x10002
    s_lshl_b32 s92, s92, 3
    s_bfe_u32 s6, s2, 0x30003
    s_add_u32 s92, s92, s6
    s_bfe_u32 s93, s2, 0x10001
    s_lshl_b32 s93, s93, 2
    s_lshr_b32 s6, s2, 6
    s_add_u32 s93, s93, s6
    s_and_b32 s94, s2, 1
    s_lshl_b32 s95, s94, 2
    s_add_u32 s95, s95, s3
    s_mov_b32 s12, s64
    s_mov_b32 s13, s65
    s_mov_b32 s14, 0x800000
    s_mov_b32 s16, s60
    s_mov_b32 s17, s61
    s_mov_b32 s18, 0x700000
    s_mul_i32 s31, s3, 40960
    v_lshlrev_b32 v84, 1, v19
    v_xor_b32 v84, v84, v18
    v_xor_b32 v85, 8, v84
    s_lshl_b32 s6, s93, 8
    v_lshl_add_u32 v86, v19, 11, s6
    v_lshl_add_u32 v3, v84, 4, v86
    v_lshl_add_u32 v4, v85, 4, v86
    v_add_u32 v4, 7168, v4
    v_add_u32 v5, 14336, v3
    v_add_u32 v6, 14336, v4
    s_mul_i32 s34, s95, 917504
    v_lshlrev_b32 v87, 4, v17
    s_mul_i32 s6, s92, 1441792
    v_add_u32 v1, s6, v87
    v_add_u32 v2, 0x1000, v1
    s_mul_i32 s33, s95, 114688
    s_lshl_b32 s32, s95, 16
    s_add_u32 s29, s32, 917504
    v_lshrrev_b32 v84, 2, v18
    v_lshl_add_u32 v84, v19, 2, v84
    v_and_b32 v85, 7, v84
    v_and_b32 v86, 8, v84
    v_lshl_add_u32 v84, v86, 1, v85
    v_and_b32 v86, 3, v17
    v_lshlrev_b32 v84, 8, v84
    v_lshl_add_u32 v84, v86, 3, v84
    v_add_u32 v84, s31, v84
    v_lshl_add_u32 v7, v85, 5, v84
    s_lshl_b32 s7, s94, 7
    v_xor_b32 v7, s7, v7
    v_xor_b32 v8, 32, v7
    v_xor_b32 v9, 64, v7
    v_xor_b32 v10, 96, v7
    v_xor_b32 v11, 128, v7
    v_xor_b32 v12, 160, v7
    v_xor_b32 v13, 192, v7
    v_xor_b32 v14, 224, v7
    s_waitcnt vmcnt(7)
    ds_read_b128 v[224:227], v21 offset:2048
    ds_read_b128 v[80:83], v20 offset:1280
    ds_read_b128 v[228:231], v21 offset:2064
    ds_read_b128 v[84:87], v20 offset:1296
    ds_read_b128 v[232:235], v21 offset:2176
    ds_read_b128 v[88:91], v20 offset:1408
    ds_read_b128 v[236:239], v21 offset:2192
    ds_read_b128 v[92:95], v20 offset:1424
    s_mov_b32 s75, 0
K1_tchk:
    v_max3_u32 v24, v160, v161, v162
    v_max3_u32 v25, v176, v177, v178
    v_max3_u32 v24, v24, v163, v164
    v_max3_u32 v25, v25, v179, v180
    v_max3_u32 v24, v24, v165, v166
    v_max3_u32 v25, v25, v181, v182
    v_max3_u32 v24, v24, v167, v168
    v_max3_u32 v25, v25, v183, v184
    v_max3_u32 v24, v24, v169, v170
    v_max3_u32 v25, v25, v185, v186
    v_max3_u32 v24, v24, v171, v172
    v_max3_u32 v25, v25, v187, v188
    v_max3_u32 v24, v24, v173, v174
    v_max3_u32 v25, v25, v189, v190
    v_max3_u32 v24, v24, v175, v191
    v_max_u32 v24, v24, v25
    v_cmp_eq_u32 vcc, -1, v24
    s_add_u32 s75, s75, 1
    s_nop 0
    s_cmp_eq_u64 vcc, 0
    s_cbranch_scc1 K1_tchkok
    s_cmp_ge_u32 s75, 0x4000
    s_cbranch_scc1 K1_tchkok
    s_sleep 2
    buffer_load_dwordx4 v[160:163], v22, s[20:23], s79 offen offset:0 sc1
    buffer_load_dwordx4 v[164:167], v22, s[20:23], s79 offen offset:16 sc1
    buffer_load_dwordx4 v[168:171], v22, s[20:23], s79 offen offset:32 sc1
    buffer_load_dwordx4 v[172:175], v22, s[20:23], s79 offen offset:48 sc1
    buffer_load_dwordx4 v[176:179], v23, s[20:23], s79 offen offset:0 sc1
    buffer_load_dwordx4 v[180:183], v23, s[20:23], s79 offen offset:16 sc1
    buffer_load_dwordx4 v[184:187], v23, s[20:23], s79 offen offset:32 sc1
    buffer_load_dwordx4 v[188:191], v23, s[20:23], s79 offen offset:48 sc1
    s_waitcnt vmcnt(0)
    s_branch K1_tchk
K1_tchkok:
    s_waitcnt lgkmcnt(0)
    s_barrier
    s_bfe_u32 s30, s86, 0x40000
    s_lshl_b32 s30, s30, 16
    s_add_u32 s30, s30, s34
    s_add_u32 s35, s30, 32768
    s_add_u32 m0, s31, 0
    s_nop 0
    buffer_load_dwordx4 v3, s[16:19], s30 offen offset:0 lds
    v_pk_mul_f32 v[240:241], v[192:193], v[160:161]
    v_pk_mul_f32 v[242:243], v[194:195], v[162:163]
    v_pk_mul_f32 v[244:245], v[196:197], v[164:165]
    v_pk_mul_f32 v[246:247], v[198:199], v[166:167]
    v_pk_mul_f32 v[248:249], v[192:193], v[168:169]
    v_pk_mul_f32 v[250:251], v[194:195], v[170:171]
    v_pk_mul_f32 v[252:253], v[196:197], v[172:173]
    v_pk_mul_f32 v[254:255], v[198:199], v[174:175]
    v_pk_fma_f32 v[240:241], v[200:201], v[168:169], v[240:241] neg_lo:[1,0,0] neg_hi:[1,0,0]
    v_pk_fma_f32 v[242:243], v[202:203], v[170:171], v[242:243] neg_lo:[1,0,0] neg_hi:[1,0,0]
    v_pk_fma_f32 v[244:245], v[204:205], v[172:173], v[244:245] neg_lo:[1,0,0] neg_hi:[1,0,0]
    v_pk_fma_f32 v[246:247], v[206:207], v[174:175], v[246:247] neg_lo:[1,0,0] neg_hi:[1,0,0]
    v_pk_fma_f32 v[248:249], v[200:201], v[160:161], v[248:249]
    v_pk_fma_f32 v[250:251], v[202:203], v[162:163], v[250:251]
    v_pk_fma_f32 v[252:253], v[204:205], v[164:165], v[252:253]
    v_pk_fma_f32 v[254:255], v[206:207], v[166:167], v[254:255]
    buffer_load_dwordx4 v4, s[16:19], s30 offen offset:1024 lds
    v_pk_fma_f32 v[240:241], v[208:209], v[176:177], v[240:241]
    v_pk_fma_f32 v[242:243], v[210:211], v[178:179], v[242:243]
    v_pk_fma_f32 v[244:245], v[212:213], v[180:181], v[244:245]
    v_pk_fma_f32 v[246:247], v[214:215], v[182:183], v[246:247]
    v_pk_fma_f32 v[248:249], v[208:209], v[184:185], v[248:249]
    v_pk_fma_f32 v[250:251], v[210:211], v[186:187], v[250:251]
    v_pk_fma_f32 v[252:253], v[212:213], v[188:189], v[252:253]
    v_pk_fma_f32 v[254:255], v[214:215], v[190:191], v[254:255]
    v_pk_fma_f32 v[240:241], v[216:217], v[184:185], v[240:241] neg_lo:[1,0,0] neg_hi:[1,0,0]
    v_pk_fma_f32 v[242:243], v[218:219], v[186:187], v[242:243] neg_lo:[1,0,0] neg_hi:[1,0,0]
    v_pk_fma_f32 v[244:245], v[220:221], v[188:189], v[244:245] neg_lo:[1,0,0] neg_hi:[1,0,0]
    v_pk_fma_f32 v[246:247], v[222:223], v[190:191], v[246:247] neg_lo:[1,0,0] neg_hi:[1,0,0]
    v_pk_fma_f32 v[248:249], v[216:217], v[176:177], v[248:249]
    v_pk_fma_f32 v[250:251], v[218:219], v[178:179], v[250:251]
    v_pk_fma_f32 v[252:253], v[220:221], v[180:181], v[252:253]
    v_pk_fma_f32 v[254:255], v[222:223], v[182:183], v[254:255]
    buffer_load_dwordx4 v5, s[16:19], s30 offen offset:2048 lds
    v_add_f32_dpp v240, v240, v240 row_ror:8 row_mask:0xf bank_mask:0xf
    v_add_f32_dpp v241, v241, v241 row_ror:8 row_mask:0xf bank_mask:0xf
    v_add_f32_dpp v242, v242, v242 row_ror:8 row_mask:0xf bank_mask:0xf
    v_add_f32_dpp v243, v243, v243 row_ror:8 row_mask:0xf bank_mask:0xf
    v_add_f32_dpp v244, v244, v244 row_ror:8 row_mask:0xf bank_mask:0xf
    v_add_f32_dpp v245, v245, v245 row_ror:8 row_mask:0xf bank_mask:0xf
    v_add_f32_dpp v246, v246, v246 row_ror:8 row_mask:0xf bank_mask:0xf
    v_add_f32_dpp v247, v247, v247 row_ror:8 row_mask:0xf bank_mask:0xf
    v_add_f32_dpp v248, v248, v248 row_ror:8 row_mask:0xf bank_mask:0xf
    v_add_f32_dpp v249, v249, v249 row_ror:8 row_mask:0xf bank_mask:0xf
    v_add_f32_dpp v250, v250, v250 row_ror:8 row_mask:0xf bank_mask:0xf
    v_add_f32_dpp v251, v251, v251 row_ror:8 row_mask:0xf bank_mask:0xf
    v_add_f32_dpp v252, v252, v252 row_ror:8 row_mask:0xf bank_mask:0xf
    v_add_f32_dpp v253, v253, v253 row_ror:8 row_mask:0xf bank_mask:0xf
    v_add_f32_dpp v254, v254, v254 row_ror:8 row_mask:0xf bank_mask:0xf
    v_add_f32_dpp v255, v255, v255 row_ror:8 row_mask:0xf bank_mask:0xf
    buffer_load_dwordx4 v6, s[16:19], s30 offen offset:3072 lds
    v_add_f32_dpp v240, v240, v240 row_ror:4 row_mask:0xf bank_mask:0xf
    v_add_f32_dpp v241, v241, v241 row_ror:4 row_mask:0xf bank_mask:0xf
    v_add_f32_dpp v242, v242, v242 row_ror:4 row_mask:0xf bank_mask:0xf
    v_add_f32_dpp v243, v243, v243 row_ror:4 row_mask:0xf bank_mask:0xf
    v_add_f32_dpp v244, v244, v244 row_ror:4 row_mask:0xf bank_mask:0xf
    v_add_f32_dpp v245, v245, v245 row_ror:4 row_mask:0xf bank_mask:0xf
    v_add_f32_dpp v246, v246, v246 row_ror:4 row_mask:0xf bank_mask:0xf
    v_add_f32_dpp v247, v247, v247 row_ror:4 row_mask:0xf bank_mask:0xf
    v_add_f32_dpp v248, v248, v248 row_ror:4 row_mask:0xf bank_mask:0xf
    v_add_f32_dpp v249, v249, v249 row_ror:4 row_mask:0xf bank_mask:0xf
    v_add_f32_dpp v250, v250, v250 row_ror:4 row_mask:0xf bank_mask:0xf
    v_add_f32_dpp v251, v251, v251 row_ror:4 row_mask:0xf bank_mask:0xf
    v_add_f32_dpp v252, v252, v252 row_ror:4 row_mask:0xf bank_mask:0xf
    v_add_f32_dpp v253, v253, v253 row_ror:4 row_mask:0xf bank_mask:0xf
    v_add_f32_dpp v254, v254, v254 row_ror:4 row_mask:0xf bank_mask:0xf
    v_add_f32_dpp v255, v255, v255 row_ror:4 row_mask:0xf bank_mask:0xf
    s_add_u32 m0, s31, 4096
    v_add_f32_dpp v240, v240, v240 row_ror:2 row_mask:0xf bank_mask:0xf
    v_add_f32_dpp v241, v241, v241 row_ror:2 row_mask:0xf bank_mask:0xf
    v_add_f32_dpp v242, v242, v242 row_ror:2 row_mask:0xf bank_mask:0xf
    v_add_f32_dpp v243, v243, v243 row_ror:2 row_mask:0xf bank_mask:0xf
    v_add_f32_dpp v244, v244, v244 row_ror:2 row_mask:0xf bank_mask:0xf
    v_add_f32_dpp v245, v245, v245 row_ror:2 row_mask:0xf bank_mask:0xf
    v_add_f32_dpp v246, v246, v246 row_ror:2 row_mask:0xf bank_mask:0xf
    v_add_f32_dpp v247, v247, v247 row_ror:2 row_mask:0xf bank_mask:0xf
    v_add_f32_dpp v248, v248, v248 row_ror:2 row_mask:0xf bank_mask:0xf
    v_add_f32_dpp v249, v249, v249 row_ror:2 row_mask:0xf bank_mask:0xf
    v_add_f32_dpp v250, v250, v250 row_ror:2 row_mask:0xf bank_mask:0xf
    v_add_f32_dpp v251, v251, v251 row_ror:2 row_mask:0xf bank_mask:0xf
    v_add_f32_dpp v252, v252, v252 row_ror:2 row_mask:0xf bank_mask:0xf
    v_add_f32_dpp v253, v253, v253 row_ror:2 row_mask:0xf bank_mask:0xf
    v_add_f32_dpp v254, v254, v254 row_ror:2 row_mask:0xf bank_mask:0xf
    v_add_f32_dpp v255, v255, v255 row_ror:2 row_mask:0xf bank_mask:0xf
    buffer_load_dwordx4 v3, s[16:19], s35 offen offset:0 lds
    v_add_f32_dpp v240, v240, v240 row_ror:1 row_mask:0xf bank_mask:0xf
    v_add_f32_dpp v241, v241, v241 row_ror:1 row_mask:0xf bank_mask:0xf
    v_add_f32_dpp v242, v242, v242 row_ror:1 row_mask:0xf bank_mask:0xf
    v_add_f32_dpp v243, v243, v243 row_ror:1 row_mask:0xf bank_mask:0xf
    v_add_f32_dpp v244, v244, v244 row_ror:1 row_mask:0xf bank_mask:0xf
    v_add_f32_dpp v245, v245, v245 row_ror:1 row_mask:0xf bank_mask:0xf
    v_add_f32_dpp v246, v246, v246 row_ror:1 row_mask:0xf bank_mask:0xf
    v_add_f32_dpp v247, v247, v247 row_ror:1 row_mask:0xf bank_mask:0xf
    v_add_f32_dpp v248, v248, v248 row_ror:1 row_mask:0xf bank_mask:0xf
    v_add_f32_dpp v249, v249, v249 row_ror:1 row_mask:0xf bank_mask:0xf
    v_add_f32_dpp v250, v250, v250 row_ror:1 row_mask:0xf bank_mask:0xf
    v_add_f32_dpp v251, v251, v251 row_ror:1 row_mask:0xf bank_mask:0xf
    v_add_f32_dpp v252, v252, v252 row_ror:1 row_mask:0xf bank_mask:0xf
    v_add_f32_dpp v253, v253, v253 row_ror:1 row_mask:0xf bank_mask:0xf
    v_add_f32_dpp v254, v254, v254 row_ror:1 row_mask:0xf bank_mask:0xf
    v_add_f32_dpp v255, v255, v255 row_ror:1 row_mask:0xf bank_mask:0xf
    buffer_load_dwordx4 v4, s[16:19], s35 offen offset:1024 lds
    v_pk_fma_f32 v[64:65], v[224:225], v[240:241], v[64:65]
    v_pk_fma_f32 v[66:67], v[226:227], v[242:243], v[66:67]
    v_pk_fma_f32 v[68:69], v[228:229], v[244:245], v[68:69]
    v_pk_fma_f32 v[70:71], v[230:231], v[246:247], v[70:71]
    v_pk_fma_f32 v[72:73], v[224:225], v[248:249], v[72:73]
    v_pk_fma_f32 v[74:75], v[226:227], v[250:251], v[74:75]
    v_pk_fma_f32 v[76:77], v[228:229], v[252:253], v[76:77]
    v_pk_fma_f32 v[78:79], v[230:231], v[254:255], v[78:79]
    v_pk_fma_f32 v[64:65], v[232:233], v[248:249], v[64:65] neg_lo:[1,0,0] neg_hi:[1,0,0]
    v_pk_fma_f32 v[66:67], v[234:235], v[250:251], v[66:67] neg_lo:[1,0,0] neg_hi:[1,0,0]
    v_pk_fma_f32 v[68:69], v[236:237], v[252:253], v[68:69] neg_lo:[1,0,0] neg_hi:[1,0,0]
    v_pk_fma_f32 v[70:71], v[238:239], v[254:255], v[70:71] neg_lo:[1,0,0] neg_hi:[1,0,0]
    v_pk_fma_f32 v[72:73], v[232:233], v[240:241], v[72:73]
    v_pk_fma_f32 v[74:75], v[234:235], v[242:243], v[74:75]
    v_pk_fma_f32 v[76:77], v[236:237], v[244:245], v[76:77]
    v_pk_fma_f32 v[78:79], v[238:239], v[246:247], v[78:79]
    buffer_load_dwordx4 v5, s[16:19], s35 offen offset:2048 lds
    buffer_load_dwordx4 v6, s[16:19], s35 offen offset:3072 lds
    v_mov_b32 v27, v15
    v_lshlrev_b32 v15, 4, v17
    v_and_b32 v20, 7, v17
    v_lshlrev_b32 v20, 7, v20
    s_lshl_b32 s72, s92, 13
    s_lshl_b32 s7, s95, 10
    s_add_u32 s72, s72, s7
    s_add_u32 s72, s72, 24117248
    s_lshl_b32 s6, s93, 19
    s_add_u32 s6, s6, 25165824
    v_add_u32 v24, s6, v15
    v_add_u32 v25, s31, v15
    s_lshl_b32 s7, s94, 12
    s_add_u32 s32, s32, s7
    s_add_u32 s70, s5, 112
    s_lshl_b32 s70, s70, 13
    s_add_u32 s71, s70, 262144
    s_lshl_b32 s6, s92, 13
    s_add_u32 s6, s6, 0x20000
    s_lshl_b32 s7, s93, 1
    s_add_u32 s7, s7, s94
    s_lshl_b32 s7, s7, 13
    v_mov_b32 v22, s6
    v_mov_b32 v23, s7
    v_and_b32 v21, 16, v17
    v_cmp_eq_u32 vcc, 0, v21
    s_nop 1
    v_cndmask_b32 v22, v23, v22, vcc
    v_lshl_add_u32 v22, v18, 7, v22
    s_lshl_b32 s73, s3, 11
    s_add_u32 s73, s73, 24117248
    buffer_load_dword v56, v20, s[20:23], s72 offen sc1
    s_bfe_u32 s30, s86, 0x40004
    s_lshl_b32 s30, s30, 16
    s_add_u32 s30, s30, s34
    s_add_u32 s35, s30, 32768
    s_add_u32 m0, s31, 8192
    s_nop 0
    buffer_load_dwordx4 v3, s[16:19], s30 offen offset:0 lds
    v_pk_fma_f32 v[96:97], v[32:33], v[64:65], v[96:97]
    v_pk_fma_f32 v[98:99], v[34:35], v[66:67], v[98:99]
    v_pk_fma_f32 v[128:129], v[36:37], v[68:69], v[128:129]
    v_pk_fma_f32 v[130:131], v[38:39], v[70:71], v[130:131]
    v_pk_fma_f32 v[112:113], v[32:33], v[72:73], v[112:113]
    v_pk_fma_f32 v[114:115], v[34:35], v[74:75], v[114:115]
    v_pk_fma_f32 v[144:145], v[36:37], v[76:77], v[144:145]
    v_pk_fma_f32 v[146:147], v[38:39], v[78:79], v[146:147]
    v_pk_fma_f32 v[96:97], v[40:41], v[72:73], v[96:97] neg_lo:[1,0,0] neg_hi:[1,0,0]
    v_pk_fma_f32 v[98:99], v[42:43], v[74:75], v[98:99] neg_lo:[1,0,0] neg_hi:[1,0,0]
    v_pk_fma_f32 v[128:129], v[44:45], v[76:77], v[128:129] neg_lo:[1,0,0] neg_hi:[1,0,0]
    v_pk_fma_f32 v[130:131], v[46:47], v[78:79], v[130:131] neg_lo:[1,0,0] neg_hi:[1,0,0]
    v_pk_fma_f32 v[112:113], v[40:41], v[64:65], v[112:113]
    v_pk_fma_f32 v[114:115], v[42:43], v[66:67], v[114:115]
    v_pk_fma_f32 v[144:145], v[44:45], v[68:69], v[144:145]
    v_pk_fma_f32 v[146:147], v[46:47], v[70:71], v[146:147]
    v_pk_mul_f32 v[176:177], v[80:81], v[96:97]
    v_pk_mul_f32 v[178:179], v[82:83], v[98:99]
    v_pk_mul_f32 v[180:181], v[84:85], v[128:129]
    v_pk_mul_f32 v[182:183], v[86:87], v[130:131]
    v_pk_mul_f32 v[184:185], v[80:81], v[112:113]
    v_pk_mul_f32 v[186:187], v[82:83], v[114:115]
    v_pk_mul_f32 v[188:189], v[84:85], v[144:145]
    v_pk_mul_f32 v[190:191], v[86:87], v[146:147]
    v_pk_fma_f32 v[176:177], v[88:89], v[112:113], v[176:177] neg_lo:[1,0,0] neg_hi:[1,0,0]
    v_pk_fma_f32 v[178:179], v[90:91], v[114:115], v[178:179] neg_lo:[1,0,0] neg_hi:[1,0,0]
    v_pk_fma_f32 v[180:181], v[92:93], v[144:145], v[180:181] neg_lo:[1,0,0] neg_hi:[1,0,0]
    v_pk_fma_f32 v[182:183], v[94:95], v[146:147], v[182:183] neg_lo:[1,0,0] neg_hi:[1,0,0]
    v_pk_fma_f32 v[184:185], v[88:89], v[96:97], v[184:185]
    v_pk_fma_f32 v[186:187], v[90:91], v[98:99], v[186:187]
    v_pk_fma_f32 v[188:189], v[92:93], v[128:129], v[188:189]
    v_pk_fma_f32 v[190:191], v[94:95], v[130:131], v[190:191]
    buffer_load_dwordx4 v4, s[16:19], s30 offen offset:1024 lds
    v_pk_mul_f32 v[176:177], v[176:177], v[28:29] op_sel:[0,0] op_sel_hi:[1,0]
    v_pk_mul_f32 v[178:179], v[178:179], v[28:29] op_sel:[0,0] op_sel_hi:[1,0]
    v_pk_mul_f32 v[180:181], v[180:181], v[28:29] op_sel:[0,0] op_sel_hi:[1,0]
    v_pk_mul_f32 v[182:183], v[182:183], v[28:29] op_sel:[0,0] op_sel_hi:[1,0]
    v_pk_mul_f32 v[184:185], v[184:185], v[28:29] op_sel:[0,0] op_sel_hi:[1,0]
    v_pk_mul_f32 v[186:187], v[186:187], v[28:29] op_sel:[0,0] op_sel_hi:[1,0]
    v_pk_mul_f32 v[188:189], v[188:189], v[28:29] op_sel:[0,0] op_sel_hi:[1,0]
    v_pk_mul_f32 v[190:191], v[190:191], v[28:29] op_sel:[0,0] op_sel_hi:[1,0]
    v_cvt_pk_bf16_f32 v224, v176, v177
    v_cvt_pk_bf16_f32 v225, v178, v179
    v_cvt_pk_bf16_f32 v226, v180, v181
    v_cvt_pk_bf16_f32 v227, v182, v183
    v_cvt_pk_bf16_f32 v228, -v184, -v185
    v_cvt_pk_bf16_f32 v229, -v186, -v187
    v_cvt_pk_bf16_f32 v230, -v188, -v189
    v_cvt_pk_bf16_f32 v231, -v190, -v191
    buffer_load_dwordx4 v5, s[16:19], s30 offen offset:2048 lds
    v_pk_fma_f32 v[100:101], v[32:33], v[96:97], v[100:101]
    v_pk_fma_f32 v[102:103], v[34:35], v[98:99], v[102:103]
    v_pk_fma_f32 v[132:133], v[36:37], v[128:129], v[132:133]
    v_pk_fma_f32 v[134:135], v[38:39], v[130:131], v[134:135]
    v_pk_fma_f32 v[116:117], v[32:33], v[112:113], v[116:117]
    v_pk_fma_f32 v[118:119], v[34:35], v[114:115], v[118:119]
    v_pk_fma_f32 v[148:149], v[36:37], v[144:145], v[148:149]
    v_pk_fma_f32 v[150:151], v[38:39], v[146:147], v[150:151]
    v_pk_fma_f32 v[100:101], v[40:41], v[112:113], v[100:101] neg_lo:[1,0,0] neg_hi:[1,0,0]
    v_pk_fma_f32 v[102:103], v[42:43], v[114:115], v[102:103] neg_lo:[1,0,0] neg_hi:[1,0,0]
    v_pk_fma_f32 v[132:133], v[44:45], v[144:145], v[132:133] neg_lo:[1,0,0] neg_hi:[1,0,0]
    v_pk_fma_f32 v[134:135], v[46:47], v[146:147], v[134:135] neg_lo:[1,0,0] neg_hi:[1,0,0]
    v_pk_fma_f32 v[116:117], v[40:41], v[96:97], v[116:117]
    v_pk_fma_f32 v[118:119], v[42:43], v[98:99], v[118:119]
    v_pk_fma_f32 v[148:149], v[44:45], v[128:129], v[148:149]
    v_pk_fma_f32 v[150:151], v[46:47], v[130:131], v[150:151]
    v_pk_mul_f32 v[160:161], v[80:81], v[100:101]
    v_pk_mul_f32 v[162:163], v[82:83], v[102:103]
    v_pk_mul_f32 v[164:165], v[84:85], v[132:133]
    v_pk_mul_f32 v[166:167], v[86:87], v[134:135]
    v_pk_mul_f32 v[168:169], v[80:81], v[116:117]
    v_pk_mul_f32 v[170:171], v[82:83], v[118:119]
    v_pk_mul_f32 v[172:173], v[84:85], v[148:149]
    v_pk_mul_f32 v[174:175], v[86:87], v[150:151]
    v_pk_fma_f32 v[160:161], v[88:89], v[116:117], v[160:161] neg_lo:[1,0,0] neg_hi:[1,0,0]
    v_pk_fma_f32 v[162:163], v[90:91], v[118:119], v[162:163] neg_lo:[1,0,0] neg_hi:[1,0,0]
    v_pk_fma_f32 v[164:165], v[92:93], v[148:149], v[164:165] neg_lo:[1,0,0] neg_hi:[1,0,0]
    v_pk_fma_f32 v[166:167], v[94:95], v[150:151], v[166:167] neg_lo:[1,0,0] neg_hi:[1,0,0]
    v_pk_fma_f32 v[168:169], v[88:89], v[100:101], v[168:169]
    v_pk_fma_f32 v[170:171], v[90:91], v[102:103], v[170:171]
    v_pk_fma_f32 v[172:173], v[92:93], v[132:133], v[172:173]
    v_pk_fma_f32 v[174:175], v[94:95], v[134:135], v[174:175]
    buffer_load_dwordx4 v6, s[16:19], s30 offen offset:3072 lds
    v_pk_mul_f32 v[160:161], v[160:161], v[28:29] op_sel:[0,1] op_sel_hi:[1,1]
    v_pk_mul_f32 v[162:163], v[162:163], v[28:29] op_sel:[0,1] op_sel_hi:[1,1]
    v_pk_mul_f32 v[164:165], v[164:165], v[28:29] op_sel:[0,1] op_sel_hi:[1,1]
    v_pk_mul_f32 v[166:167], v[166:167], v[28:29] op_sel:[0,1] op_sel_hi:[1,1]
    v_pk_mul_f32 v[168:169], v[168:169], v[28:29] op_sel:[0,1] op_sel_hi:[1,1]
    v_pk_mul_f32 v[170:171], v[170:171], v[28:29] op_sel:[0,1] op_sel_hi:[1,1]
    v_pk_mul_f32 v[172:173], v[172:173], v[28:29] op_sel:[0,1] op_sel_hi:[1,1]
    v_pk_mul_f32 v[174:175], v[174:175], v[28:29] op_sel:[0,1] op_sel_hi:[1,1]
    v_cvt_pk_bf16_f32 v232, v160, v161
    v_cvt_pk_bf16_f32 v233, v162, v163
    v_cvt_pk_bf16_f32 v234, v164, v165
    v_cvt_pk_bf16_f32 v235, v166, v167
    v_cvt_pk_bf16_f32 v236, -v168, -v169
    v_cvt_pk_bf16_f32 v237, -v170, -v171
    v_cvt_pk_bf16_f32 v238, -v172, -v173
    v_cvt_pk_bf16_f32 v239, -v174, -v175
    s_add_u32 m0, s31, 12288
    s_nop 0
    buffer_load_dwordx4 v3, s[16:19], s35 offen offset:0 lds
    v_pk_fma_f32 v[104:105], v[32:33], v[100:101], v[104:105]
    v_pk_fma_f32 v[106:107], v[34:35], v[102:103], v[106:107]
    v_pk_fma_f32 v[136:137], v[36:37], v[132:133], v[136:137]
    v_pk_fma_f32 v[138:139], v[38:39], v[134:135], v[138:139]
    v_pk_fma_f32 v[120:121], v[32:33], v[116:117], v[120:121]
    v_pk_fma_f32 v[122:123], v[34:35], v[118:119], v[122:123]
    v_pk_fma_f32 v[152:153], v[36:37], v[148:149], v[152:153]
    v_pk_fma_f32 v[154:155], v[38:39], v[150:151], v[154:155]
    v_pk_fma_f32 v[104:105], v[40:41], v[116:117], v[104:105] neg_lo:[1,0,0] neg_hi:[1,0,0]
    v_pk_fma_f32 v[106:107], v[42:43], v[118:119], v[106:107] neg_lo:[1,0,0] neg_hi:[1,0,0]
    v_pk_fma_f32 v[136:137], v[44:45], v[148:149], v[136:137] neg_lo:[1,0,0] neg_hi:[1,0,0]
    v_pk_fma_f32 v[138:139], v[46:47], v[150:151], v[138:139] neg_lo:[1,0,0] neg_hi:[1,0,0]
    v_pk_fma_f32 v[120:121], v[40:41], v[100:101], v[120:121]
    v_pk_fma_f32 v[122:123], v[42:43], v[102:103], v[122:123]
    v_pk_fma_f32 v[152:153], v[44:45], v[132:133], v[152:153]
    v_pk_fma_f32 v[154:155], v[46:47], v[134:135], v[154:155]
    v_pk_mul_f32 v[176:177], v[80:81], v[104:105]
    v_pk_mul_f32 v[178:179], v[82:83], v[106:107]
    v_pk_mul_f32 v[180:181], v[84:85], v[136:137]
    v_pk_mul_f32 v[182:183], v[86:87], v[138:139]
    v_pk_mul_f32 v[184:185], v[80:81], v[120:121]
    v_pk_mul_f32 v[186:187], v[82:83], v[122:123]
    v_pk_mul_f32 v[188:189], v[84:85], v[152:153]
    v_pk_mul_f32 v[190:191], v[86:87], v[154:155]
    v_pk_fma_f32 v[176:177], v[88:89], v[120:121], v[176:177] neg_lo:[1,0,0] neg_hi:[1,0,0]
    v_pk_fma_f32 v[178:179], v[90:91], v[122:123], v[178:179] neg_lo:[1,0,0] neg_hi:[1,0,0]
    v_pk_fma_f32 v[180:181], v[92:93], v[152:153], v[180:181] neg_lo:[1,0,0] neg_hi:[1,0,0]
    v_pk_fma_f32 v[182:183], v[94:95], v[154:155], v[182:183] neg_lo:[1,0,0] neg_hi:[1,0,0]
    v_pk_fma_f32 v[184:185], v[88:89], v[104:105], v[184:185]
    v_pk_fma_f32 v[186:187], v[90:91], v[106:107], v[186:187]
    v_pk_fma_f32 v[188:189], v[92:93], v[136:137], v[188:189]
    v_pk_fma_f32 v[190:191], v[94:95], v[138:139], v[190:191]
    buffer_load_dwordx4 v4, s[16:19], s35 offen offset:1024 lds
    v_pk_mul_f32 v[176:177], v[176:177], v[30:31] op_sel:[0,0] op_sel_hi:[1,0]
    v_pk_mul_f32 v[178:179], v[178:179], v[30:31] op_sel:[0,0] op_sel_hi:[1,0]
    v_pk_mul_f32 v[180:181], v[180:181], v[30:31] op_sel:[0,0] op_sel_hi:[1,0]
    v_pk_mul_f32 v[182:183], v[182:183], v[30:31] op_sel:[0,0] op_sel_hi:[1,0]
    v_pk_mul_f32 v[184:185], v[184:185], v[30:31] op_sel:[0,0] op_sel_hi:[1,0]
    v_pk_mul_f32 v[186:187], v[186:187], v[30:31] op_sel:[0,0] op_sel_hi:[1,0]
    v_pk_mul_f32 v[188:189], v[188:189], v[30:31] op_sel:[0,0] op_sel_hi:[1,0]
    v_pk_mul_f32 v[190:191], v[190:191], v[30:31] op_sel:[0,0] op_sel_hi:[1,0]
    v_cvt_pk_bf16_f32 v240, v176, v177
    v_cvt_pk_bf16_f32 v241, v178, v179
    v_cvt_pk_bf16_f32 v242, v180, v181
    v_cvt_pk_bf16_f32 v243, v182, v183
    v_cvt_pk_bf16_f32 v244, -v184, -v185
    v_cvt_pk_bf16_f32 v245, -v186, -v187
    v_cvt_pk_bf16_f32 v246, -v188, -v189
    v_cvt_pk_bf16_f32 v247, -v190, -v191
    buffer_load_dwordx4 v5, s[16:19], s35 offen offset:2048 lds
    v_pk_fma_f32 v[108:109], v[32:33], v[104:105], v[108:109]
    v_pk_fma_f32 v[110:111], v[34:35], v[106:107], v[110:111]
    v_pk_fma_f32 v[140:141], v[36:37], v[136:137], v[140:141]
    v_pk_fma_f32 v[142:143], v[38:39], v[138:139], v[142:143]
    v_pk_fma_f32 v[124:125], v[32:33], v[120:121], v[124:125]
    v_pk_fma_f32 v[126:127], v[34:35], v[122:123], v[126:127]
    v_pk_fma_f32 v[156:157], v[36:37], v[152:153], v[156:157]
    v_pk_fma_f32 v[158:159], v[38:39], v[154:155], v[158:159]
    v_pk_fma_f32 v[108:109], v[40:41], v[120:121], v[108:109] neg_lo:[1,0,0] neg_hi:[1,0,0]
    v_pk_fma_f32 v[110:111], v[42:43], v[122:123], v[110:111] neg_lo:[1,0,0] neg_hi:[1,0,0]
    v_pk_fma_f32 v[140:141], v[44:45], v[152:153], v[140:141] neg_lo:[1,0,0] neg_hi:[1,0,0]
    v_pk_fma_f32 v[142:143], v[46:47], v[154:155], v[142:143] neg_lo:[1,0,0] neg_hi:[1,0,0]
    v_pk_fma_f32 v[124:125], v[40:41], v[104:105], v[124:125]
    v_pk_fma_f32 v[126:127], v[42:43], v[106:107], v[126:127]
    v_pk_fma_f32 v[156:157], v[44:45], v[136:137], v[156:157]
    v_pk_fma_f32 v[158:159], v[46:47], v[138:139], v[158:159]
    v_pk_mul_f32 v[160:161], v[80:81], v[108:109]
    v_pk_mul_f32 v[162:163], v[82:83], v[110:111]
    v_pk_mul_f32 v[164:165], v[84:85], v[140:141]
    v_pk_mul_f32 v[166:167], v[86:87], v[142:143]
    v_pk_mul_f32 v[168:169], v[80:81], v[124:125]
    v_pk_mul_f32 v[170:171], v[82:83], v[126:127]
    v_pk_mul_f32 v[172:173], v[84:85], v[156:157]
    v_pk_mul_f32 v[174:175], v[86:87], v[158:159]
    v_pk_fma_f32 v[160:161], v[88:89], v[124:125], v[160:161] neg_lo:[1,0,0] neg_hi:[1,0,0]
    v_pk_fma_f32 v[162:163], v[90:91], v[126:127], v[162:163] neg_lo:[1,0,0] neg_hi:[1,0,0]
    v_pk_fma_f32 v[164:165], v[92:93], v[156:157], v[164:165] neg_lo:[1,0,0] neg_hi:[1,0,0]
    v_pk_fma_f32 v[166:167], v[94:95], v[158:159], v[166:167] neg_lo:[1,0,0] neg_hi:[1,0,0]
    v_pk_fma_f32 v[168:169], v[88:89], v[108:109], v[168:169]
    v_pk_fma_f32 v[170:171], v[90:91], v[110:111], v[170:171]
    v_pk_fma_f32 v[172:173], v[92:93], v[140:141], v[172:173]
    v_pk_fma_f32 v[174:175], v[94:95], v[142:143], v[174:175]
    buffer_load_dwordx4 v6, s[16:19], s35 offen offset:3072 lds
    v_pk_mul_f32 v[160:161], v[160:161], v[30:31] op_sel:[0,1] op_sel_hi:[1,1]
    v_pk_mul_f32 v[162:163], v[162:163], v[30:31] op_sel:[0,1] op_sel_hi:[1,1]
    v_pk_mul_f32 v[164:165], v[164:165], v[30:31] op_sel:[0,1] op_sel_hi:[1,1]
    v_pk_mul_f32 v[166:167], v[166:167], v[30:31] op_sel:[0,1] op_sel_hi:[1,1]
    v_pk_mul_f32 v[168:169], v[168:169], v[30:31] op_sel:[0,1] op_sel_hi:[1,1]
    v_pk_mul_f32 v[170:171], v[170:171], v[30:31] op_sel:[0,1] op_sel_hi:[1,1]
    v_pk_mul_f32 v[172:173], v[172:173], v[30:31] op_sel:[0,1] op_sel_hi:[1,1]
    v_pk_mul_f32 v[174:175], v[174:175], v[30:31] op_sel:[0,1] op_sel_hi:[1,1]
    v_cvt_pk_bf16_f32 v248, v160, v161
    v_cvt_pk_bf16_f32 v249, v162, v163
    v_cvt_pk_bf16_f32 v250, v164, v165
    v_cvt_pk_bf16_f32 v251, v166, v167
    v_cvt_pk_bf16_f32 v252, -v168, -v169
    v_cvt_pk_bf16_f32 v253, -v170, -v171
    v_cvt_pk_bf16_f32 v254, -v172, -v173
    v_cvt_pk_bf16_f32 v255, -v174, -v175
    s_waitcnt vmcnt(8)
    s_mov_b32 s75, 0
P2_pf:
    v_cmp_gt_u32 vcc, 1, v56
    s_add_u32 s75, s75, 1
    s_nop 0
    s_cmp_eq_u64 vcc, 0
    s_cbranch_scc1 P2_pfok
    s_cmp_ge_u32 s75, 0x4000
    s_cbranch_scc1 P2_pfok
    s_sleep 1
    buffer_load_dword v56, v20, s[20:23], s72 offen sc1
    s_waitcnt vmcnt(0)
    s_branch P2_pf
P2_pfok:
    s_bfe_u32 s28, s86, 0x40000
    s_lshl_b32 s28, s28, 13
    s_add_u32 s28, s28, s33
    buffer_load_dwordx4 v[96:99], v1, s[20:23], s28 offen offset:0 sc1
    buffer_load_dwordx4 v[100:103], v1, s[20:23], s28 offen offset:1024 sc1
    buffer_load_dwordx4 v[104:107], v1, s[20:23], s28 offen offset:2048 sc1
    buffer_load_dwordx4 v[108:111], v1, s[20:23], s28 offen offset:3072 sc1
    buffer_load_dwordx4 v[112:115], v2, s[20:23], s28 offen offset:0 sc1
    buffer_load_dwordx4 v[116:119], v2, s[20:23], s28 offen offset:1024 sc1
    buffer_load_dwordx4 v[120:123], v2, s[20:23], s28 offen offset:2048 sc1
    buffer_load_dwordx4 v[124:127], v2, s[20:23], s28 offen offset:3072 sc1
    v_mov_b32 v57, 2
    s_mov_b64 exec, 1
    buffer_store_dword v57, off, s[20:23], s76 sc1
    s_mov_b64 exec, -1
    ds_read_b64_tr_b16 v[32:33], v7 offset:0
    ds_read_b64_tr_b16 v[34:35], v7 offset:2048
    ds_read_b64_tr_b16 v[36:37], v8 offset:0
    ds_read_b64_tr_b16 v[38:39], v8 offset:2048
    ds_read_b64_tr_b16 v[40:41], v9 offset:0
    ds_read_b64_tr_b16 v[42:43], v9 offset:2048
    s_bfe_u32 s28, s86, 0x40004
    s_lshl_b32 s28, s28, 13
    s_add_u32 s28, s28, s33
    buffer_load_dwordx4 v[128:131], v1, s[20:23], s28 offen offset:0 sc1
    buffer_load_dwordx4 v[132:135], v1, s[20:23], s28 offen offset:1024 sc1
    buffer_load_dwordx4 v[136:139], v1, s[20:23], s28 offen offset:2048 sc1
    buffer_load_dwordx4 v[140:143], v1, s[20:23], s28 offen offset:3072 sc1
    buffer_load_dwordx4 v[144:147], v2, s[20:23], s28 offen offset:0 sc1
    buffer_load_dwordx4 v[148:151], v2, s[20:23], s28 offen offset:1024 sc1
    buffer_load_dwordx4 v[152:155], v2, s[20:23], s28 offen offset:2048 sc1
    buffer_load_dwordx4 v[156:159], v2, s[20:23], s28 offen offset:3072 sc1
    s_waitcnt vmcnt(9)
    s_waitcnt lgkmcnt(4)
    v_mfma_f32_16x16x32_bf16 a[0:3], v[32:35], v[96:99], 0
    ds_read_b64_tr_b16 v[44:45], v10 offset:0
    v_mfma_f32_16x16x32_bf16 a[32:35], v[32:35], v[100:103], 0
    ds_read_b64_tr_b16 v[46:47], v10 offset:2048
    v_mfma_f32_16x16x32_bf16 a[64:67], v[32:35], v[104:107], 0
    s_bfe_u32 s30, s86, 0x40008
    v_mfma_f32_16x16x32_bf16 a[96:99], v[32:35], v[108:111], 0
    s_lshl_b32 s30, s30, 16
    v_mfma_f32_16x16x32_bf16 a[128:131], v[32:35], v[112:115], 0
    v_mfma_f32_16x16x32_bf16 a[160:163], v[32:35], v[116:119], 0
    s_bfe_u32 s28, s86, 0x40008
    v_mfma_f32_16x16x32_bf16 a[192:195], v[32:35], v[120:123], 0
    s_add_u32 s30, s30, s34
    v_mfma_f32_16x16x32_bf16 a[224:227], v[32:35], v[124:127], 0
    s_waitcnt lgkmcnt(4)
    v_mfma_f32_16x16x32_bf16 a[4:7], v[36:39], v[96:99], 0
    ds_read_b64_tr_b16 v[48:49], v11 offset:0
    v_mfma_f32_16x16x32_bf16 a[36:39], v[36:39], v[100:103], 0
    ds_read_b64_tr_b16 v[50:51], v11 offset:2048
    v_mfma_f32_16x16x32_bf16 a[68:71], v[36:39], v[104:107], 0
    s_add_u32 s35, s30, 32768
    v_mfma_f32_16x16x32_bf16 a[100:103], v[36:39], v[108:111], 0
    s_lshl_b32 s28, s28, 13
    v_mfma_f32_16x16x32_bf16 a[132:135], v[36:39], v[112:115], 0
    v_mfma_f32_16x16x32_bf16 a[164:167], v[36:39], v[116:119], 0
    s_add_u32 m0, s31, 16384
    v_mfma_f32_16x16x32_bf16 a[196:199], v[36:39], v[120:123], 0
    buffer_load_dwordx4 v3, s[16:19], s30 offen offset:0 lds
    v_mfma_f32_16x16x32_bf16 a[228:231], v[36:39], v[124:127], 0
    s_waitcnt lgkmcnt(4)
    v_mfma_f32_16x16x32_bf16 a[8:11], v[40:43], v[96:99], 0
    ds_read_b64_tr_b16 v[52:53], v12 offset:0
    v_mfma_f32_16x16x32_bf16 a[40:43], v[40:43], v[100:103], 0
    ds_read_b64_tr_b16 v[54:55], v12 offset:2048
    v_mfma_f32_16x16x32_bf16 a[72:75], v[40:43], v[104:107], 0
    s_add_u32 s28, s28, s33
    v_mfma_f32_16x16x32_bf16 a[104:107], v[40:43], v[108:111], 0
    buffer_load_dwordx4 v4, s[16:19], s30 offen offset:1024 lds
    v_mfma_f32_16x16x32_bf16 a[136:139], v[40:43], v[112:115], 0
    v_mfma_f32_16x16x32_bf16 a[168:171], v[40:43], v[116:119], 0
    buffer_load_dwordx4 v5, s[16:19], s30 offen offset:2048 lds
    v_mfma_f32_16x16x32_bf16 a[200:203], v[40:43], v[120:123], 0
    buffer_load_dwordx4 v[160:163], v1, s[20:23], s28 offen offset:0 sc1
    v_mfma_f32_16x16x32_bf16 a[232:235], v[40:43], v[124:127], 0
    s_waitcnt lgkmcnt(4)
    v_mfma_f32_16x16x32_bf16 a[12:15], v[44:47], v[96:99], 0
    ds_read_b64_tr_b16 v[56:57], v13 offset:0
    v_mfma_f32_16x16x32_bf16 a[44:47], v[44:47], v[100:103], 0
    ds_read_b64_tr_b16 v[58:59], v13 offset:2048
    v_mfma_f32_16x16x32_bf16 a[76:79], v[44:47], v[104:107], 0
    buffer_load_dwordx4 v[164:167], v1, s[20:23], s28 offen offset:1024 sc1
    v_mfma_f32_16x16x32_bf16 a[108:111], v[44:47], v[108:111], 0
    buffer_load_dwordx4 v6, s[16:19], s30 offen offset:3072 lds
    v_mfma_f32_16x16x32_bf16 a[140:143], v[44:47], v[112:115], 0
    v_mfma_f32_16x16x32_bf16 a[172:175], v[44:47], v[116:119], 0
    s_add_u32 m0, s31, 20480
    v_mfma_f32_16x16x32_bf16 a[204:207], v[44:47], v[120:123], 0
    buffer_load_dwordx4 v[168:171], v1, s[20:23], s28 offen offset:2048 sc1
    v_mfma_f32_16x16x32_bf16 a[236:239], v[44:47], v[124:127], 0
    s_waitcnt lgkmcnt(4)
    v_mfma_f32_16x16x32_bf16 a[16:19], v[48:51], v[96:99], 0
    ds_read_b64_tr_b16 v[60:61], v14 offset:0
    v_mfma_f32_16x16x32_bf16 a[48:51], v[48:51], v[100:103], 0
    ds_read_b64_tr_b16 v[62:63], v14 offset:2048
    v_mfma_f32_16x16x32_bf16 a[80:83], v[48:51], v[104:107], 0
    buffer_load_dwordx4 v[172:175], v1, s[20:23], s28 offen offset:3072 sc1
    v_mfma_f32_16x16x32_bf16 a[112:115], v[48:51], v[108:111], 0
    buffer_load_dwordx4 v3, s[16:19], s35 offen offset:0 lds
    v_mfma_f32_16x16x32_bf16 a[144:147], v[48:51], v[112:115], 0
    v_mfma_f32_16x16x32_bf16 a[176:179], v[48:51], v[116:119], 0
    buffer_load_dwordx4 v4, s[16:19], s35 offen offset:1024 lds
    v_mfma_f32_16x16x32_bf16 a[208:211], v[48:51], v[120:123], 0
    buffer_load_dwordx4 v[176:179], v2, s[20:23], s28 offen offset:0 sc1
    v_mfma_f32_16x16x32_bf16 a[240:243], v[48:51], v[124:127], 0
    s_waitcnt lgkmcnt(4)
    v_mfma_f32_16x16x32_bf16 a[20:23], v[52:55], v[96:99], 0
    s_waitcnt vmcnt(28)
    v_mfma_f32_16x16x32_bf16 a[52:55], v[52:55], v[100:103], 0
    ds_read_b64_tr_b16 v[32:33], v7 offset:8192
    v_mfma_f32_16x16x32_bf16 a[84:87], v[52:55], v[104:107], 0
    ds_read_b64_tr_b16 v[34:35], v7 offset:10240
    v_mfma_f32_16x16x32_bf16 a[116:119], v[52:55], v[108:111], 0
    buffer_load_dwordx4 v[180:183], v2, s[20:23], s28 offen offset:1024 sc1
    v_mfma_f32_16x16x32_bf16 a[148:151], v[52:55], v[112:115], 0
    buffer_load_dwordx4 v5, s[16:19], s35 offen offset:2048 lds
    v_mfma_f32_16x16x32_bf16 a[180:183], v[52:55], v[116:119], 0
    buffer_load_dwordx4 v6, s[16:19], s35 offen offset:3072 lds
    v_mfma_f32_16x16x32_bf16 a[212:215], v[52:55], v[120:123], 0
    buffer_load_dwordx4 v[184:187], v2, s[20:23], s28 offen offset:2048 sc1
    v_mfma_f32_16x16x32_bf16 a[244:247], v[52:55], v[124:127], 0
    s_waitcnt lgkmcnt(4)
    v_mfma_f32_16x16x32_bf16 a[24:27], v[56:59], v[96:99], 0
    ds_read_b64_tr_b16 v[36:37], v8 offset:8192
    v_mfma_f32_16x16x32_bf16 a[56:59], v[56:59], v[100:103], 0
    ds_read_b64_tr_b16 v[38:39], v8 offset:10240
    v_mfma_f32_16x16x32_bf16 a[88:91], v[56:59], v[104:107], 0
    buffer_load_dwordx4 v[188:191], v2, s[20:23], s28 offen offset:3072 sc1
    v_mfma_f32_16x16x32_bf16 a[120:123], v[56:59], v[108:111], 0
    v_mfma_f32_16x16x32_bf16 a[152:155], v[56:59], v[112:115], 0
    v_mfma_f32_16x16x32_bf16 a[184:187], v[56:59], v[116:119], 0
    v_mfma_f32_16x16x32_bf16 a[216:219], v[56:59], v[120:123], 0
    v_mfma_f32_16x16x32_bf16 a[248:251], v[56:59], v[124:127], 0
    s_waitcnt lgkmcnt(4)
    v_mfma_f32_16x16x32_bf16 a[28:31], v[60:63], v[96:99], 0
    ds_read_b64_tr_b16 v[40:41], v9 offset:8192
    v_mfma_f32_16x16x32_bf16 a[60:63], v[60:63], v[100:103], 0
    ds_read_b64_tr_b16 v[42:43], v9 offset:10240
    v_mfma_f32_16x16x32_bf16 a[92:95], v[60:63], v[104:107], 0
    v_mfma_f32_16x16x32_bf16 a[124:127], v[60:63], v[108:111], 0
    v_mfma_f32_16x16x32_bf16 a[156:159], v[60:63], v[112:115], 0
    v_mfma_f32_16x16x32_bf16 a[188:191], v[60:63], v[116:119], 0
    v_mfma_f32_16x16x32_bf16 a[220:223], v[60:63], v[120:123], 0
    v_mfma_f32_16x16x32_bf16 a[252:255], v[60:63], v[124:127], 0
    s_waitcnt vmcnt(16)
    s_waitcnt lgkmcnt(4)
    v_mfma_f32_16x16x32_bf16 a[0:3], v[32:35], v[128:131], a[0:3]
    ds_read_b64_tr_b16 v[44:45], v10 offset:8192
    v_mfma_f32_16x16x32_bf16 a[32:35], v[32:35], v[132:135], a[32:35]
    ds_read_b64_tr_b16 v[46:47], v10 offset:10240
    v_mfma_f32_16x16x32_bf16 a[64:67], v[32:35], v[136:139], a[64:67]
    buffer_store_dwordx4 v[224:227], v27, s[20:23], s70 offen offset:0 sc1
    v_mfma_f32_16x16x32_bf16 a[96:99], v[32:35], v[140:143], a[96:99]
    buffer_store_dwordx4 v[228:231], v27, s[20:23], s71 offen offset:0 sc1
    v_mfma_f32_16x16x32_bf16 a[128:131], v[32:35], v[144:147], a[128:131]
    v_mfma_f32_16x16x32_bf16 a[160:163], v[32:35], v[148:151], a[160:163]
    s_bfe_u32 s30, s86, 0x4000c
    v_mfma_f32_16x16x32_bf16 a[192:195], v[32:35], v[152:155], a[192:195]
    s_lshl_b32 s30, s30, 16
    v_mfma_f32_16x16x32_bf16 a[224:227], v[32:35], v[156:159], a[224:227]
    s_waitcnt lgkmcnt(4)
    v_mfma_f32_16x16x32_bf16 a[4:7], v[36:39], v[128:131], a[4:7]
    ds_read_b64_tr_b16 v[48:49], v11 offset:8192
    v_mfma_f32_16x16x32_bf16 a[36:39], v[36:39], v[132:135], a[36:39]
    ds_read_b64_tr_b16 v[50:51], v11 offset:10240
    v_mfma_f32_16x16x32_bf16 a[68:71], v[36:39], v[136:139], a[68:71]
    s_bfe_u32 s28, s86, 0x4000c
    v_mfma_f32_16x16x32_bf16 a[100:103], v[36:39], v[140:143], a[100:103]
    s_add_u32 s30, s30, s34
    v_mfma_f32_16x16x32_bf16 a[132:135], v[36:39], v[144:147], a[132:135]
    v_mfma_f32_16x16x32_bf16 a[164:167], v[36:39], v[148:151], a[164:167]
    s_add_u32 s35, s30, 32768
    v_mfma_f32_16x16x32_bf16 a[196:199], v[36:39], v[152:155], a[196:199]
    s_lshl_b32 s28, s28, 13
    v_mfma_f32_16x16x32_bf16 a[228:231], v[36:39], v[156:159], a[228:231]
    s_waitcnt lgkmcnt(4)
    v_mfma_f32_16x16x32_bf16 a[8:11], v[40:43], v[128:131], a[8:11]
    ds_read_b64_tr_b16 v[52:53], v12 offset:8192
    v_mfma_f32_16x16x32_bf16 a[40:43], v[40:43], v[132:135], a[40:43]
    ds_read_b64_tr_b16 v[54:55], v12 offset:10240
    v_mfma_f32_16x16x32_bf16 a[72:75], v[40:43], v[136:139], a[72:75]
    s_add_u32 m0, s31, 24576
    v_mfma_f32_16x16x32_bf16 a[104:107], v[40:43], v[140:143], a[104:107]
    buffer_load_dwordx4 v3, s[16:19], s30 offen offset:0 lds
    v_mfma_f32_16x16x32_bf16 a[136:139], v[40:43], v[144:147], a[136:139]
    v_mfma_f32_16x16x32_bf16 a[168:171], v[40:43], v[148:151], a[168:171]
    s_add_u32 s28, s28, s33
    v_mfma_f32_16x16x32_bf16 a[200:203], v[40:43], v[152:155], a[200:203]
    buffer_load_dwordx4 v4, s[16:19], s30 offen offset:1024 lds
    v_mfma_f32_16x16x32_bf16 a[232:235], v[40:43], v[156:159], a[232:235]
    s_waitcnt lgkmcnt(4)
    v_mfma_f32_16x16x32_bf16 a[12:15], v[44:47], v[128:131], a[12:15]
    ds_read_b64_tr_b16 v[56:57], v13 offset:8192
    v_mfma_f32_16x16x32_bf16 a[44:47], v[44:47], v[132:135], a[44:47]
    ds_read_b64_tr_b16 v[58:59], v13 offset:10240
    v_mfma_f32_16x16x32_bf16 a[76:79], v[44:47], v[136:139], a[76:79]
    buffer_load_dwordx4 v5, s[16:19], s30 offen offset:2048 lds
    v_mfma_f32_16x16x32_bf16 a[108:111], v[44:47], v[140:143], a[108:111]
    buffer_load_dwordx4 v[192:195], v1, s[20:23], s28 offen offset:0 sc1
    v_mfma_f32_16x16x32_bf16 a[140:143], v[44:47], v[144:147], a[140:143]
    v_mfma_f32_16x16x32_bf16 a[172:175], v[44:47], v[148:151], a[172:175]
    buffer_load_dwordx4 v[196:199], v1, s[20:23], s28 offen offset:1024 sc1
    v_mfma_f32_16x16x32_bf16 a[204:207], v[44:47], v[152:155], a[204:207]
    buffer_load_dwordx4 v6, s[16:19], s30 offen offset:3072 lds
    v_mfma_f32_16x16x32_bf16 a[236:239], v[44:47], v[156:159], a[236:239]
    s_waitcnt lgkmcnt(4)
    v_mfma_f32_16x16x32_bf16 a[16:19], v[48:51], v[128:131], a[16:19]
    ds_read_b64_tr_b16 v[60:61], v14 offset:8192
    v_mfma_f32_16x16x32_bf16 a[48:51], v[48:51], v[132:135], a[48:51]
    ds_read_b64_tr_b16 v[62:63], v14 offset:10240
    v_mfma_f32_16x16x32_bf16 a[80:83], v[48:51], v[136:139], a[80:83]
    s_add_u32 m0, s31, 28672
    v_mfma_f32_16x16x32_bf16 a[112:115], v[48:51], v[140:143], a[112:115]
    buffer_load_dwordx4 v[200:203], v1, s[20:23], s28 offen offset:2048 sc1
    v_mfma_f32_16x16x32_bf16 a[144:147], v[48:51], v[144:147], a[144:147]
    v_mfma_f32_16x16x32_bf16 a[176:179], v[48:51], v[148:151], a[176:179]
    buffer_load_dwordx4 v[204:207], v1, s[20:23], s28 offen offset:3072 sc1
    v_mfma_f32_16x16x32_bf16 a[208:211], v[48:51], v[152:155], a[208:211]
    buffer_load_dwordx4 v3, s[16:19], s35 offen offset:0 lds
    v_mfma_f32_16x16x32_bf16 a[240:243], v[48:51], v[156:159], a[240:243]
    s_waitcnt lgkmcnt(4)
    v_mfma_f32_16x16x32_bf16 a[20:23], v[52:55], v[128:131], a[20:23]
    s_waitcnt vmcnt(13)
    v_mfma_f32_16x16x32_bf16 a[52:55], v[52:55], v[132:135], a[52:55]
    ds_read_b64_tr_b16 v[32:33], v7 offset:16384
    v_mfma_f32_16x16x32_bf16 a[84:87], v[52:55], v[136:139], a[84:87]
    ds_read_b64_tr_b16 v[34:35], v7 offset:18432
    v_mfma_f32_16x16x32_bf16 a[116:119], v[52:55], v[140:143], a[116:119]
    buffer_load_dwordx4 v4, s[16:19], s35 offen offset:1024 lds
    v_mfma_f32_16x16x32_bf16 a[148:151], v[52:55], v[144:147], a[148:151]
    buffer_load_dwordx4 v[208:211], v2, s[20:23], s28 offen offset:0 sc1
    v_mfma_f32_16x16x32_bf16 a[180:183], v[52:55], v[148:151], a[180:183]
    buffer_load_dwordx4 v[212:215], v2, s[20:23], s28 offen offset:1024 sc1
    v_mfma_f32_16x16x32_bf16 a[212:215], v[52:55], v[152:155], a[212:215]
    buffer_load_dwordx4 v5, s[16:19], s35 offen offset:2048 lds
    v_mfma_f32_16x16x32_bf16 a[244:247], v[52:55], v[156:159], a[244:247]
    s_waitcnt lgkmcnt(4)
    v_mfma_f32_16x16x32_bf16 a[24:27], v[56:59], v[128:131], a[24:27]
    ds_read_b64_tr_b16 v[36:37], v8 offset:16384
    v_mfma_f32_16x16x32_bf16 a[56:59], v[56:59], v[132:135], a[56:59]
    ds_read_b64_tr_b16 v[38:39], v8 offset:18432
    v_mfma_f32_16x16x32_bf16 a[88:91], v[56:59], v[136:139], a[88:91]
    buffer_load_dwordx4 v6, s[16:19], s35 offen offset:3072 lds
    v_mfma_f32_16x16x32_bf16 a[120:123], v[56:59], v[140:143], a[120:123]
    v_mfma_f32_16x16x32_bf16 a[152:155], v[56:59], v[144:147], a[152:155]
    buffer_load_dwordx4 v[216:219], v2, s[20:23], s28 offen offset:2048 sc1
    v_mfma_f32_16x16x32_bf16 a[184:187], v[56:59], v[148:151], a[184:187]
    v_mfma_f32_16x16x32_bf16 a[216:219], v[56:59], v[152:155], a[216:219]
    buffer_load_dwordx4 v[220:223], v2, s[20:23], s28 offen offset:3072 sc1
    v_mfma_f32_16x16x32_bf16 a[248:251], v[56:59], v[156:159], a[248:251]
    s_waitcnt lgkmcnt(4)
    v_mfma_f32_16x16x32_bf16 a[28:31], v[60:63], v[128:131], a[28:31]
    ds_read_b64_tr_b16 v[40:41], v9 offset:16384
    v_mfma_f32_16x16x32_bf16 a[60:63], v[60:63], v[132:135], a[60:63]
    ds_read_b64_tr_b16 v[42:43], v9 offset:18432
    v_mfma_f32_16x16x32_bf16 a[92:95], v[60:63], v[136:139], a[92:95]
    v_mfma_f32_16x16x32_bf16 a[124:127], v[60:63], v[140:143], a[124:127]
    v_mfma_f32_16x16x32_bf16 a[156:159], v[60:63], v[144:147], a[156:159]
    v_mfma_f32_16x16x32_bf16 a[188:191], v[60:63], v[148:151], a[188:191]
    v_mfma_f32_16x16x32_bf16 a[220:223], v[60:63], v[152:155], a[220:223]
    v_mfma_f32_16x16x32_bf16 a[252:255], v[60:63], v[156:159], a[252:255]
    s_waitcnt vmcnt(18)
    s_waitcnt lgkmcnt(4)
    v_mfma_f32_16x16x32_bf16 a[0:3], v[32:35], v[160:163], a[0:3]
    ds_read_b64_tr_b16 v[44:45], v10 offset:16384
    v_mfma_f32_16x16x32_bf16 a[32:35], v[32:35], v[164:167], a[32:35]
    ds_read_b64_tr_b16 v[46:47], v10 offset:18432
    v_mfma_f32_16x16x32_bf16 a[64:67], v[32:35], v[168:171], a[64:67]
    buffer_store_dwordx4 v[232:235], v27, s[20:23], s70 offen offset:1024 sc1
    v_mfma_f32_16x16x32_bf16 a[96:99], v[32:35], v[172:175], a[96:99]
    buffer_store_dwordx4 v[236:239], v27, s[20:23], s71 offen offset:1024 sc1
    v_mfma_f32_16x16x32_bf16 a[128:131], v[32:35], v[176:179], a[128:131]
    v_mfma_f32_16x16x32_bf16 a[160:163], v[32:35], v[180:183], a[160:163]
    s_bfe_u32 s30, s86, 0x40010
    v_mfma_f32_16x16x32_bf16 a[192:195], v[32:35], v[184:187], a[192:195]
    s_lshl_b32 s30, s30, 16
    v_mfma_f32_16x16x32_bf16 a[224:227], v[32:35], v[188:191], a[224:227]
    s_waitcnt lgkmcnt(4)
    v_mfma_f32_16x16x32_bf16 a[4:7], v[36:39], v[160:163], a[4:7]
    ds_read_b64_tr_b16 v[48:49], v11 offset:16384
    v_mfma_f32_16x16x32_bf16 a[36:39], v[36:39], v[164:167], a[36:39]
    ds_read_b64_tr_b16 v[50:51], v11 offset:18432
    v_mfma_f32_16x16x32_bf16 a[68:71], v[36:39], v[168:171], a[68:71]
    s_bfe_u32 s28, s86, 0x40010
    v_mfma_f32_16x16x32_bf16 a[100:103], v[36:39], v[172:175], a[100:103]
    s_add_u32 s30, s30, s34
    v_mfma_f32_16x16x32_bf16 a[132:135], v[36:39], v[176:179], a[132:135]
    v_mfma_f32_16x16x32_bf16 a[164:167], v[36:39], v[180:183], a[164:167]
    s_add_u32 s35, s30, 32768
    v_mfma_f32_16x16x32_bf16 a[196:199], v[36:39], v[184:187], a[196:199]
    s_lshl_b32 s28, s28, 13
    v_mfma_f32_16x16x32_bf16 a[228:231], v[36:39], v[188:191], a[228:231]
    s_waitcnt lgkmcnt(4)
    v_mfma_f32_16x16x32_bf16 a[8:11], v[40:43], v[160:163], a[8:11]
    ds_read_b64_tr_b16 v[52:53], v12 offset:16384
    v_mfma_f32_16x16x32_bf16 a[40:43], v[40:43], v[164:167], a[40:43]
    ds_read_b64_tr_b16 v[54:55], v12 offset:18432
    v_mfma_f32_16x16x32_bf16 a[72:75], v[40:43], v[168:171], a[72:75]
    s_add_u32 m0, s31, 32768
    v_mfma_f32_16x16x32_bf16 a[104:107], v[40:43], v[172:175], a[104:107]
    buffer_load_dwordx4 v3, s[16:19], s30 offen offset:0 lds
    v_mfma_f32_16x16x32_bf16 a[136:139], v[40:43], v[176:179], a[136:139]
    v_mfma_f32_16x16x32_bf16 a[168:171], v[40:43], v[180:183], a[168:171]
    s_add_u32 s28, s28, s33
    v_mfma_f32_16x16x32_bf16 a[200:203], v[40:43], v[184:187], a[200:203]
    buffer_load_dwordx4 v4, s[16:19], s30 offen offset:1024 lds
    v_mfma_f32_16x16x32_bf16 a[232:235], v[40:43], v[188:191], a[232:235]
    s_waitcnt lgkmcnt(4)
    v_mfma_f32_16x16x32_bf16 a[12:15], v[44:47], v[160:163], a[12:15]
    ds_read_b64_tr_b16 v[56:57], v13 offset:16384
    v_mfma_f32_16x16x32_bf16 a[44:47], v[44:47], v[164:167], a[44:47]
    ds_read_b64_tr_b16 v[58:59], v13 offset:18432
    v_mfma_f32_16x16x32_bf16 a[76:79], v[44:47], v[168:171], a[76:79]
    buffer_load_dwordx4 v5, s[16:19], s30 offen offset:2048 lds
    v_mfma_f32_16x16x32_bf16 a[108:111], v[44:47], v[172:175], a[108:111]
    buffer_load_dwordx4 v[96:99], v1, s[20:23], s28 offen offset:0 sc1
    v_mfma_f32_16x16x32_bf16 a[140:143], v[44:47], v[176:179], a[140:143]
    v_mfma_f32_16x16x32_bf16 a[172:175], v[44:47], v[180:183], a[172:175]
    buffer_load_dwordx4 v[100:103], v1, s[20:23], s28 offen offset:1024 sc1
    v_mfma_f32_16x16x32_bf16 a[204:207], v[44:47], v[184:187], a[204:207]
    buffer_load_dwordx4 v6, s[16:19], s30 offen offset:3072 lds
    v_mfma_f32_16x16x32_bf16 a[236:239], v[44:47], v[188:191], a[236:239]
    s_waitcnt lgkmcnt(4)
    v_mfma_f32_16x16x32_bf16 a[16:19], v[48:51], v[160:163], a[16:19]
    ds_read_b64_tr_b16 v[60:61], v14 offset:16384
    v_mfma_f32_16x16x32_bf16 a[48:51], v[48:51], v[164:167], a[48:51]
    ds_read_b64_tr_b16 v[62:63], v14 offset:18432
    v_mfma_f32_16x16x32_bf16 a[80:83], v[48:51], v[168:171], a[80:83]
    s_add_u32 m0, s31, 36864
    v_mfma_f32_16x16x32_bf16 a[112:115], v[48:51], v[172:175], a[112:115]
    buffer_load_dwordx4 v[104:107], v1, s[20:23], s28 offen offset:2048 sc1
    v_mfma_f32_16x16x32_bf16 a[144:147], v[48:51], v[176:179], a[144:147]
    v_mfma_f32_16x16x32_bf16 a[176:179], v[48:51], v[180:183], a[176:179]
    buffer_load_dwordx4 v[108:111], v1, s[20:23], s28 offen offset:3072 sc1
    v_mfma_f32_16x16x32_bf16 a[208:211], v[48:51], v[184:187], a[208:211]
    buffer_load_dwordx4 v3, s[16:19], s35 offen offset:0 lds
    v_mfma_f32_16x16x32_bf16 a[240:243], v[48:51], v[188:191], a[240:243]
    s_waitcnt lgkmcnt(4)
    v_mfma_f32_16x16x32_bf16 a[20:23], v[52:55], v[160:163], a[20:23]
    s_waitcnt vmcnt(13)
    v_mfma_f32_16x16x32_bf16 a[52:55], v[52:55], v[164:167], a[52:55]
    ds_read_b64_tr_b16 v[32:33], v7 offset:24576
    v_mfma_f32_16x16x32_bf16 a[84:87], v[52:55], v[168:171], a[84:87]
    ds_read_b64_tr_b16 v[34:35], v7 offset:26624
    v_mfma_f32_16x16x32_bf16 a[116:119], v[52:55], v[172:175], a[116:119]
    buffer_load_dwordx4 v4, s[16:19], s35 offen offset:1024 lds
    v_mfma_f32_16x16x32_bf16 a[148:151], v[52:55], v[176:179], a[148:151]
    buffer_load_dwordx4 v[112:115], v2, s[20:23], s28 offen offset:0 sc1
    v_mfma_f32_16x16x32_bf16 a[180:183], v[52:55], v[180:183], a[180:183]
    buffer_load_dwordx4 v[116:119], v2, s[20:23], s28 offen offset:1024 sc1
    v_mfma_f32_16x16x32_bf16 a[212:215], v[52:55], v[184:187], a[212:215]
    buffer_load_dwordx4 v5, s[16:19], s35 offen offset:2048 lds
    v_mfma_f32_16x16x32_bf16 a[244:247], v[52:55], v[188:191], a[244:247]
    s_waitcnt lgkmcnt(4)
    v_mfma_f32_16x16x32_bf16 a[24:27], v[56:59], v[160:163], a[24:27]
    ds_read_b64_tr_b16 v[36:37], v8 offset:24576
    v_mfma_f32_16x16x32_bf16 a[56:59], v[56:59], v[164:167], a[56:59]
    ds_read_b64_tr_b16 v[38:39], v8 offset:26624
    v_mfma_f32_16x16x32_bf16 a[88:91], v[56:59], v[168:171], a[88:91]
    buffer_load_dwordx4 v6, s[16:19], s35 offen offset:3072 lds
    v_mfma_f32_16x16x32_bf16 a[120:123], v[56:59], v[172:175], a[120:123]
    v_mfma_f32_16x16x32_bf16 a[152:155], v[56:59], v[176:179], a[152:155]
    buffer_load_dwordx4 v[120:123], v2, s[20:23], s28 offen offset:2048 sc1
    v_mfma_f32_16x16x32_bf16 a[184:187], v[56:59], v[180:183], a[184:187]
    v_mfma_f32_16x16x32_bf16 a[216:219], v[56:59], v[184:187], a[216:219]
    buffer_load_dwordx4 v[124:127], v2, s[20:23], s28 offen offset:3072 sc1
    v_mfma_f32_16x16x32_bf16 a[248:251], v[56:59], v[188:191], a[248:251]
    s_waitcnt lgkmcnt(4)
    v_mfma_f32_16x16x32_bf16 a[28:31], v[60:63], v[160:163], a[28:31]
    ds_read_b64_tr_b16 v[40:41], v9 offset:24576
    v_mfma_f32_16x16x32_bf16 a[60:63], v[60:63], v[164:167], a[60:63]
    ds_read_b64_tr_b16 v[42:43], v9 offset:26624
    v_mfma_f32_16x16x32_bf16 a[92:95], v[60:63], v[168:171], a[92:95]
    v_mfma_f32_16x16x32_bf16 a[124:127], v[60:63], v[172:175], a[124:127]
    v_mfma_f32_16x16x32_bf16 a[156:159], v[60:63], v[176:179], a[156:159]
    v_mfma_f32_16x16x32_bf16 a[188:191], v[60:63], v[180:183], a[188:191]
    v_mfma_f32_16x16x32_bf16 a[220:223], v[60:63], v[184:187], a[220:223]
    v_mfma_f32_16x16x32_bf16 a[252:255], v[60:63], v[188:191], a[252:255]
    s_waitcnt vmcnt(18)
    s_waitcnt lgkmcnt(4)
    v_mfma_f32_16x16x32_bf16 a[0:3], v[32:35], v[192:195], a[0:3]
    ds_read_b64_tr_b16 v[44:45], v10 offset:24576
    v_mfma_f32_16x16x32_bf16 a[32:35], v[32:35], v[196:199], a[32:35]
    ds_read_b64_tr_b16 v[46:47], v10 offset:26624
    v_mfma_f32_16x16x32_bf16 a[64:67], v[32:35], v[200:203], a[64:67]
    buffer_store_dwordx4 v[240:243], v27, s[20:23], s70 offen offset:2048 sc1
    v_mfma_f32_16x16x32_bf16 a[96:99], v[32:35], v[204:207], a[96:99]
    buffer_store_dwordx4 v[244:247], v27, s[20:23], s71 offen offset:2048 sc1
    v_mfma_f32_16x16x32_bf16 a[128:131], v[32:35], v[208:211], a[128:131]
    v_mfma_f32_16x16x32_bf16 a[160:163], v[32:35], v[212:215], a[160:163]
    s_bfe_u32 s30, s86, 0x40014
    v_mfma_f32_16x16x32_bf16 a[192:195], v[32:35], v[216:219], a[192:195]
    s_lshl_b32 s30, s30, 16
    v_mfma_f32_16x16x32_bf16 a[224:227], v[32:35], v[220:223], a[224:227]
    s_waitcnt lgkmcnt(4)
    v_mfma_f32_16x16x32_bf16 a[4:7], v[36:39], v[192:195], a[4:7]
    ds_read_b64_tr_b16 v[48:49], v11 offset:24576
    v_mfma_f32_16x16x32_bf16 a[36:39], v[36:39], v[196:199], a[36:39]
    ds_read_b64_tr_b16 v[50:51], v11 offset:26624
    v_mfma_f32_16x16x32_bf16 a[68:71], v[36:39], v[200:203], a[68:71]
    s_bfe_u32 s28, s86, 0x40014
    v_mfma_f32_16x16x32_bf16 a[100:103], v[36:39], v[204:207], a[100:103]
    s_add_u32 s30, s30, s34
    v_mfma_f32_16x16x32_bf16 a[132:135], v[36:39], v[208:211], a[132:135]
    v_mfma_f32_16x16x32_bf16 a[164:167], v[36:39], v[212:215], a[164:167]
    s_add_u32 s35, s30, 32768
    v_mfma_f32_16x16x32_bf16 a[196:199], v[36:39], v[216:219], a[196:199]
    s_lshl_b32 s28, s28, 13
    v_mfma_f32_16x16x32_bf16 a[228:231], v[36:39], v[220:223], a[228:231]
    s_waitcnt lgkmcnt(4)
    v_mfma_f32_16x16x32_bf16 a[8:11], v[40:43], v[192:195], a[8:11]
    ds_read_b64_tr_b16 v[52:53], v12 offset:24576
    v_mfma_f32_16x16x32_bf16 a[40:43], v[40:43], v[196:199], a[40:43]
    ds_read_b64_tr_b16 v[54:55], v12 offset:26624
    v_mfma_f32_16x16x32_bf16 a[72:75], v[40:43], v[200:203], a[72:75]
    s_add_u32 m0, s31, 0
    v_mfma_f32_16x16x32_bf16 a[104:107], v[40:43], v[204:207], a[104:107]
    buffer_load_dwordx4 v3, s[16:19], s30 offen offset:0 lds
    v_mfma_f32_16x16x32_bf16 a[136:139], v[40:43], v[208:211], a[136:139]
    v_mfma_f32_16x16x32_bf16 a[168:171], v[40:43], v[212:215], a[168:171]
    s_add_u32 s28, s28, s33
    v_mfma_f32_16x16x32_bf16 a[200:203], v[40:43], v[216:219], a[200:203]
    buffer_load_dwordx4 v4, s[16:19], s30 offen offset:1024 lds
    v_mfma_f32_16x16x32_bf16 a[232:235], v[40:43], v[220:223], a[232:235]
    s_waitcnt lgkmcnt(4)
    v_mfma_f32_16x16x32_bf16 a[12:15], v[44:47], v[192:195], a[12:15]
    ds_read_b64_tr_b16 v[56:57], v13 offset:24576
    v_mfma_f32_16x16x32_bf16 a[44:47], v[44:47], v[196:199], a[44:47]
    ds_read_b64_tr_b16 v[58:59], v13 offset:26624
    v_mfma_f32_16x16x32_bf16 a[76:79], v[44:47], v[200:203], a[76:79]
    buffer_load_dwordx4 v5, s[16:19], s30 offen offset:2048 lds
    v_mfma_f32_16x16x32_bf16 a[108:111], v[44:47], v[204:207], a[108:111]
    buffer_load_dwordx4 v[128:131], v1, s[20:23], s28 offen offset:0 sc1
    v_mfma_f32_16x16x32_bf16 a[140:143], v[44:47], v[208:211], a[140:143]
    v_mfma_f32_16x16x32_bf16 a[172:175], v[44:47], v[212:215], a[172:175]
    buffer_load_dwordx4 v[132:135], v1, s[20:23], s28 offen offset:1024 sc1
    v_mfma_f32_16x16x32_bf16 a[204:207], v[44:47], v[216:219], a[204:207]
    buffer_load_dwordx4 v6, s[16:19], s30 offen offset:3072 lds
    v_mfma_f32_16x16x32_bf16 a[236:239], v[44:47], v[220:223], a[236:239]
    s_waitcnt lgkmcnt(4)
    v_mfma_f32_16x16x32_bf16 a[16:19], v[48:51], v[192:195], a[16:19]
    ds_read_b64_tr_b16 v[60:61], v14 offset:24576
    v_mfma_f32_16x16x32_bf16 a[48:51], v[48:51], v[196:199], a[48:51]
    ds_read_b64_tr_b16 v[62:63], v14 offset:26624
    v_mfma_f32_16x16x32_bf16 a[80:83], v[48:51], v[200:203], a[80:83]
    s_add_u32 m0, s31, 4096
    v_mfma_f32_16x16x32_bf16 a[112:115], v[48:51], v[204:207], a[112:115]
    buffer_load_dwordx4 v[136:139], v1, s[20:23], s28 offen offset:2048 sc1
    v_mfma_f32_16x16x32_bf16 a[144:147], v[48:51], v[208:211], a[144:147]
    v_mfma_f32_16x16x32_bf16 a[176:179], v[48:51], v[212:215], a[176:179]
    buffer_load_dwordx4 v[140:143], v1, s[20:23], s28 offen offset:3072 sc1
    v_mfma_f32_16x16x32_bf16 a[208:211], v[48:51], v[216:219], a[208:211]
    buffer_load_dwordx4 v3, s[16:19], s35 offen offset:0 lds
    v_mfma_f32_16x16x32_bf16 a[240:243], v[48:51], v[220:223], a[240:243]
    s_waitcnt lgkmcnt(4)
    v_mfma_f32_16x16x32_bf16 a[20:23], v[52:55], v[192:195], a[20:23]
    s_waitcnt vmcnt(13)
    v_mfma_f32_16x16x32_bf16 a[52:55], v[52:55], v[196:199], a[52:55]
    ds_read_b64_tr_b16 v[32:33], v7 offset:32768
    v_mfma_f32_16x16x32_bf16 a[84:87], v[52:55], v[200:203], a[84:87]
    ds_read_b64_tr_b16 v[34:35], v7 offset:34816
    v_mfma_f32_16x16x32_bf16 a[116:119], v[52:55], v[204:207], a[116:119]
    buffer_load_dwordx4 v4, s[16:19], s35 offen offset:1024 lds
    v_mfma_f32_16x16x32_bf16 a[148:151], v[52:55], v[208:211], a[148:151]
    buffer_load_dwordx4 v[144:147], v2, s[20:23], s28 offen offset:0 sc1
    v_mfma_f32_16x16x32_bf16 a[180:183], v[52:55], v[212:215], a[180:183]
    buffer_load_dwordx4 v[148:151], v2, s[20:23], s28 offen offset:1024 sc1
    v_mfma_f32_16x16x32_bf16 a[212:215], v[52:55], v[216:219], a[212:215]
    buffer_load_dwordx4 v5, s[16:19], s35 offen offset:2048 lds
    v_mfma_f32_16x16x32_bf16 a[244:247], v[52:55], v[220:223], a[244:247]
    s_waitcnt lgkmcnt(4)
    v_mfma_f32_16x16x32_bf16 a[24:27], v[56:59], v[192:195], a[24:27]
    ds_read_b64_tr_b16 v[36:37], v8 offset:32768
    v_mfma_f32_16x16x32_bf16 a[56:59], v[56:59], v[196:199], a[56:59]
    ds_read_b64_tr_b16 v[38:39], v8 offset:34816
    v_mfma_f32_16x16x32_bf16 a[88:91], v[56:59], v[200:203], a[88:91]
    buffer_load_dwordx4 v6, s[16:19], s35 offen offset:3072 lds
    v_mfma_f32_16x16x32_bf16 a[120:123], v[56:59], v[204:207], a[120:123]
    v_mfma_f32_16x16x32_bf16 a[152:155], v[56:59], v[208:211], a[152:155]
    buffer_load_dwordx4 v[152:155], v2, s[20:23], s28 offen offset:2048 sc1
    v_mfma_f32_16x16x32_bf16 a[184:187], v[56:59], v[212:215], a[184:187]
    v_mfma_f32_16x16x32_bf16 a[216:219], v[56:59], v[216:219], a[216:219]
    buffer_load_dwordx4 v[156:159], v2, s[20:23], s28 offen offset:3072 sc1
    v_mfma_f32_16x16x32_bf16 a[248:251], v[56:59], v[220:223], a[248:251]
    s_waitcnt lgkmcnt(4)
    v_mfma_f32_16x16x32_bf16 a[28:31], v[60:63], v[192:195], a[28:31]
    ds_read_b64_tr_b16 v[40:41], v9 offset:32768
    v_mfma_f32_16x16x32_bf16 a[60:63], v[60:63], v[196:199], a[60:63]
    ds_read_b64_tr_b16 v[42:43], v9 offset:34816
    v_mfma_f32_16x16x32_bf16 a[92:95], v[60:63], v[200:203], a[92:95]
    v_mfma_f32_16x16x32_bf16 a[124:127], v[60:63], v[204:207], a[124:127]
    v_mfma_f32_16x16x32_bf16 a[156:159], v[60:63], v[208:211], a[156:159]
    v_mfma_f32_16x16x32_bf16 a[188:191], v[60:63], v[212:215], a[188:191]
    v_mfma_f32_16x16x32_bf16 a[220:223], v[60:63], v[216:219], a[220:223]
    v_mfma_f32_16x16x32_bf16 a[252:255], v[60:63], v[220:223], a[252:255]
CP_c:
    s_waitcnt vmcnt(18)
    s_waitcnt lgkmcnt(4)
    v_mfma_f32_16x16x32_bf16 a[0:3], v[32:35], v[96:99], a[0:3]
    ds_read_b64_tr_b16 v[44:45], v10 offset:32768
    v_mfma_f32_16x16x32_bf16 a[32:35], v[32:35], v[100:103], a[32:35]
    ds_read_b64_tr_b16 v[46:47], v10 offset:34816
    v_mfma_f32_16x16x32_bf16 a[64:67], v[32:35], v[104:107], a[64:67]
    buffer_store_dwordx4 v[248:251], v27, s[20:23], s70 offen offset:3072 sc1
    v_mfma_f32_16x16x32_bf16 a[96:99], v[32:35], v[108:111], a[96:99]
    buffer_store_dwordx4 v[252:255], v27, s[20:23], s71 offen offset:3072 sc1
    v_mfma_f32_16x16x32_bf16 a[128:131], v[32:35], v[112:115], a[128:131]
    v_mfma_f32_16x16x32_bf16 a[160:163], v[32:35], v[116:119], a[160:163]
    s_bfe_u32 s30, s86, 0x40018
    v_mfma_f32_16x16x32_bf16 a[192:195], v[32:35], v[120:123], a[192:195]
    s_lshl_b32 s30, s30, 16
    v_mfma_f32_16x16x32_bf16 a[224:227], v[32:35], v[124:127], a[224:227]
    s_waitcnt lgkmcnt(4)
    v_mfma_f32_16x16x32_bf16 a[4:7], v[36:39], v[96:99], a[4:7]
    ds_read_b64_tr_b16 v[48:49], v11 offset:32768
    v_mfma_f32_16x16x32_bf16 a[36:39], v[36:39], v[100:103], a[36:39]
    ds_read_b64_tr_b16 v[50:51], v11 offset:34816
    v_mfma_f32_16x16x32_bf16 a[68:71], v[36:39], v[104:107], a[68:71]
    s_bfe_u32 s28, s86, 0x40018
    v_mfma_f32_16x16x32_bf16 a[100:103], v[36:39], v[108:111], a[100:103]
    s_add_u32 s30, s30, s34
    v_mfma_f32_16x16x32_bf16 a[132:135], v[36:39], v[112:115], a[132:135]
    v_mfma_f32_16x16x32_bf16 a[164:167], v[36:39], v[116:119], a[164:167]
    s_add_u32 s35, s30, 32768
    v_mfma_f32_16x16x32_bf16 a[196:199], v[36:39], v[120:123], a[196:199]
    s_lshl_b32 s28, s28, 13
    v_mfma_f32_16x16x32_bf16 a[228:231], v[36:39], v[124:127], a[228:231]
    s_waitcnt lgkmcnt(4)
    v_mfma_f32_16x16x32_bf16 a[8:11], v[40:43], v[96:99], a[8:11]
    ds_read_b64_tr_b16 v[52:53], v12 offset:32768
    v_mfma_f32_16x16x32_bf16 a[40:43], v[40:43], v[100:103], a[40:43]
    ds_read_b64_tr_b16 v[54:55], v12 offset:34816
    v_mfma_f32_16x16x32_bf16 a[72:75], v[40:43], v[104:107], a[72:75]
    s_add_u32 m0, s31, 8192
    v_mfma_f32_16x16x32_bf16 a[104:107], v[40:43], v[108:111], a[104:107]
    buffer_load_dwordx4 v3, s[16:19], s30 offen offset:0 lds
    v_mfma_f32_16x16x32_bf16 a[136:139], v[40:43], v[112:115], a[136:139]
    v_mfma_f32_16x16x32_bf16 a[168:171], v[40:43], v[116:119], a[168:171]
    s_add_u32 s28, s28, s33
    v_mfma_f32_16x16x32_bf16 a[200:203], v[40:43], v[120:123], a[200:203]
    buffer_load_dwordx4 v4, s[16:19], s30 offen offset:1024 lds
    v_mfma_f32_16x16x32_bf16 a[232:235], v[40:43], v[124:127], a[232:235]
    s_waitcnt lgkmcnt(4)
    v_mfma_f32_16x16x32_bf16 a[12:15], v[44:47], v[96:99], a[12:15]
    ds_read_b64_tr_b16 v[56:57], v13 offset:32768
    v_mfma_f32_16x16x32_bf16 a[44:47], v[44:47], v[100:103], a[44:47]
    ds_read_b64_tr_b16 v[58:59], v13 offset:34816
    v_mfma_f32_16x16x32_bf16 a[76:79], v[44:47], v[104:107], a[76:79]
    buffer_load_dwordx4 v5, s[16:19], s30 offen offset:2048 lds
    v_mfma_f32_16x16x32_bf16 a[108:111], v[44:47], v[108:111], a[108:111]
    buffer_load_dwordx4 v[160:163], v1, s[20:23], s28 offen offset:0 sc1
    v_mfma_f32_16x16x32_bf16 a[140:143], v[44:47], v[112:115], a[140:143]
    v_mfma_f32_16x16x32_bf16 a[172:175], v[44:47], v[116:119], a[172:175]
    buffer_load_dwordx4 v[164:167], v1, s[20:23], s28 offen offset:1024 sc1
    v_mfma_f32_16x16x32_bf16 a[204:207], v[44:47], v[120:123], a[204:207]
    buffer_load_dwordx4 v6, s[16:19], s30 offen offset:3072 lds
    v_mfma_f32_16x16x32_bf16 a[236:239], v[44:47], v[124:127], a[236:239]
    s_waitcnt lgkmcnt(4)
    v_mfma_f32_16x16x32_bf16 a[16:19], v[48:51], v[96:99], a[16:19]
    ds_read_b64_tr_b16 v[60:61], v14 offset:32768
    v_mfma_f32_16x16x32_bf16 a[48:51], v[48:51], v[100:103], a[48:51]
    ds_read_b64_tr_b16 v[62:63], v14 offset:34816
    v_mfma_f32_16x16x32_bf16 a[80:83], v[48:51], v[104:107], a[80:83]
    s_add_u32 m0, s31, 12288
    v_mfma_f32_16x16x32_bf16 a[112:115], v[48:51], v[108:111], a[112:115]
    buffer_load_dwordx4 v[168:171], v1, s[20:23], s28 offen offset:2048 sc1
    v_mfma_f32_16x16x32_bf16 a[144:147], v[48:51], v[112:115], a[144:147]
    v_mfma_f32_16x16x32_bf16 a[176:179], v[48:51], v[116:119], a[176:179]
    buffer_load_dwordx4 v[172:175], v1, s[20:23], s28 offen offset:3072 sc1
    v_mfma_f32_16x16x32_bf16 a[208:211], v[48:51], v[120:123], a[208:211]
    buffer_load_dwordx4 v3, s[16:19], s35 offen offset:0 lds
    v_mfma_f32_16x16x32_bf16 a[240:243], v[48:51], v[124:127], a[240:243]
    s_waitcnt lgkmcnt(4)
    v_mfma_f32_16x16x32_bf16 a[20:23], v[52:55], v[96:99], a[20:23]
    s_waitcnt vmcnt(13)
    v_mfma_f32_16x16x32_bf16 a[52:55], v[52:55], v[100:103], a[52:55]
    ds_read_b64_tr_b16 v[32:33], v7 offset:0
    v_mfma_f32_16x16x32_bf16 a[84:87], v[52:55], v[104:107], a[84:87]
    ds_read_b64_tr_b16 v[34:35], v7 offset:2048
    v_mfma_f32_16x16x32_bf16 a[116:119], v[52:55], v[108:111], a[116:119]
    buffer_load_dwordx4 v4, s[16:19], s35 offen offset:1024 lds
    v_mfma_f32_16x16x32_bf16 a[148:151], v[52:55], v[112:115], a[148:151]
    buffer_load_dwordx4 v[176:179], v2, s[20:23], s28 offen offset:0 sc1
    v_mfma_f32_16x16x32_bf16 a[180:183], v[52:55], v[116:119], a[180:183]
    buffer_load_dwordx4 v[180:183], v2, s[20:23], s28 offen offset:1024 sc1
    v_mfma_f32_16x16x32_bf16 a[212:215], v[52:55], v[120:123], a[212:215]
    buffer_load_dwordx4 v5, s[16:19], s35 offen offset:2048 lds
    v_mfma_f32_16x16x32_bf16 a[244:247], v[52:55], v[124:127], a[244:247]
    s_waitcnt lgkmcnt(4)
    v_mfma_f32_16x16x32_bf16 a[24:27], v[56:59], v[96:99], a[24:27]
    ds_read_b64_tr_b16 v[36:37], v8 offset:0
    v_mfma_f32_16x16x32_bf16 a[56:59], v[56:59], v[100:103], a[56:59]
    ds_read_b64_tr_b16 v[38:39], v8 offset:2048
    v_mfma_f32_16x16x32_bf16 a[88:91], v[56:59], v[104:107], a[88:91]
    buffer_load_dwordx4 v6, s[16:19], s35 offen offset:3072 lds
    v_mfma_f32_16x16x32_bf16 a[120:123], v[56:59], v[108:111], a[120:123]
    v_mfma_f32_16x16x32_bf16 a[152:155], v[56:59], v[112:115], a[152:155]
    buffer_load_dwordx4 v[184:187], v2, s[20:23], s28 offen offset:2048 sc1
    v_mfma_f32_16x16x32_bf16 a[184:187], v[56:59], v[116:119], a[184:187]
    v_mfma_f32_16x16x32_bf16 a[216:219], v[56:59], v[120:123], a[216:219]
    buffer_load_dwordx4 v[188:191], v2, s[20:23], s28 offen offset:3072 sc1
    v_mfma_f32_16x16x32_bf16 a[248:251], v[56:59], v[124:127], a[248:251]
    s_waitcnt lgkmcnt(4)
    v_mfma_f32_16x16x32_bf16 a[28:31], v[60:63], v[96:99], a[28:31]
    ds_read_b64_tr_b16 v[40:41], v9 offset:0
    v_mfma_f32_16x16x32_bf16 a[60:63], v[60:63], v[100:103], a[60:63]
    ds_read_b64_tr_b16 v[42:43], v9 offset:2048
    v_mfma_f32_16x16x32_bf16 a[92:95], v[60:63], v[104:107], a[92:95]
    v_mfma_f32_16x16x32_bf16 a[124:127], v[60:63], v[108:111], a[124:127]
    v_mfma_f32_16x16x32_bf16 a[156:159], v[60:63], v[112:115], a[156:159]
    v_mfma_f32_16x16x32_bf16 a[188:191], v[60:63], v[116:119], a[188:191]
    v_mfma_f32_16x16x32_bf16 a[220:223], v[60:63], v[120:123], a[220:223]
    v_mfma_f32_16x16x32_bf16 a[252:255], v[60:63], v[124:127], a[252:255]
    s_waitcnt vmcnt(18)
    buffer_load_dword v21, v20, s[20:23], s72 offen sc1
    s_waitcnt lgkmcnt(4)
    v_mfma_f32_16x16x32_bf16 a[0:3], v[32:35], v[128:131], a[0:3]
    ds_read_b64_tr_b16 v[44:45], v10 offset:0
    v_mfma_f32_16x16x32_bf16 a[32:35], v[32:35], v[132:135], a[32:35]
    ds_read_b64_tr_b16 v[46:47], v10 offset:2048
    v_mfma_f32_16x16x32_bf16 a[64:67], v[32:35], v[136:139], a[64:67]
    s_bfe_u32 s30, s86, 0x4001c
    v_mfma_f32_16x16x32_bf16 a[96:99], v[32:35], v[140:143], a[96:99]
    s_lshl_b32 s30, s30, 16
    v_mfma_f32_16x16x32_bf16 a[128:131], v[32:35], v[144:147], a[128:131]
    v_mfma_f32_16x16x32_bf16 a[160:163], v[32:35], v[148:151], a[160:163]
    s_bfe_u32 s28, s86, 0x4001c
    v_mfma_f32_16x16x32_bf16 a[192:195], v[32:35], v[152:155], a[192:195]
    s_add_u32 s30, s30, s34
    v_mfma_f32_16x16x32_bf16 a[224:227], v[32:35], v[156:159], a[224:227]
    s_waitcnt lgkmcnt(4)
    v_mfma_f32_16x16x32_bf16 a[4:7], v[36:39], v[128:131], a[4:7]
    ds_read_b64_tr_b16 v[48:49], v11 offset:0
    v_mfma_f32_16x16x32_bf16 a[36:39], v[36:39], v[132:135], a[36:39]
    ds_read_b64_tr_b16 v[50:51], v11 offset:2048
    v_mfma_f32_16x16x32_bf16 a[68:71], v[36:39], v[136:139], a[68:71]
    s_add_u32 s35, s30, 32768
    v_mfma_f32_16x16x32_bf16 a[100:103], v[36:39], v[140:143], a[100:103]
    s_lshl_b32 s28, s28, 13
    v_mfma_f32_16x16x32_bf16 a[132:135], v[36:39], v[144:147], a[132:135]
    v_mfma_f32_16x16x32_bf16 a[164:167], v[36:39], v[148:151], a[164:167]
    s_add_u32 m0, s31, 16384
    v_mfma_f32_16x16x32_bf16 a[196:199], v[36:39], v[152:155], a[196:199]
    buffer_load_dwordx4 v3, s[16:19], s30 offen offset:0 lds
    v_mfma_f32_16x16x32_bf16 a[228:231], v[36:39], v[156:159], a[228:231]
    s_waitcnt lgkmcnt(4)
    v_mfma_f32_16x16x32_bf16 a[8:11], v[40:43], v[128:131], a[8:11]
    ds_read_b64_tr_b16 v[52:53], v12 offset:0
    v_mfma_f32_16x16x32_bf16 a[40:43], v[40:43], v[132:135], a[40:43]
    ds_read_b64_tr_b16 v[54:55], v12 offset:2048
    v_mfma_f32_16x16x32_bf16 a[72:75], v[40:43], v[136:139], a[72:75]
    s_add_u32 s28, s28, s33
    v_mfma_f32_16x16x32_bf16 a[104:107], v[40:43], v[140:143], a[104:107]
    buffer_load_dwordx4 v4, s[16:19], s30 offen offset:1024 lds
    v_mfma_f32_16x16x32_bf16 a[136:139], v[40:43], v[144:147], a[136:139]
    v_mfma_f32_16x16x32_bf16 a[168:171], v[40:43], v[148:151], a[168:171]
    buffer_load_dwordx4 v5, s[16:19], s30 offen offset:2048 lds
    v_mfma_f32_16x16x32_bf16 a[200:203], v[40:43], v[152:155], a[200:203]
    buffer_load_dwordx4 v[192:195], v1, s[20:23], s28 offen offset:0 sc1
    v_mfma_f32_16x16x32_bf16 a[232:235], v[40:43], v[156:159], a[232:235]
    s_waitcnt lgkmcnt(4)
    v_mfma_f32_16x16x32_bf16 a[12:15], v[44:47], v[128:131], a[12:15]
    ds_read_b64_tr_b16 v[56:57], v13 offset:0
    v_mfma_f32_16x16x32_bf16 a[44:47], v[44:47], v[132:135], a[44:47]
    ds_read_b64_tr_b16 v[58:59], v13 offset:2048
    v_mfma_f32_16x16x32_bf16 a[76:79], v[44:47], v[136:139], a[76:79]
    buffer_load_dwordx4 v[196:199], v1, s[20:23], s28 offen offset:1024 sc1
    v_mfma_f32_16x16x32_bf16 a[108:111], v[44:47], v[140:143], a[108:111]
    buffer_load_dwordx4 v6, s[16:19], s30 offen offset:3072 lds
    v_mfma_f32_16x16x32_bf16 a[140:143], v[44:47], v[144:147], a[140:143]
    v_mfma_f32_16x16x32_bf16 a[172:175], v[44:47], v[148:151], a[172:175]
    s_add_u32 m0, s31, 20480
    v_mfma_f32_16x16x32_bf16 a[204:207], v[44:47], v[152:155], a[204:207]
    buffer_load_dwordx4 v[200:203], v1, s[20:23], s28 offen offset:2048 sc1
    v_mfma_f32_16x16x32_bf16 a[236:239], v[44:47], v[156:159], a[236:239]
    s_waitcnt lgkmcnt(4)
    v_mfma_f32_16x16x32_bf16 a[16:19], v[48:51], v[128:131], a[16:19]
    ds_read_b64_tr_b16 v[60:61], v14 offset:0
    v_mfma_f32_16x16x32_bf16 a[48:51], v[48:51], v[132:135], a[48:51]
    ds_read_b64_tr_b16 v[62:63], v14 offset:2048
    v_mfma_f32_16x16x32_bf16 a[80:83], v[48:51], v[136:139], a[80:83]
    buffer_load_dwordx4 v[204:207], v1, s[20:23], s28 offen offset:3072 sc1
    v_mfma_f32_16x16x32_bf16 a[112:115], v[48:51], v[140:143], a[112:115]
    buffer_load_dwordx4 v3, s[16:19], s35 offen offset:0 lds
    v_mfma_f32_16x16x32_bf16 a[144:147], v[48:51], v[144:147], a[144:147]
    v_mfma_f32_16x16x32_bf16 a[176:179], v[48:51], v[148:151], a[176:179]
    buffer_load_dwordx4 v4, s[16:19], s35 offen offset:1024 lds
    v_mfma_f32_16x16x32_bf16 a[208:211], v[48:51], v[152:155], a[208:211]
    buffer_load_dwordx4 v[208:211], v2, s[20:23], s28 offen offset:0 sc1
    v_mfma_f32_16x16x32_bf16 a[240:243], v[48:51], v[156:159], a[240:243]
    s_waitcnt lgkmcnt(4)
    v_mfma_f32_16x16x32_bf16 a[20:23], v[52:55], v[128:131], a[20:23]
    s_waitcnt vmcnt(14)
    v_mfma_f32_16x16x32_bf16 a[52:55], v[52:55], v[132:135], a[52:55]
    ds_read_b64_tr_b16 v[32:33], v7 offset:8192
    v_mfma_f32_16x16x32_bf16 a[84:87], v[52:55], v[136:139], a[84:87]
    ds_read_b64_tr_b16 v[34:35], v7 offset:10240
    v_mfma_f32_16x16x32_bf16 a[116:119], v[52:55], v[140:143], a[116:119]
    buffer_load_dwordx4 v[212:215], v2, s[20:23], s28 offen offset:1024 sc1
    v_mfma_f32_16x16x32_bf16 a[148:151], v[52:55], v[144:147], a[148:151]
    buffer_load_dwordx4 v5, s[16:19], s35 offen offset:2048 lds
    v_mfma_f32_16x16x32_bf16 a[180:183], v[52:55], v[148:151], a[180:183]
    buffer_load_dwordx4 v6, s[16:19], s35 offen offset:3072 lds
    v_mfma_f32_16x16x32_bf16 a[212:215], v[52:55], v[152:155], a[212:215]
    buffer_load_dwordx4 v[216:219], v2, s[20:23], s28 offen offset:2048 sc1
    v_mfma_f32_16x16x32_bf16 a[244:247], v[52:55], v[156:159], a[244:247]
    s_waitcnt lgkmcnt(4)
    v_mfma_f32_16x16x32_bf16 a[24:27], v[56:59], v[128:131], a[24:27]
    ds_read_b64_tr_b16 v[36:37], v8 offset:8192
    v_mfma_f32_16x16x32_bf16 a[56:59], v[56:59], v[132:135], a[56:59]
    ds_read_b64_tr_b16 v[38:39], v8 offset:10240
    v_mfma_f32_16x16x32_bf16 a[88:91], v[56:59], v[136:139], a[88:91]
    buffer_load_dwordx4 v[220:223], v2, s[20:23], s28 offen offset:3072 sc1
    v_mfma_f32_16x16x32_bf16 a[120:123], v[56:59], v[140:143], a[120:123]
    v_mfma_f32_16x16x32_bf16 a[152:155], v[56:59], v[144:147], a[152:155]
    v_mfma_f32_16x16x32_bf16 a[184:187], v[56:59], v[148:151], a[184:187]
    v_mfma_f32_16x16x32_bf16 a[216:219], v[56:59], v[152:155], a[216:219]
    v_mfma_f32_16x16x32_bf16 a[248:251], v[56:59], v[156:159], a[248:251]
    s_waitcnt lgkmcnt(4)
    v_mfma_f32_16x16x32_bf16 a[28:31], v[60:63], v[128:131], a[28:31]
    ds_read_b64_tr_b16 v[40:41], v9 offset:8192
    v_mfma_f32_16x16x32_bf16 a[60:63], v[60:63], v[132:135], a[60:63]
    ds_read_b64_tr_b16 v[42:43], v9 offset:10240
    v_mfma_f32_16x16x32_bf16 a[92:95], v[60:63], v[136:139], a[92:95]
    v_mfma_f32_16x16x32_bf16 a[124:127], v[60:63], v[140:143], a[124:127]
    v_mfma_f32_16x16x32_bf16 a[156:159], v[60:63], v[144:147], a[156:159]
    v_mfma_f32_16x16x32_bf16 a[188:191], v[60:63], v[148:151], a[188:191]
    v_mfma_f32_16x16x32_bf16 a[220:223], v[60:63], v[152:155], a[220:223]
    v_mfma_f32_16x16x32_bf16 a[252:255], v[60:63], v[156:159], a[252:255]
    s_waitcnt vmcnt(17)
    s_waitcnt vmcnt(16)
    s_mov_b32 s75, 0
P2_pg:
    v_cmp_gt_u32 vcc, 2, v21
    s_add_u32 s75, s75, 1
    s_nop 0
    s_cmp_eq_u64 vcc, 0
    s_cbranch_scc1 P2_pgok
    s_cmp_ge_u32 s75, 0x4000
    s_cbranch_scc1 P2_pgok
    s_sleep 1
    buffer_load_dword v21, v20, s[20:23], s72 offen sc1
    s_waitcnt vmcnt(0)
    s_branch P2_pg
P2_pgok:
    s_waitcnt lgkmcnt(4)
    v_mfma_f32_16x16x32_bf16 a[0:3], v[32:35], v[160:163], a[0:3]
    ds_read_b64_tr_b16 v[44:45], v10 offset:8192
    v_mfma_f32_16x16x32_bf16 a[32:35], v[32:35], v[164:167], a[32:35]
    ds_read_b64_tr_b16 v[46:47], v10 offset:10240
    v_mfma_f32_16x16x32_bf16 a[64:67], v[32:35], v[168:171], a[64:67]
    s_bfe_u32 s30, s87, 0x40000
    v_mfma_f32_16x16x32_bf16 a[96:99], v[32:35], v[172:175], a[96:99]
    s_lshl_b32 s30, s30, 16
    v_mfma_f32_16x16x32_bf16 a[128:131], v[32:35], v[176:179], a[128:131]
    v_mfma_f32_16x16x32_bf16 a[160:163], v[32:35], v[180:183], a[160:163]
    s_bfe_u32 s28, s87, 0x40000
    v_mfma_f32_16x16x32_bf16 a[192:195], v[32:35], v[184:187], a[192:195]
    s_add_u32 s30, s30, s34
    v_mfma_f32_16x16x32_bf16 a[224:227], v[32:35], v[188:191], a[224:227]
    s_waitcnt lgkmcnt(4)
    v_mfma_f32_16x16x32_bf16 a[4:7], v[36:39], v[160:163], a[4:7]
    ds_read_b64_tr_b16 v[48:49], v11 offset:8192
    v_mfma_f32_16x16x32_bf16 a[36:39], v[36:39], v[164:167], a[36:39]
    ds_read_b64_tr_b16 v[50:51], v11 offset:10240
    v_mfma_f32_16x16x32_bf16 a[68:71], v[36:39], v[168:171], a[68:71]
    s_add_u32 s35, s30, 32768
    v_mfma_f32_16x16x32_bf16 a[100:103], v[36:39], v[172:175], a[100:103]
    s_lshl_b32 s28, s28, 13
    v_mfma_f32_16x16x32_bf16 a[132:135], v[36:39], v[176:179], a[132:135]
    v_mfma_f32_16x16x32_bf16 a[164:167], v[36:39], v[180:183], a[164:167]
    s_add_u32 m0, s31, 24576
    v_mfma_f32_16x16x32_bf16 a[196:199], v[36:39], v[184:187], a[196:199]
    buffer_load_dwordx4 v3, s[16:19], s30 offen offset:0 lds
    v_mfma_f32_16x16x32_bf16 a[228:231], v[36:39], v[188:191], a[228:231]
    s_waitcnt lgkmcnt(4)
    v_mfma_f32_16x16x32_bf16 a[8:11], v[40:43], v[160:163], a[8:11]
    ds_read_b64_tr_b16 v[52:53], v12 offset:8192
    v_mfma_f32_16x16x32_bf16 a[40:43], v[40:43], v[164:167], a[40:43]
    ds_read_b64_tr_b16 v[54:55], v12 offset:10240
    v_mfma_f32_16x16x32_bf16 a[72:75], v[40:43], v[168:171], a[72:75]
    s_add_u32 s28, s28, s33
    v_mfma_f32_16x16x32_bf16 a[104:107], v[40:43], v[172:175], a[104:107]
    buffer_load_dwordx4 v4, s[16:19], s30 offen offset:1024 lds
    v_mfma_f32_16x16x32_bf16 a[136:139], v[40:43], v[176:179], a[136:139]
    v_mfma_f32_16x16x32_bf16 a[168:171], v[40:43], v[180:183], a[168:171]
    buffer_load_dwordx4 v5, s[16:19], s30 offen offset:2048 lds
    v_mfma_f32_16x16x32_bf16 a[200:203], v[40:43], v[184:187], a[200:203]
    buffer_load_dwordx4 v[96:99], v1, s[20:23], s28 offen offset:0 sc1
    v_mfma_f32_16x16x32_bf16 a[232:235], v[40:43], v[188:191], a[232:235]
    s_waitcnt lgkmcnt(4)
    v_mfma_f32_16x16x32_bf16 a[12:15], v[44:47], v[160:163], a[12:15]
    ds_read_b64_tr_b16 v[56:57], v13 offset:8192
    v_mfma_f32_16x16x32_bf16 a[44:47], v[44:47], v[164:167], a[44:47]
    ds_read_b64_tr_b16 v[58:59], v13 offset:10240
    v_mfma_f32_16x16x32_bf16 a[76:79], v[44:47], v[168:171], a[76:79]
    buffer_load_dwordx4 v[100:103], v1, s[20:23], s28 offen offset:1024 sc1
    v_mfma_f32_16x16x32_bf16 a[108:111], v[44:47], v[172:175], a[108:111]
    buffer_load_dwordx4 v6, s[16:19], s30 offen offset:3072 lds
    v_mfma_f32_16x16x32_bf16 a[140:143], v[44:47], v[176:179], a[140:143]
    v_mfma_f32_16x16x32_bf16 a[172:175], v[44:47], v[180:183], a[172:175]
    s_add_u32 m0, s31, 28672
    v_mfma_f32_16x16x32_bf16 a[204:207], v[44:47], v[184:187], a[204:207]
    buffer_load_dwordx4 v[104:107], v1, s[20:23], s28 offen offset:2048 sc1
    v_mfma_f32_16x16x32_bf16 a[236:239], v[44:47], v[188:191], a[236:239]
    s_waitcnt lgkmcnt(4)
    v_mfma_f32_16x16x32_bf16 a[16:19], v[48:51], v[160:163], a[16:19]
    ds_read_b64_tr_b16 v[60:61], v14 offset:8192
    v_mfma_f32_16x16x32_bf16 a[48:51], v[48:51], v[164:167], a[48:51]
    ds_read_b64_tr_b16 v[62:63], v14 offset:10240
    v_mfma_f32_16x16x32_bf16 a[80:83], v[48:51], v[168:171], a[80:83]
    buffer_load_dwordx4 v[108:111], v1, s[20:23], s28 offen offset:3072 sc1
    v_mfma_f32_16x16x32_bf16 a[112:115], v[48:51], v[172:175], a[112:115]
    buffer_load_dwordx4 v3, s[16:19], s35 offen offset:0 lds
    v_mfma_f32_16x16x32_bf16 a[144:147], v[48:51], v[176:179], a[144:147]
    v_mfma_f32_16x16x32_bf16 a[176:179], v[48:51], v[180:183], a[176:179]
    buffer_load_dwordx4 v4, s[16:19], s35 offen offset:1024 lds
    v_mfma_f32_16x16x32_bf16 a[208:211], v[48:51], v[184:187], a[208:211]
    buffer_load_dwordx4 v[112:115], v2, s[20:23], s28 offen offset:0 sc1
    v_mfma_f32_16x16x32_bf16 a[240:243], v[48:51], v[188:191], a[240:243]
    s_waitcnt lgkmcnt(4)
    v_mfma_f32_16x16x32_bf16 a[20:23], v[52:55], v[160:163], a[20:23]
    s_waitcnt vmcnt(13)
    v_mfma_f32_16x16x32_bf16 a[52:55], v[52:55], v[164:167], a[52:55]
    ds_read_b64_tr_b16 v[32:33], v7 offset:16384
    v_mfma_f32_16x16x32_bf16 a[84:87], v[52:55], v[168:171], a[84:87]
    ds_read_b64_tr_b16 v[34:35], v7 offset:18432
    v_mfma_f32_16x16x32_bf16 a[116:119], v[52:55], v[172:175], a[116:119]
    buffer_load_dwordx4 v[116:119], v2, s[20:23], s28 offen offset:1024 sc1
    v_mfma_f32_16x16x32_bf16 a[148:151], v[52:55], v[176:179], a[148:151]
    buffer_load_dwordx4 v5, s[16:19], s35 offen offset:2048 lds
    v_mfma_f32_16x16x32_bf16 a[180:183], v[52:55], v[180:183], a[180:183]
    buffer_load_dwordx4 v6, s[16:19], s35 offen offset:3072 lds
    v_mfma_f32_16x16x32_bf16 a[212:215], v[52:55], v[184:187], a[212:215]
    buffer_load_dwordx4 v[120:123], v2, s[20:23], s28 offen offset:2048 sc1
    v_mfma_f32_16x16x32_bf16 a[244:247], v[52:55], v[188:191], a[244:247]
    s_waitcnt lgkmcnt(4)
    v_mfma_f32_16x16x32_bf16 a[24:27], v[56:59], v[160:163], a[24:27]
    ds_read_b64_tr_b16 v[36:37], v8 offset:16384
    v_mfma_f32_16x16x32_bf16 a[56:59], v[56:59], v[164:167], a[56:59]
    ds_read_b64_tr_b16 v[38:39], v8 offset:18432
    v_mfma_f32_16x16x32_bf16 a[88:91], v[56:59], v[168:171], a[88:91]
    buffer_load_dwordx4 v[124:127], v2, s[20:23], s28 offen offset:3072 sc1
    v_mfma_f32_16x16x32_bf16 a[120:123], v[56:59], v[172:175], a[120:123]
    v_mfma_f32_16x16x32_bf16 a[152:155], v[56:59], v[176:179], a[152:155]
    v_mfma_f32_16x16x32_bf16 a[184:187], v[56:59], v[180:183], a[184:187]
    v_mfma_f32_16x16x32_bf16 a[216:219], v[56:59], v[184:187], a[216:219]
    v_mfma_f32_16x16x32_bf16 a[248:251], v[56:59], v[188:191], a[248:251]
    s_waitcnt lgkmcnt(4)
    v_mfma_f32_16x16x32_bf16 a[28:31], v[60:63], v[160:163], a[28:31]
    ds_read_b64_tr_b16 v[40:41], v9 offset:16384
    v_mfma_f32_16x16x32_bf16 a[60:63], v[60:63], v[164:167], a[60:63]
    ds_read_b64_tr_b16 v[42:43], v9 offset:18432
    v_mfma_f32_16x16x32_bf16 a[92:95], v[60:63], v[168:171], a[92:95]
    v_mfma_f32_16x16x32_bf16 a[124:127], v[60:63], v[172:175], a[124:127]
    v_mfma_f32_16x16x32_bf16 a[156:159], v[60:63], v[176:179], a[156:159]
    v_mfma_f32_16x16x32_bf16 a[188:191], v[60:63], v[180:183], a[188:191]
    v_mfma_f32_16x16x32_bf16 a[220:223], v[60:63], v[184:187], a[220:223]
    v_mfma_f32_16x16x32_bf16 a[252:255], v[60:63], v[188:191], a[252:255]
    s_waitcnt vmcnt(16)
    s_waitcnt vmcnt(49)
    s_add_u32 s7, s76, 0x20000
    s_mov_b64 exec, 1
    buffer_store_dword v26, off, s[20:23], s7 sc1
    s_mov_b64 exec, -1
    s_waitcnt lgkmcnt(4)
    v_mfma_f32_16x16x32_bf16 a[0:3], v[32:35], v[192:195], a[0:3]
    ds_read_b64_tr_b16 v[44:45], v10 offset:16384
    v_mfma_f32_16x16x32_bf16 a[32:35], v[32:35], v[196:199], a[32:35]
    ds_read_b64_tr_b16 v[46:47], v10 offset:18432
    v_mfma_f32_16x16x32_bf16 a[64:67], v[32:35], v[200:203], a[64:67]
    s_bfe_u32 s30, s87, 0x40004
    v_mfma_f32_16x16x32_bf16 a[96:99], v[32:35], v[204:207], a[96:99]
    s_lshl_b32 s30, s30, 16
    v_mfma_f32_16x16x32_bf16 a[128:131], v[32:35], v[208:211], a[128:131]
    v_mfma_f32_16x16x32_bf16 a[160:163], v[32:35], v[212:215], a[160:163]
    s_bfe_u32 s28, s87, 0x40004
    v_mfma_f32_16x16x32_bf16 a[192:195], v[32:35], v[216:219], a[192:195]
    s_add_u32 s30, s30, s34
    v_mfma_f32_16x16x32_bf16 a[224:227], v[32:35], v[220:223], a[224:227]
    s_waitcnt lgkmcnt(4)
    v_mfma_f32_16x16x32_bf16 a[4:7], v[36:39], v[192:195], a[4:7]
    ds_read_b64_tr_b16 v[48:49], v11 offset:16384
    v_mfma_f32_16x16x32_bf16 a[36:39], v[36:39], v[196:199], a[36:39]
    ds_read_b64_tr_b16 v[50:51], v11 offset:18432
    v_mfma_f32_16x16x32_bf16 a[68:71], v[36:39], v[200:203], a[68:71]
    s_add_u32 s35, s30, 32768
    v_mfma_f32_16x16x32_bf16 a[100:103], v[36:39], v[204:207], a[100:103]
    s_lshl_b32 s28, s28, 13
    v_mfma_f32_16x16x32_bf16 a[132:135], v[36:39], v[208:211], a[132:135]
    v_mfma_f32_16x16x32_bf16 a[164:167], v[36:39], v[212:215], a[164:167]
    s_add_u32 m0, s31, 32768
    v_mfma_f32_16x16x32_bf16 a[196:199], v[36:39], v[216:219], a[196:199]
    buffer_load_dwordx4 v3, s[16:19], s30 offen offset:0 lds
    v_mfma_f32_16x16x32_bf16 a[228:231], v[36:39], v[220:223], a[228:231]
    s_waitcnt lgkmcnt(4)
    v_mfma_f32_16x16x32_bf16 a[8:11], v[40:43], v[192:195], a[8:11]
    ds_read_b64_tr_b16 v[52:53], v12 offset:16384
    v_mfma_f32_16x16x32_bf16 a[40:43], v[40:43], v[196:199], a[40:43]
    ds_read_b64_tr_b16 v[54:55], v12 offset:18432
    v_mfma_f32_16x16x32_bf16 a[72:75], v[40:43], v[200:203], a[72:75]
    s_add_u32 s28, s28, s33
    v_mfma_f32_16x16x32_bf16 a[104:107], v[40:43], v[204:207], a[104:107]
    buffer_load_dwordx4 v4, s[16:19], s30 offen offset:1024 lds
    v_mfma_f32_16x16x32_bf16 a[136:139], v[40:43], v[208:211], a[136:139]
    v_mfma_f32_16x16x32_bf16 a[168:171], v[40:43], v[212:215], a[168:171]
    buffer_load_dwordx4 v5, s[16:19], s30 offen offset:2048 lds
    v_mfma_f32_16x16x32_bf16 a[200:203], v[40:43], v[216:219], a[200:203]
    buffer_load_dwordx4 v[128:131], v1, s[20:23], s28 offen offset:0 sc1
    v_mfma_f32_16x16x32_bf16 a[232:235], v[40:43], v[220:223], a[232:235]
    s_waitcnt lgkmcnt(4)
    v_mfma_f32_16x16x32_bf16 a[12:15], v[44:47], v[192:195], a[12:15]
    ds_read_b64_tr_b16 v[56:57], v13 offset:16384
    v_mfma_f32_16x16x32_bf16 a[44:47], v[44:47], v[196:199], a[44:47]
    ds_read_b64_tr_b16 v[58:59], v13 offset:18432
    v_mfma_f32_16x16x32_bf16 a[76:79], v[44:47], v[200:203], a[76:79]
    buffer_load_dwordx4 v[132:135], v1, s[20:23], s28 offen offset:1024 sc1
    v_mfma_f32_16x16x32_bf16 a[108:111], v[44:47], v[204:207], a[108:111]
    buffer_load_dwordx4 v6, s[16:19], s30 offen offset:3072 lds
    v_mfma_f32_16x16x32_bf16 a[140:143], v[44:47], v[208:211], a[140:143]
    v_mfma_f32_16x16x32_bf16 a[172:175], v[44:47], v[212:215], a[172:175]
    s_add_u32 m0, s31, 36864
    v_mfma_f32_16x16x32_bf16 a[204:207], v[44:47], v[216:219], a[204:207]
    buffer_load_dwordx4 v[136:139], v1, s[20:23], s28 offen offset:2048 sc1
    v_mfma_f32_16x16x32_bf16 a[236:239], v[44:47], v[220:223], a[236:239]
    s_waitcnt lgkmcnt(4)
    v_mfma_f32_16x16x32_bf16 a[16:19], v[48:51], v[192:195], a[16:19]
    ds_read_b64_tr_b16 v[60:61], v14 offset:16384
    v_mfma_f32_16x16x32_bf16 a[48:51], v[48:51], v[196:199], a[48:51]
    ds_read_b64_tr_b16 v[62:63], v14 offset:18432
    v_mfma_f32_16x16x32_bf16 a[80:83], v[48:51], v[200:203], a[80:83]
    buffer_load_dwordx4 v[140:143], v1, s[20:23], s28 offen offset:3072 sc1
    v_mfma_f32_16x16x32_bf16 a[112:115], v[48:51], v[204:207], a[112:115]
    buffer_load_dwordx4 v3, s[16:19], s35 offen offset:0 lds
    v_mfma_f32_16x16x32_bf16 a[144:147], v[48:51], v[208:211], a[144:147]
    v_mfma_f32_16x16x32_bf16 a[176:179], v[48:51], v[212:215], a[176:179]
    buffer_load_dwordx4 v4, s[16:19], s35 offen offset:1024 lds
    v_mfma_f32_16x16x32_bf16 a[208:211], v[48:51], v[216:219], a[208:211]
    buffer_load_dwordx4 v[144:147], v2, s[20:23], s28 offen offset:0 sc1
    v_mfma_f32_16x16x32_bf16 a[240:243], v[48:51], v[220:223], a[240:243]
    s_waitcnt lgkmcnt(4)
    v_mfma_f32_16x16x32_bf16 a[20:23], v[52:55], v[192:195], a[20:23]
    s_waitcnt vmcnt(14)
    v_mfma_f32_16x16x32_bf16 a[52:55], v[52:55], v[196:199], a[52:55]
    ds_read_b64_tr_b16 v[32:33], v7 offset:24576
    v_mfma_f32_16x16x32_bf16 a[84:87], v[52:55], v[200:203], a[84:87]
    ds_read_b64_tr_b16 v[34:35], v7 offset:26624
    v_mfma_f32_16x16x32_bf16 a[116:119], v[52:55], v[204:207], a[116:119]
    buffer_load_dwordx4 v[148:151], v2, s[20:23], s28 offen offset:1024 sc1
    v_mfma_f32_16x16x32_bf16 a[148:151], v[52:55], v[208:211], a[148:151]
    buffer_load_dwordx4 v5, s[16:19], s35 offen offset:2048 lds
    v_mfma_f32_16x16x32_bf16 a[180:183], v[52:55], v[212:215], a[180:183]
    buffer_load_dwordx4 v6, s[16:19], s35 offen offset:3072 lds
    v_mfma_f32_16x16x32_bf16 a[212:215], v[52:55], v[216:219], a[212:215]
    buffer_load_dwordx4 v[152:155], v2, s[20:23], s28 offen offset:2048 sc1
    v_mfma_f32_16x16x32_bf16 a[244:247], v[52:55], v[220:223], a[244:247]
    s_waitcnt lgkmcnt(4)
    v_mfma_f32_16x16x32_bf16 a[24:27], v[56:59], v[192:195], a[24:27]
    ds_read_b64_tr_b16 v[36:37], v8 offset:24576
    v_mfma_f32_16x16x32_bf16 a[56:59], v[56:59], v[196:199], a[56:59]
    ds_read_b64_tr_b16 v[38:39], v8 offset:26624
    v_mfma_f32_16x16x32_bf16 a[88:91], v[56:59], v[200:203], a[88:91]
    buffer_load_dwordx4 v[156:159], v2, s[20:23], s28 offen offset:3072 sc1
    v_mfma_f32_16x16x32_bf16 a[120:123], v[56:59], v[204:207], a[120:123]
    v_mfma_f32_16x16x32_bf16 a[152:155], v[56:59], v[208:211], a[152:155]
    v_mfma_f32_16x16x32_bf16 a[184:187], v[56:59], v[212:215], a[184:187]
    v_mfma_f32_16x16x32_bf16 a[216:219], v[56:59], v[216:219], a[216:219]
    v_mfma_f32_16x16x32_bf16 a[248:251], v[56:59], v[220:223], a[248:251]
    s_waitcnt lgkmcnt(4)
    v_mfma_f32_16x16x32_bf16 a[28:31], v[60:63], v[192:195], a[28:31]
    ds_read_b64_tr_b16 v[40:41], v9 offset:24576
    v_mfma_f32_16x16x32_bf16 a[60:63], v[60:63], v[196:199], a[60:63]
    ds_read_b64_tr_b16 v[42:43], v9 offset:26624
    v_mfma_f32_16x16x32_bf16 a[92:95], v[60:63], v[200:203], a[92:95]
    v_mfma_f32_16x16x32_bf16 a[124:127], v[60:63], v[204:207], a[124:127]
    v_mfma_f32_16x16x32_bf16 a[156:159], v[60:63], v[208:211], a[156:159]
    v_mfma_f32_16x16x32_bf16 a[188:191], v[60:63], v[212:215], a[188:191]
    v_mfma_f32_16x16x32_bf16 a[220:223], v[60:63], v[216:219], a[220:223]
    v_mfma_f32_16x16x32_bf16 a[252:255], v[60:63], v[220:223], a[252:255]
    s_waitcnt vmcnt(17)
    s_waitcnt lgkmcnt(4)
    v_mfma_f32_16x16x32_bf16 a[0:3], v[32:35], v[96:99], a[0:3]
    ds_read_b64_tr_b16 v[44:45], v10 offset:24576
    v_mfma_f32_16x16x32_bf16 a[32:35], v[32:35], v[100:103], a[32:35]
    ds_read_b64_tr_b16 v[46:47], v10 offset:26624
    v_mfma_f32_16x16x32_bf16 a[64:67], v[32:35], v[104:107], a[64:67]
    s_bfe_u32 s30, s87, 0x40008
    v_mfma_f32_16x16x32_bf16 a[96:99], v[32:35], v[108:111], a[96:99]
    s_lshl_b32 s30, s30, 16
    v_mfma_f32_16x16x32_bf16 a[128:131], v[32:35], v[112:115], a[128:131]
    v_mfma_f32_16x16x32_bf16 a[160:163], v[32:35], v[116:119], a[160:163]
    s_bfe_u32 s28, s87, 0x40008
    v_mfma_f32_16x16x32_bf16 a[192:195], v[32:35], v[120:123], a[192:195]
    s_add_u32 s30, s30, s34
    v_mfma_f32_16x16x32_bf16 a[224:227], v[32:35], v[124:127], a[224:227]
    s_waitcnt lgkmcnt(4)
    v_mfma_f32_16x16x32_bf16 a[4:7], v[36:39], v[96:99], a[4:7]
    ds_read_b64_tr_b16 v[48:49], v11 offset:24576
    v_mfma_f32_16x16x32_bf16 a[36:39], v[36:39], v[100:103], a[36:39]
    ds_read_b64_tr_b16 v[50:51], v11 offset:26624
    v_mfma_f32_16x16x32_bf16 a[68:71], v[36:39], v[104:107], a[68:71]
    s_add_u32 s35, s30, 32768
    v_mfma_f32_16x16x32_bf16 a[100:103], v[36:39], v[108:111], a[100:103]
    s_lshl_b32 s28, s28, 13
    v_mfma_f32_16x16x32_bf16 a[132:135], v[36:39], v[112:115], a[132:135]
    v_mfma_f32_16x16x32_bf16 a[164:167], v[36:39], v[116:119], a[164:167]
    s_add_u32 m0, s31, 0
    v_mfma_f32_16x16x32_bf16 a[196:199], v[36:39], v[120:123], a[196:199]
    buffer_load_dwordx4 v3, s[16:19], s30 offen offset:0 lds
    v_mfma_f32_16x16x32_bf16 a[228:231], v[36:39], v[124:127], a[228:231]
    s_waitcnt lgkmcnt(4)
    v_mfma_f32_16x16x32_bf16 a[8:11], v[40:43], v[96:99], a[8:11]
    ds_read_b64_tr_b16 v[52:53], v12 offset:24576
    v_mfma_f32_16x16x32_bf16 a[40:43], v[40:43], v[100:103], a[40:43]
    ds_read_b64_tr_b16 v[54:55], v12 offset:26624
    v_mfma_f32_16x16x32_bf16 a[72:75], v[40:43], v[104:107], a[72:75]
    s_add_u32 s28, s28, s33
    v_mfma_f32_16x16x32_bf16 a[104:107], v[40:43], v[108:111], a[104:107]
    buffer_load_dwordx4 v4, s[16:19], s30 offen offset:1024 lds
    v_mfma_f32_16x16x32_bf16 a[136:139], v[40:43], v[112:115], a[136:139]
    v_mfma_f32_16x16x32_bf16 a[168:171], v[40:43], v[116:119], a[168:171]
    buffer_load_dwordx4 v5, s[16:19], s30 offen offset:2048 lds
    v_mfma_f32_16x16x32_bf16 a[200:203], v[40:43], v[120:123], a[200:203]
    buffer_load_dwordx4 v[160:163], v1, s[20:23], s28 offen offset:0 sc1
    v_mfma_f32_16x16x32_bf16 a[232:235], v[40:43], v[124:127], a[232:235]
    s_waitcnt lgkmcnt(4)
    v_mfma_f32_16x16x32_bf16 a[12:15], v[44:47], v[96:99], a[12:15]
    ds_read_b64_tr_b16 v[56:57], v13 offset:24576
    v_mfma_f32_16x16x32_bf16 a[44:47], v[44:47], v[100:103], a[44:47]
    ds_read_b64_tr_b16 v[58:59], v13 offset:26624
    v_mfma_f32_16x16x32_bf16 a[76:79], v[44:47], v[104:107], a[76:79]
    buffer_load_dwordx4 v[164:167], v1, s[20:23], s28 offen offset:1024 sc1
    v_mfma_f32_16x16x32_bf16 a[108:111], v[44:47], v[108:111], a[108:111]
    buffer_load_dwordx4 v6, s[16:19], s30 offen offset:3072 lds
    v_mfma_f32_16x16x32_bf16 a[140:143], v[44:47], v[112:115], a[140:143]
    v_mfma_f32_16x16x32_bf16 a[172:175], v[44:47], v[116:119], a[172:175]
    s_add_u32 m0, s31, 4096
    v_mfma_f32_16x16x32_bf16 a[204:207], v[44:47], v[120:123], a[204:207]
    buffer_load_dwordx4 v[168:171], v1, s[20:23], s28 offen offset:2048 sc1
    v_mfma_f32_16x16x32_bf16 a[236:239], v[44:47], v[124:127], a[236:239]
    s_waitcnt lgkmcnt(4)
    v_mfma_f32_16x16x32_bf16 a[16:19], v[48:51], v[96:99], a[16:19]
    ds_read_b64_tr_b16 v[60:61], v14 offset:24576
    v_mfma_f32_16x16x32_bf16 a[48:51], v[48:51], v[100:103], a[48:51]
    ds_read_b64_tr_b16 v[62:63], v14 offset:26624
    v_mfma_f32_16x16x32_bf16 a[80:83], v[48:51], v[104:107], a[80:83]
    buffer_load_dwordx4 v[172:175], v1, s[20:23], s28 offen offset:3072 sc1
    v_mfma_f32_16x16x32_bf16 a[112:115], v[48:51], v[108:111], a[112:115]
    buffer_load_dwordx4 v3, s[16:19], s35 offen offset:0 lds
    v_mfma_f32_16x16x32_bf16 a[144:147], v[48:51], v[112:115], a[144:147]
    v_mfma_f32_16x16x32_bf16 a[176:179], v[48:51], v[116:119], a[176:179]
    buffer_load_dwordx4 v4, s[16:19], s35 offen offset:1024 lds
    v_mfma_f32_16x16x32_bf16 a[208:211], v[48:51], v[120:123], a[208:211]
    buffer_load_dwordx4 v[176:179], v2, s[20:23], s28 offen offset:0 sc1
    v_mfma_f32_16x16x32_bf16 a[240:243], v[48:51], v[124:127], a[240:243]
    s_waitcnt lgkmcnt(4)
    v_mfma_f32_16x16x32_bf16 a[20:23], v[52:55], v[96:99], a[20:23]
    s_waitcnt vmcnt(13)
    v_mfma_f32_16x16x32_bf16 a[52:55], v[52:55], v[100:103], a[52:55]
    ds_read_b64_tr_b16 v[32:33], v7 offset:32768
    v_mfma_f32_16x16x32_bf16 a[84:87], v[52:55], v[104:107], a[84:87]
    ds_read_b64_tr_b16 v[34:35], v7 offset:34816
    v_mfma_f32_16x16x32_bf16 a[116:119], v[52:55], v[108:111], a[116:119]
    buffer_load_dwordx4 v[180:183], v2, s[20:23], s28 offen offset:1024 sc1
    v_mfma_f32_16x16x32_bf16 a[148:151], v[52:55], v[112:115], a[148:151]
    buffer_load_dwordx4 v5, s[16:19], s35 offen offset:2048 lds
    v_mfma_f32_16x16x32_bf16 a[180:183], v[52:55], v[116:119], a[180:183]
    buffer_load_dwordx4 v6, s[16:19], s35 offen offset:3072 lds
    v_mfma_f32_16x16x32_bf16 a[212:215], v[52:55], v[120:123], a[212:215]
    buffer_load_dwordx4 v[184:187], v2, s[20:23], s28 offen offset:2048 sc1
    v_mfma_f32_16x16x32_bf16 a[244:247], v[52:55], v[124:127], a[244:247]
    s_waitcnt lgkmcnt(4)
    v_mfma_f32_16x16x32_bf16 a[24:27], v[56:59], v[96:99], a[24:27]
    ds_read_b64_tr_b16 v[36:37], v8 offset:32768
    v_mfma_f32_16x16x32_bf16 a[56:59], v[56:59], v[100:103], a[56:59]
    ds_read_b64_tr_b16 v[38:39], v8 offset:34816
    v_mfma_f32_16x16x32_bf16 a[88:91], v[56:59], v[104:107], a[88:91]
    buffer_load_dwordx4 v[188:191], v2, s[20:23], s28 offen offset:3072 sc1
    v_mfma_f32_16x16x32_bf16 a[120:123], v[56:59], v[108:111], a[120:123]
    v_mfma_f32_16x16x32_bf16 a[152:155], v[56:59], v[112:115], a[152:155]
    v_mfma_f32_16x16x32_bf16 a[184:187], v[56:59], v[116:119], a[184:187]
    v_mfma_f32_16x16x32_bf16 a[216:219], v[56:59], v[120:123], a[216:219]
    v_mfma_f32_16x16x32_bf16 a[248:251], v[56:59], v[124:127], a[248:251]
    s_waitcnt lgkmcnt(4)
    v_mfma_f32_16x16x32_bf16 a[28:31], v[60:63], v[96:99], a[28:31]
    ds_read_b64_tr_b16 v[40:41], v9 offset:32768
    v_mfma_f32_16x16x32_bf16 a[60:63], v[60:63], v[100:103], a[60:63]
    ds_read_b64_tr_b16 v[42:43], v9 offset:34816
    v_mfma_f32_16x16x32_bf16 a[92:95], v[60:63], v[104:107], a[92:95]
    v_mfma_f32_16x16x32_bf16 a[124:127], v[60:63], v[108:111], a[124:127]
    v_mfma_f32_16x16x32_bf16 a[156:159], v[60:63], v[112:115], a[156:159]
    v_mfma_f32_16x16x32_bf16 a[188:191], v[60:63], v[116:119], a[188:191]
    v_mfma_f32_16x16x32_bf16 a[220:223], v[60:63], v[120:123], a[220:223]
    v_mfma_f32_16x16x32_bf16 a[252:255], v[60:63], v[124:127], a[252:255]
    s_waitcnt vmcnt(16)
    s_waitcnt lgkmcnt(4)
    v_mfma_f32_16x16x32_bf16 a[0:3], v[32:35], v[128:131], a[0:3]
    ds_read_b64_tr_b16 v[44:45], v10 offset:32768
    v_mfma_f32_16x16x32_bf16 a[32:35], v[32:35], v[132:135], a[32:35]
    ds_read_b64_tr_b16 v[46:47], v10 offset:34816
    v_mfma_f32_16x16x32_bf16 a[64:67], v[32:35], v[136:139], a[64:67]
    s_bfe_u32 s30, s87, 0x4000c
    v_mfma_f32_16x16x32_bf16 a[96:99], v[32:35], v[140:143], a[96:99]
    s_lshl_b32 s30, s30, 16
    v_mfma_f32_16x16x32_bf16 a[128:131], v[32:35], v[144:147], a[128:131]
    v_mfma_f32_16x16x32_bf16 a[160:163], v[32:35], v[148:151], a[160:163]
    s_bfe_u32 s28, s87, 0x4000c
    v_mfma_f32_16x16x32_bf16 a[192:195], v[32:35], v[152:155], a[192:195]
    s_add_u32 s30, s30, s34
    v_mfma_f32_16x16x32_bf16 a[224:227], v[32:35], v[156:159], a[224:227]
    s_waitcnt lgkmcnt(4)
    v_mfma_f32_16x16x32_bf16 a[4:7], v[36:39], v[128:131], a[4:7]
    ds_read_b64_tr_b16 v[48:49], v11 offset:32768
    v_mfma_f32_16x16x32_bf16 a[36:39], v[36:39], v[132:135], a[36:39]
    ds_read_b64_tr_b16 v[50:51], v11 offset:34816
    v_mfma_f32_16x16x32_bf16 a[68:71], v[36:39], v[136:139], a[68:71]
    s_add_u32 s35, s30, 32768
    v_mfma_f32_16x16x32_bf16 a[100:103], v[36:39], v[140:143], a[100:103]
    s_lshl_b32 s28, s28, 13
    v_mfma_f32_16x16x32_bf16 a[132:135], v[36:39], v[144:147], a[132:135]
    v_mfma_f32_16x16x32_bf16 a[164:167], v[36:39], v[148:151], a[164:167]
    s_add_u32 m0, s31, 8192
    v_mfma_f32_16x16x32_bf16 a[196:199], v[36:39], v[152:155], a[196:199]
    buffer_load_dwordx4 v3, s[16:19], s30 offen offset:0 lds
    v_mfma_f32_16x16x32_bf16 a[228:231], v[36:39], v[156:159], a[228:231]
    s_waitcnt lgkmcnt(4)
    v_mfma_f32_16x16x32_bf16 a[8:11], v[40:43], v[128:131], a[8:11]
    ds_read_b64_tr_b16 v[52:53], v12 offset:32768
    v_mfma_f32_16x16x32_bf16 a[40:43], v[40:43], v[132:135], a[40:43]
    ds_read_b64_tr_b16 v[54:55], v12 offset:34816
    v_mfma_f32_16x16x32_bf16 a[72:75], v[40:43], v[136:139], a[72:75]
    s_add_u32 s28, s28, s33
    v_mfma_f32_16x16x32_bf16 a[104:107], v[40:43], v[140:143], a[104:107]
    buffer_load_dwordx4 v4, s[16:19], s30 offen offset:1024 lds
    v_mfma_f32_16x16x32_bf16 a[136:139], v[40:43], v[144:147], a[136:139]
    v_mfma_f32_16x16x32_bf16 a[168:171], v[40:43], v[148:151], a[168:171]
    buffer_load_dwordx4 v5, s[16:19], s30 offen offset:2048 lds
    v_mfma_f32_16x16x32_bf16 a[200:203], v[40:43], v[152:155], a[200:203]
    buffer_load_dwordx4 v[192:195], v1, s[20:23], s28 offen offset:0 sc1
    v_mfma_f32_16x16x32_bf16 a[232:235], v[40:43], v[156:159], a[232:235]
    s_waitcnt lgkmcnt(4)
    v_mfma_f32_16x16x32_bf16 a[12:15], v[44:47], v[128:131], a[12:15]
    ds_read_b64_tr_b16 v[56:57], v13 offset:32768
    v_mfma_f32_16x16x32_bf16 a[44:47], v[44:47], v[132:135], a[44:47]
    ds_read_b64_tr_b16 v[58:59], v13 offset:34816
    v_mfma_f32_16x16x32_bf16 a[76:79], v[44:47], v[136:139], a[76:79]
    buffer_load_dwordx4 v[196:199], v1, s[20:23], s28 offen offset:1024 sc1
    v_mfma_f32_16x16x32_bf16 a[108:111], v[44:47], v[140:143], a[108:111]
    buffer_load_dwordx4 v6, s[16:19], s30 offen offset:3072 lds
    v_mfma_f32_16x16x32_bf16 a[140:143], v[44:47], v[144:147], a[140:143]
    v_mfma_f32_16x16x32_bf16 a[172:175], v[44:47], v[148:151], a[172:175]
    s_add_u32 m0, s31, 12288
    v_mfma_f32_16x16x32_bf16 a[204:207], v[44:47], v[152:155], a[204:207]
    buffer_load_dwordx4 v[200:203], v1, s[20:23], s28 offen offset:2048 sc1
    v_mfma_f32_16x16x32_bf16 a[236:239], v[44:47], v[156:159], a[236:239]
    s_waitcnt lgkmcnt(4)
    v_mfma_f32_16x16x32_bf16 a[16:19], v[48:51], v[128:131], a[16:19]
    ds_read_b64_tr_b16 v[60:61], v14 offset:32768
    v_mfma_f32_16x16x32_bf16 a[48:51], v[48:51], v[132:135], a[48:51]
    ds_read_b64_tr_b16 v[62:63], v14 offset:34816
    v_mfma_f32_16x16x32_bf16 a[80:83], v[48:51], v[136:139], a[80:83]
    buffer_load_dwordx4 v[204:207], v1, s[20:23], s28 offen offset:3072 sc1
    v_mfma_f32_16x16x32_bf16 a[112:115], v[48:51], v[140:143], a[112:115]
    buffer_load_dwordx4 v3, s[16:19], s35 offen offset:0 lds
    v_mfma_f32_16x16x32_bf16 a[144:147], v[48:51], v[144:147], a[144:147]
    v_mfma_f32_16x16x32_bf16 a[176:179], v[48:51], v[148:151], a[176:179]
    buffer_load_dwordx4 v4, s[16:19], s35 offen offset:1024 lds
    v_mfma_f32_16x16x32_bf16 a[208:211], v[48:51], v[152:155], a[208:211]
    buffer_load_dwordx4 v[208:211], v2, s[20:23], s28 offen offset:0 sc1
    v_mfma_f32_16x16x32_bf16 a[240:243], v[48:51], v[156:159], a[240:243]
    s_waitcnt lgkmcnt(4)
    v_mfma_f32_16x16x32_bf16 a[20:23], v[52:55], v[128:131], a[20:23]
    s_waitcnt vmcnt(13)
    v_mfma_f32_16x16x32_bf16 a[52:55], v[52:55], v[132:135], a[52:55]
    ds_read_b64_tr_b16 v[32:33], v7 offset:0
    v_mfma_f32_16x16x32_bf16 a[84:87], v[52:55], v[136:139], a[84:87]
    ds_read_b64_tr_b16 v[34:35], v7 offset:2048
    v_mfma_f32_16x16x32_bf16 a[116:119], v[52:55], v[140:143], a[116:119]
    buffer_load_dwordx4 v[212:215], v2, s[20:23], s28 offen offset:1024 sc1
    v_mfma_f32_16x16x32_bf16 a[148:151], v[52:55], v[144:147], a[148:151]
    buffer_load_dwordx4 v5, s[16:19], s35 offen offset:2048 lds
    v_mfma_f32_16x16x32_bf16 a[180:183], v[52:55], v[148:151], a[180:183]
    buffer_load_dwordx4 v6, s[16:19], s35 offen offset:3072 lds
    v_mfma_f32_16x16x32_bf16 a[212:215], v[52:55], v[152:155], a[212:215]
    buffer_load_dwordx4 v[216:219], v2, s[20:23], s28 offen offset:2048 sc1
    v_mfma_f32_16x16x32_bf16 a[244:247], v[52:55], v[156:159], a[244:247]
    s_waitcnt lgkmcnt(4)
    v_mfma_f32_16x16x32_bf16 a[24:27], v[56:59], v[128:131], a[24:27]
    ds_read_b64_tr_b16 v[36:37], v8 offset:0
    v_mfma_f32_16x16x32_bf16 a[56:59], v[56:59], v[132:135], a[56:59]
    ds_read_b64_tr_b16 v[38:39], v8 offset:2048
    v_mfma_f32_16x16x32_bf16 a[88:91], v[56:59], v[136:139], a[88:91]
    buffer_load_dwordx4 v[220:223], v2, s[20:23], s28 offen offset:3072 sc1
    v_mfma_f32_16x16x32_bf16 a[120:123], v[56:59], v[140:143], a[120:123]
    v_mfma_f32_16x16x32_bf16 a[152:155], v[56:59], v[144:147], a[152:155]
    v_mfma_f32_16x16x32_bf16 a[184:187], v[56:59], v[148:151], a[184:187]
    v_mfma_f32_16x16x32_bf16 a[216:219], v[56:59], v[152:155], a[216:219]
    v_mfma_f32_16x16x32_bf16 a[248:251], v[56:59], v[156:159], a[248:251]
    s_waitcnt lgkmcnt(4)
    v_mfma_f32_16x16x32_bf16 a[28:31], v[60:63], v[128:131], a[28:31]
    ds_read_b64_tr_b16 v[40:41], v9 offset:0
    v_mfma_f32_16x16x32_bf16 a[60:63], v[60:63], v[132:135], a[60:63]
    ds_read_b64_tr_b16 v[42:43], v9 offset:2048
    v_mfma_f32_16x16x32_bf16 a[92:95], v[60:63], v[136:139], a[92:95]
    v_mfma_f32_16x16x32_bf16 a[124:127], v[60:63], v[140:143], a[124:127]
    v_mfma_f32_16x16x32_bf16 a[156:159], v[60:63], v[144:147], a[156:159]
    v_mfma_f32_16x16x32_bf16 a[188:191], v[60:63], v[148:151], a[188:191]
    v_mfma_f32_16x16x32_bf16 a[220:223], v[60:63], v[152:155], a[220:223]
    v_mfma_f32_16x16x32_bf16 a[252:255], v[60:63], v[156:159], a[252:255]
    s_waitcnt vmcnt(16)
    v_mov_b32 v23, 1
    s_mov_b64 exec, 0xffffffff
    buffer_load_dword v23, v22, s[20:23], s73 offen sc1
    s_mov_b64 exec, -1
    s_waitcnt lgkmcnt(4)
    v_mfma_f32_16x16x32_bf16 a[0:3], v[32:35], v[160:163], a[0:3]
    ds_read_b64_tr_b16 v[44:45], v10 offset:0
    v_mfma_f32_16x16x32_bf16 a[32:35], v[32:35], v[164:167], a[32:35]
    ds_read_b64_tr_b16 v[46:47], v10 offset:2048
    v_mfma_f32_16x16x32_bf16 a[64:67], v[32:35], v[168:171], a[64:67]
    s_bfe_u32 s30, s87, 0x40010
    v_mfma_f32_16x16x32_bf16 a[96:99], v[32:35], v[172:175], a[96:99]
    s_lshl_b32 s30, s30, 16
    v_mfma_f32_16x16x32_bf16 a[128:131], v[32:35], v[176:179], a[128:131]
    v_mfma_f32_16x16x32_bf16 a[160:163], v[32:35], v[180:183], a[160:163]
    s_bfe_u32 s28, s87, 0x40010
    v_mfma_f32_16x16x32_bf16 a[192:195], v[32:35], v[184:187], a[192:195]
    s_add_u32 s30, s30, s34
    v_mfma_f32_16x16x32_bf16 a[224:227], v[32:35], v[188:191], a[224:227]
    s_waitcnt lgkmcnt(4)
    v_mfma_f32_16x16x32_bf16 a[4:7], v[36:39], v[160:163], a[4:7]
    ds_read_b64_tr_b16 v[48:49], v11 offset:0
    v_mfma_f32_16x16x32_bf16 a[36:39], v[36:39], v[164:167], a[36:39]
    ds_read_b64_tr_b16 v[50:51], v11 offset:2048
    v_mfma_f32_16x16x32_bf16 a[68:71], v[36:39], v[168:171], a[68:71]
    s_add_u32 s35, s30, 32768
    v_mfma_f32_16x16x32_bf16 a[100:103], v[36:39], v[172:175], a[100:103]
    s_lshl_b32 s28, s28, 13
    v_mfma_f32_16x16x32_bf16 a[132:135], v[36:39], v[176:179], a[132:135]
    v_mfma_f32_16x16x32_bf16 a[164:167], v[36:39], v[180:183], a[164:167]
    s_add_u32 m0, s31, 16384
    v_mfma_f32_16x16x32_bf16 a[196:199], v[36:39], v[184:187], a[196:199]
    buffer_load_dwordx4 v3, s[16:19], s30 offen offset:0 lds
    v_mfma_f32_16x16x32_bf16 a[228:231], v[36:39], v[188:191], a[228:231]
    s_waitcnt lgkmcnt(4)
    v_mfma_f32_16x16x32_bf16 a[8:11], v[40:43], v[160:163], a[8:11]
    ds_read_b64_tr_b16 v[52:53], v12 offset:0
    v_mfma_f32_16x16x32_bf16 a[40:43], v[40:43], v[164:167], a[40:43]
    ds_read_b64_tr_b16 v[54:55], v12 offset:2048
    v_mfma_f32_16x16x32_bf16 a[72:75], v[40:43], v[168:171], a[72:75]
    s_add_u32 s28, s28, s33
    v_mfma_f32_16x16x32_bf16 a[104:107], v[40:43], v[172:175], a[104:107]
    buffer_load_dwordx4 v4, s[16:19], s30 offen offset:1024 lds
    v_mfma_f32_16x16x32_bf16 a[136:139], v[40:43], v[176:179], a[136:139]
    v_mfma_f32_16x16x32_bf16 a[168:171], v[40:43], v[180:183], a[168:171]
    buffer_load_dwordx4 v5, s[16:19], s30 offen offset:2048 lds
    v_mfma_f32_16x16x32_bf16 a[200:203], v[40:43], v[184:187], a[200:203]
    buffer_load_dwordx4 v[96:99], v1, s[20:23], s28 offen offset:0 sc1
    v_mfma_f32_16x16x32_bf16 a[232:235], v[40:43], v[188:191], a[232:235]
    s_waitcnt lgkmcnt(4)
    v_mfma_f32_16x16x32_bf16 a[12:15], v[44:47], v[160:163], a[12:15]
    ds_read_b64_tr_b16 v[56:57], v13 offset:0
    v_mfma_f32_16x16x32_bf16 a[44:47], v[44:47], v[164:167], a[44:47]
    ds_read_b64_tr_b16 v[58:59], v13 offset:2048
    v_mfma_f32_16x16x32_bf16 a[76:79], v[44:47], v[168:171], a[76:79]
    buffer_load_dwordx4 v[100:103], v1, s[20:23], s28 offen offset:1024 sc1
    v_mfma_f32_16x16x32_bf16 a[108:111], v[44:47], v[172:175], a[108:111]
    buffer_load_dwordx4 v6, s[16:19], s30 offen offset:3072 lds
    v_mfma_f32_16x16x32_bf16 a[140:143], v[44:47], v[176:179], a[140:143]
    v_mfma_f32_16x16x32_bf16 a[172:175], v[44:47], v[180:183], a[172:175]
    s_add_u32 m0, s31, 20480
    v_mfma_f32_16x16x32_bf16 a[204:207], v[44:47], v[184:187], a[204:207]
    buffer_load_dwordx4 v[104:107], v1, s[20:23], s28 offen offset:2048 sc1
    v_mfma_f32_16x16x32_bf16 a[236:239], v[44:47], v[188:191], a[236:239]
    s_waitcnt lgkmcnt(4)
    v_mfma_f32_16x16x32_bf16 a[16:19], v[48:51], v[160:163], a[16:19]
    ds_read_b64_tr_b16 v[60:61], v14 offset:0
    v_mfma_f32_16x16x32_bf16 a[48:51], v[48:51], v[164:167], a[48:51]
    ds_read_b64_tr_b16 v[62:63], v14 offset:2048
    v_mfma_f32_16x16x32_bf16 a[80:83], v[48:51], v[168:171], a[80:83]
    buffer_load_dwordx4 v[108:111], v1, s[20:23], s28 offen offset:3072 sc1
    v_mfma_f32_16x16x32_bf16 a[112:115], v[48:51], v[172:175], a[112:115]
    buffer_load_dwordx4 v3, s[16:19], s35 offen offset:0 lds
    v_mfma_f32_16x16x32_bf16 a[144:147], v[48:51], v[176:179], a[144:147]
    v_mfma_f32_16x16x32_bf16 a[176:179], v[48:51], v[180:183], a[176:179]
    buffer_load_dwordx4 v4, s[16:19], s35 offen offset:1024 lds
    v_mfma_f32_16x16x32_bf16 a[208:211], v[48:51], v[184:187], a[208:211]
    buffer_load_dwordx4 v[112:115], v2, s[20:23], s28 offen offset:0 sc1
    v_mfma_f32_16x16x32_bf16 a[240:243], v[48:51], v[188:191], a[240:243]
    s_waitcnt lgkmcnt(4)
    v_mfma_f32_16x16x32_bf16 a[20:23], v[52:55], v[160:163], a[20:23]
    s_waitcnt vmcnt(14)
    v_mfma_f32_16x16x32_bf16 a[52:55], v[52:55], v[164:167], a[52:55]
    ds_read_b64_tr_b16 v[32:33], v7 offset:8192
    v_mfma_f32_16x16x32_bf16 a[84:87], v[52:55], v[168:171], a[84:87]
    ds_read_b64_tr_b16 v[34:35], v7 offset:10240
    v_mfma_f32_16x16x32_bf16 a[116:119], v[52:55], v[172:175], a[116:119]
    buffer_load_dwordx4 v[116:119], v2, s[20:23], s28 offen offset:1024 sc1
    v_mfma_f32_16x16x32_bf16 a[148:151], v[52:55], v[176:179], a[148:151]
    buffer_load_dwordx4 v5, s[16:19], s35 offen offset:2048 lds
    v_mfma_f32_16x16x32_bf16 a[180:183], v[52:55], v[180:183], a[180:183]
    buffer_load_dwordx4 v6, s[16:19], s35 offen offset:3072 lds
    v_mfma_f32_16x16x32_bf16 a[212:215], v[52:55], v[184:187], a[212:215]
    buffer_load_dwordx4 v[120:123], v2, s[20:23], s28 offen offset:2048 sc1
    v_mfma_f32_16x16x32_bf16 a[244:247], v[52:55], v[188:191], a[244:247]
    s_waitcnt lgkmcnt(4)
    v_mfma_f32_16x16x32_bf16 a[24:27], v[56:59], v[160:163], a[24:27]
    ds_read_b64_tr_b16 v[36:37], v8 offset:8192
    v_mfma_f32_16x16x32_bf16 a[56:59], v[56:59], v[164:167], a[56:59]
    ds_read_b64_tr_b16 v[38:39], v8 offset:10240
    v_mfma_f32_16x16x32_bf16 a[88:91], v[56:59], v[168:171], a[88:91]
    buffer_load_dwordx4 v[124:127], v2, s[20:23], s28 offen offset:3072 sc1
    v_mfma_f32_16x16x32_bf16 a[120:123], v[56:59], v[172:175], a[120:123]
    v_mfma_f32_16x16x32_bf16 a[152:155], v[56:59], v[176:179], a[152:155]
    v_mfma_f32_16x16x32_bf16 a[184:187], v[56:59], v[180:183], a[184:187]
    v_mfma_f32_16x16x32_bf16 a[216:219], v[56:59], v[184:187], a[216:219]
    v_mfma_f32_16x16x32_bf16 a[248:251], v[56:59], v[188:191], a[248:251]
    s_waitcnt lgkmcnt(4)
    v_mfma_f32_16x16x32_bf16 a[28:31], v[60:63], v[160:163], a[28:31]
    ds_read_b64_tr_b16 v[40:41], v9 offset:8192
    v_mfma_f32_16x16x32_bf16 a[60:63], v[60:63], v[164:167], a[60:63]
    ds_read_b64_tr_b16 v[42:43], v9 offset:10240
    v_mfma_f32_16x16x32_bf16 a[92:95], v[60:63], v[168:171], a[92:95]
    v_mfma_f32_16x16x32_bf16 a[124:127], v[60:63], v[172:175], a[124:127]
    v_mfma_f32_16x16x32_bf16 a[156:159], v[60:63], v[176:179], a[156:159]
    v_mfma_f32_16x16x32_bf16 a[188:191], v[60:63], v[180:183], a[188:191]
    v_mfma_f32_16x16x32_bf16 a[220:223], v[60:63], v[184:187], a[220:223]
    v_mfma_f32_16x16x32_bf16 a[252:255], v[60:63], v[188:191], a[252:255]
    s_waitcnt vmcnt(17)
    s_waitcnt lgkmcnt(4)
    v_mfma_f32_16x16x32_bf16 a[0:3], v[32:35], v[192:195], a[0:3]
    ds_read_b64_tr_b16 v[44:45], v10 offset:8192
    v_mfma_f32_16x16x32_bf16 a[32:35], v[32:35], v[196:199], a[32:35]
    ds_read_b64_tr_b16 v[46:47], v10 offset:10240
    v_mfma_f32_16x16x32_bf16 a[64:67], v[32:35], v[200:203], a[64:67]
    s_bfe_u32 s30, s87, 0x40014
    v_mfma_f32_16x16x32_bf16 a[96:99], v[32:35], v[204:207], a[96:99]
    s_lshl_b32 s30, s30, 16
    v_mfma_f32_16x16x32_bf16 a[128:131], v[32:35], v[208:211], a[128:131]
    v_mfma_f32_16x16x32_bf16 a[160:163], v[32:35], v[212:215], a[160:163]
    s_bfe_u32 s28, s87, 0x40014
    v_mfma_f32_16x16x32_bf16 a[192:195], v[32:35], v[216:219], a[192:195]
    s_add_u32 s30, s30, s34
    v_mfma_f32_16x16x32_bf16 a[224:227], v[32:35], v[220:223], a[224:227]
    s_waitcnt lgkmcnt(4)
    v_mfma_f32_16x16x32_bf16 a[4:7], v[36:39], v[192:195], a[4:7]
    ds_read_b64_tr_b16 v[48:49], v11 offset:8192
    v_mfma_f32_16x16x32_bf16 a[36:39], v[36:39], v[196:199], a[36:39]
    ds_read_b64_tr_b16 v[50:51], v11 offset:10240
    v_mfma_f32_16x16x32_bf16 a[68:71], v[36:39], v[200:203], a[68:71]
    s_add_u32 s35, s30, 32768
    v_mfma_f32_16x16x32_bf16 a[100:103], v[36:39], v[204:207], a[100:103]
    s_lshl_b32 s28, s28, 13
    v_mfma_f32_16x16x32_bf16 a[132:135], v[36:39], v[208:211], a[132:135]
    v_mfma_f32_16x16x32_bf16 a[164:167], v[36:39], v[212:215], a[164:167]
    s_add_u32 m0, s31, 24576
    v_mfma_f32_16x16x32_bf16 a[196:199], v[36:39], v[216:219], a[196:199]
    buffer_load_dwordx4 v3, s[16:19], s30 offen offset:0 lds
    v_mfma_f32_16x16x32_bf16 a[228:231], v[36:39], v[220:223], a[228:231]
    s_waitcnt lgkmcnt(4)
    v_mfma_f32_16x16x32_bf16 a[8:11], v[40:43], v[192:195], a[8:11]
    ds_read_b64_tr_b16 v[52:53], v12 offset:8192
    v_mfma_f32_16x16x32_bf16 a[40:43], v[40:43], v[196:199], a[40:43]
    ds_read_b64_tr_b16 v[54:55], v12 offset:10240
    v_mfma_f32_16x16x32_bf16 a[72:75], v[40:43], v[200:203], a[72:75]
    s_add_u32 s28, s28, s33
    v_mfma_f32_16x16x32_bf16 a[104:107], v[40:43], v[204:207], a[104:107]
    buffer_load_dwordx4 v4, s[16:19], s30 offen offset:1024 lds
    v_mfma_f32_16x16x32_bf16 a[136:139], v[40:43], v[208:211], a[136:139]
    v_mfma_f32_16x16x32_bf16 a[168:171], v[40:43], v[212:215], a[168:171]
    buffer_load_dwordx4 v5, s[16:19], s30 offen offset:2048 lds
    v_mfma_f32_16x16x32_bf16 a[200:203], v[40:43], v[216:219], a[200:203]
    buffer_load_dwordx4 v[128:131], v1, s[20:23], s28 offen offset:0 sc1
    v_mfma_f32_16x16x32_bf16 a[232:235], v[40:43], v[220:223], a[232:235]
    s_waitcnt lgkmcnt(4)
    v_mfma_f32_16x16x32_bf16 a[12:15], v[44:47], v[192:195], a[12:15]
    ds_read_b64_tr_b16 v[56:57], v13 offset:8192
    v_mfma_f32_16x16x32_bf16 a[44:47], v[44:47], v[196:199], a[44:47]
    ds_read_b64_tr_b16 v[58:59], v13 offset:10240
    v_mfma_f32_16x16x32_bf16 a[76:79], v[44:47], v[200:203], a[76:79]
    buffer_load_dwordx4 v[132:135], v1, s[20:23], s28 offen offset:1024 sc1
    v_mfma_f32_16x16x32_bf16 a[108:111], v[44:47], v[204:207], a[108:111]
    buffer_load_dwordx4 v6, s[16:19], s30 offen offset:3072 lds
    v_mfma_f32_16x16x32_bf16 a[140:143], v[44:47], v[208:211], a[140:143]
    v_mfma_f32_16x16x32_bf16 a[172:175], v[44:47], v[212:215], a[172:175]
    s_add_u32 m0, s31, 28672
    v_mfma_f32_16x16x32_bf16 a[204:207], v[44:47], v[216:219], a[204:207]
    buffer_load_dwordx4 v[136:139], v1, s[20:23], s28 offen offset:2048 sc1
    v_mfma_f32_16x16x32_bf16 a[236:239], v[44:47], v[220:223], a[236:239]
    s_waitcnt lgkmcnt(4)
    v_mfma_f32_16x16x32_bf16 a[16:19], v[48:51], v[192:195], a[16:19]
    ds_read_b64_tr_b16 v[60:61], v14 offset:8192
    v_mfma_f32_16x16x32_bf16 a[48:51], v[48:51], v[196:199], a[48:51]
    ds_read_b64_tr_b16 v[62:63], v14 offset:10240
    v_mfma_f32_16x16x32_bf16 a[80:83], v[48:51], v[200:203], a[80:83]
    buffer_load_dwordx4 v[140:143], v1, s[20:23], s28 offen offset:3072 sc1
    v_mfma_f32_16x16x32_bf16 a[112:115], v[48:51], v[204:207], a[112:115]
    buffer_load_dwordx4 v3, s[16:19], s35 offen offset:0 lds
    v_mfma_f32_16x16x32_bf16 a[144:147], v[48:51], v[208:211], a[144:147]
    v_mfma_f32_16x16x32_bf16 a[176:179], v[48:51], v[212:215], a[176:179]
    buffer_load_dwordx4 v4, s[16:19], s35 offen offset:1024 lds
    v_mfma_f32_16x16x32_bf16 a[208:211], v[48:51], v[216:219], a[208:211]
    buffer_load_dwordx4 v[144:147], v2, s[20:23], s28 offen offset:0 sc1
    v_mfma_f32_16x16x32_bf16 a[240:243], v[48:51], v[220:223], a[240:243]
    s_waitcnt lgkmcnt(4)
    v_mfma_f32_16x16x32_bf16 a[20:23], v[52:55], v[192:195], a[20:23]
    s_waitcnt vmcnt(13)
    v_mfma_f32_16x16x32_bf16 a[52:55], v[52:55], v[196:199], a[52:55]
    ds_read_b64_tr_b16 v[32:33], v7 offset:16384
    v_mfma_f32_16x16x32_bf16 a[84:87], v[52:55], v[200:203], a[84:87]
    ds_read_b64_tr_b16 v[34:35], v7 offset:18432
    v_mfma_f32_16x16x32_bf16 a[116:119], v[52:55], v[204:207], a[116:119]
    buffer_load_dwordx4 v[148:151], v2, s[20:23], s28 offen offset:1024 sc1
    v_mfma_f32_16x16x32_bf16 a[148:151], v[52:55], v[208:211], a[148:151]
    buffer_load_dwordx4 v5, s[16:19], s35 offen offset:2048 lds
    v_mfma_f32_16x16x32_bf16 a[180:183], v[52:55], v[212:215], a[180:183]
    buffer_load_dwordx4 v6, s[16:19], s35 offen offset:3072 lds
    v_mfma_f32_16x16x32_bf16 a[212:215], v[52:55], v[216:219], a[212:215]
    buffer_load_dwordx4 v[152:155], v2, s[20:23], s28 offen offset:2048 sc1
    v_mfma_f32_16x16x32_bf16 a[244:247], v[52:55], v[220:223], a[244:247]
    s_waitcnt lgkmcnt(4)
    v_mfma_f32_16x16x32_bf16 a[24:27], v[56:59], v[192:195], a[24:27]
    ds_read_b64_tr_b16 v[36:37], v8 offset:16384
    v_mfma_f32_16x16x32_bf16 a[56:59], v[56:59], v[196:199], a[56:59]
    ds_read_b64_tr_b16 v[38:39], v8 offset:18432
    v_mfma_f32_16x16x32_bf16 a[88:91], v[56:59], v[200:203], a[88:91]
    buffer_load_dwordx4 v[156:159], v2, s[20:23], s28 offen offset:3072 sc1
    v_mfma_f32_16x16x32_bf16 a[120:123], v[56:59], v[204:207], a[120:123]
    v_mfma_f32_16x16x32_bf16 a[152:155], v[56:59], v[208:211], a[152:155]
    v_mfma_f32_16x16x32_bf16 a[184:187], v[56:59], v[212:215], a[184:187]
    v_mfma_f32_16x16x32_bf16 a[216:219], v[56:59], v[216:219], a[216:219]
    v_mfma_f32_16x16x32_bf16 a[248:251], v[56:59], v[220:223], a[248:251]
    s_waitcnt lgkmcnt(4)
    v_mfma_f32_16x16x32_bf16 a[28:31], v[60:63], v[192:195], a[28:31]
    ds_read_b64_tr_b16 v[40:41], v9 offset:16384
    v_mfma_f32_16x16x32_bf16 a[60:63], v[60:63], v[196:199], a[60:63]
    ds_read_b64_tr_b16 v[42:43], v9 offset:18432
    v_mfma_f32_16x16x32_bf16 a[92:95], v[60:63], v[200:203], a[92:95]
    v_mfma_f32_16x16x32_bf16 a[124:127], v[60:63], v[204:207], a[124:127]
    v_mfma_f32_16x16x32_bf16 a[156:159], v[60:63], v[208:211], a[156:159]
    v_mfma_f32_16x16x32_bf16 a[188:191], v[60:63], v[212:215], a[188:191]
    v_mfma_f32_16x16x32_bf16 a[220:223], v[60:63], v[216:219], a[220:223]
    v_mfma_f32_16x16x32_bf16 a[252:255], v[60:63], v[220:223], a[252:255]
    s_waitcnt vmcnt(16)
    s_waitcnt vmcnt(32)
    s_mov_b32 s75, 0
P2_ps:
    v_cmp_gt_u32 vcc, 1, v23
    s_add_u32 s75, s75, 1
    s_nop 0
    s_cmp_eq_u64 vcc, 0
    s_cbranch_scc1 P2_psok
    s_cmp_ge_u32 s75, 0x4000
    s_cbranch_scc1 P2_psok
    s_sleep 2
    buffer_load_dword v23, v22, s[20:23], s73 offen sc1
    s_waitcnt vmcnt(0)
    s_branch P2_ps
P2_psok:
    s_waitcnt lgkmcnt(4)
    v_mfma_f32_16x16x32_bf16 a[0:3], v[32:35], v[96:99], a[0:3]
    ds_read_b64_tr_b16 v[44:45], v10 offset:16384
    v_mfma_f32_16x16x32_bf16 a[32:35], v[32:35], v[100:103], a[32:35]
    ds_read_b64_tr_b16 v[46:47], v10 offset:18432
    v_mfma_f32_16x16x32_bf16 a[64:67], v[32:35], v[104:107], a[64:67]
    s_bfe_u32 s30, s88, 0x40000
    v_mfma_f32_16x16x32_bf16 a[96:99], v[32:35], v[108:111], a[96:99]
    s_lshl_b32 s30, s30, 13
    v_mfma_f32_16x16x32_bf16 a[128:131], v[32:35], v[112:115], a[128:131]
    v_mfma_f32_16x16x32_bf16 a[160:163], v[32:35], v[116:119], a[160:163]
    s_bfe_u32 s28, s88, 0x40000
    v_mfma_f32_16x16x32_bf16 a[192:195], v[32:35], v[120:123], a[192:195]
    s_add_u32 s30, s30, s32
    v_mfma_f32_16x16x32_bf16 a[224:227], v[32:35], v[124:127], a[224:227]
    s_waitcnt lgkmcnt(4)
    v_mfma_f32_16x16x32_bf16 a[4:7], v[36:39], v[96:99], a[4:7]
    ds_read_b64_tr_b16 v[48:49], v11 offset:16384
    v_mfma_f32_16x16x32_bf16 a[36:39], v[36:39], v[100:103], a[36:39]
    ds_read_b64_tr_b16 v[50:51], v11 offset:18432
    v_mfma_f32_16x16x32_bf16 a[68:71], v[36:39], v[104:107], a[68:71]
    s_xor_b32 s35, s30, 4096
    v_mfma_f32_16x16x32_bf16 a[100:103], v[36:39], v[108:111], a[100:103]
    s_lshl_b32 s28, s28, 13
    v_mfma_f32_16x16x32_bf16 a[132:135], v[36:39], v[112:115], a[132:135]
    v_mfma_f32_16x16x32_bf16 a[164:167], v[36:39], v[116:119], a[164:167]
    s_add_u32 m0, s31, 32768
    v_mfma_f32_16x16x32_bf16 a[196:199], v[36:39], v[120:123], a[196:199]
    buffer_load_dwordx4 v24, s[20:23], s30 offen offset:0 sc1 lds
    v_mfma_f32_16x16x32_bf16 a[228:231], v[36:39], v[124:127], a[228:231]
    s_waitcnt lgkmcnt(4)
    v_mfma_f32_16x16x32_bf16 a[8:11], v[40:43], v[96:99], a[8:11]
    ds_read_b64_tr_b16 v[52:53], v12 offset:16384
    v_mfma_f32_16x16x32_bf16 a[40:43], v[40:43], v[100:103], a[40:43]
    ds_read_b64_tr_b16 v[54:55], v12 offset:18432
    v_mfma_f32_16x16x32_bf16 a[72:75], v[40:43], v[104:107], a[72:75]
    s_add_u32 s28, s28, s29
    v_mfma_f32_16x16x32_bf16 a[104:107], v[40:43], v[108:111], a[104:107]
    buffer_load_dwordx4 v24, s[20:23], s30 offen offset:1024 sc1 lds
    v_mfma_f32_16x16x32_bf16 a[136:139], v[40:43], v[112:115], a[136:139]
    v_mfma_f32_16x16x32_bf16 a[168:171], v[40:43], v[116:119], a[168:171]
    buffer_load_dwordx4 v24, s[20:23], s30 offen offset:2048 sc1 lds
    v_mfma_f32_16x16x32_bf16 a[200:203], v[40:43], v[120:123], a[200:203]
    buffer_load_dwordx4 v[160:163], v1, s[20:23], s28 offen offset:0 sc1
    v_mfma_f32_16x16x32_bf16 a[232:235], v[40:43], v[124:127], a[232:235]
    s_waitcnt lgkmcnt(4)
    v_mfma_f32_16x16x32_bf16 a[12:15], v[44:47], v[96:99], a[12:15]
    ds_read_b64_tr_b16 v[56:57], v13 offset:16384
    v_mfma_f32_16x16x32_bf16 a[44:47], v[44:47], v[100:103], a[44:47]
    ds_read_b64_tr_b16 v[58:59], v13 offset:18432
    v_mfma_f32_16x16x32_bf16 a[76:79], v[44:47], v[104:107], a[76:79]
    buffer_load_dwordx4 v[164:167], v1, s[20:23], s28 offen offset:1024 sc1
    v_mfma_f32_16x16x32_bf16 a[108:111], v[44:47], v[108:111], a[108:111]
    buffer_load_dwordx4 v24, s[20:23], s30 offen offset:3072 sc1 lds
    v_mfma_f32_16x16x32_bf16 a[140:143], v[44:47], v[112:115], a[140:143]
    v_mfma_f32_16x16x32_bf16 a[172:175], v[44:47], v[116:119], a[172:175]
    s_add_u32 m0, s31, 36864
    v_mfma_f32_16x16x32_bf16 a[204:207], v[44:47], v[120:123], a[204:207]
    buffer_load_dwordx4 v[168:171], v1, s[20:23], s28 offen offset:2048 sc1
    v_mfma_f32_16x16x32_bf16 a[236:239], v[44:47], v[124:127], a[236:239]
    s_waitcnt lgkmcnt(4)
    v_mfma_f32_16x16x32_bf16 a[16:19], v[48:51], v[96:99], a[16:19]
    ds_read_b64_tr_b16 v[60:61], v14 offset:16384
    v_mfma_f32_16x16x32_bf16 a[48:51], v[48:51], v[100:103], a[48:51]
    ds_read_b64_tr_b16 v[62:63], v14 offset:18432
    v_mfma_f32_16x16x32_bf16 a[80:83], v[48:51], v[104:107], a[80:83]
    buffer_load_dwordx4 v[172:175], v1, s[20:23], s28 offen offset:3072 sc1
    v_mfma_f32_16x16x32_bf16 a[112:115], v[48:51], v[108:111], a[112:115]
    buffer_load_dwordx4 v24, s[20:23], s35 offen offset:0 sc1 lds
    v_mfma_f32_16x16x32_bf16 a[144:147], v[48:51], v[112:115], a[144:147]
    v_mfma_f32_16x16x32_bf16 a[176:179], v[48:51], v[116:119], a[176:179]
    buffer_load_dwordx4 v24, s[20:23], s35 offen offset:1024 sc1 lds
    v_mfma_f32_16x16x32_bf16 a[208:211], v[48:51], v[120:123], a[208:211]
    buffer_load_dwordx4 v[176:179], v2, s[20:23], s28 offen offset:0 sc1
    v_mfma_f32_16x16x32_bf16 a[240:243], v[48:51], v[124:127], a[240:243]
    s_waitcnt lgkmcnt(4)
    v_mfma_f32_16x16x32_bf16 a[20:23], v[52:55], v[96:99], a[20:23]
    s_waitcnt vmcnt(13)
    v_mfma_f32_16x16x32_bf16 a[52:55], v[52:55], v[100:103], a[52:55]
    ds_read_b64_tr_b16 v[32:33], v7 offset:24576
    v_mfma_f32_16x16x32_bf16 a[84:87], v[52:55], v[104:107], a[84:87]
    ds_read_b64_tr_b16 v[34:35], v7 offset:26624
    v_mfma_f32_16x16x32_bf16 a[116:119], v[52:55], v[108:111], a[116:119]
    buffer_load_dwordx4 v[180:183], v2, s[20:23], s28 offen offset:1024 sc1
    v_mfma_f32_16x16x32_bf16 a[148:151], v[52:55], v[112:115], a[148:151]
    buffer_load_dwordx4 v24, s[20:23], s35 offen offset:2048 sc1 lds
    v_mfma_f32_16x16x32_bf16 a[180:183], v[52:55], v[116:119], a[180:183]
    buffer_load_dwordx4 v24, s[20:23], s35 offen offset:3072 sc1 lds
    v_mfma_f32_16x16x32_bf16 a[212:215], v[52:55], v[120:123], a[212:215]
    buffer_load_dwordx4 v[184:187], v2, s[20:23], s28 offen offset:2048 sc1
    v_mfma_f32_16x16x32_bf16 a[244:247], v[52:55], v[124:127], a[244:247]
    s_waitcnt lgkmcnt(4)
    v_mfma_f32_16x16x32_bf16 a[24:27], v[56:59], v[96:99], a[24:27]
    ds_read_b64_tr_b16 v[36:37], v8 offset:24576
    v_mfma_f32_16x16x32_bf16 a[56:59], v[56:59], v[100:103], a[56:59]
    ds_read_b64_tr_b16 v[38:39], v8 offset:26624
    v_mfma_f32_16x16x32_bf16 a[88:91], v[56:59], v[104:107], a[88:91]
    buffer_load_dwordx4 v[188:191], v2, s[20:23], s28 offen offset:3072 sc1
    v_mfma_f32_16x16x32_bf16 a[120:123], v[56:59], v[108:111], a[120:123]
    v_mfma_f32_16x16x32_bf16 a[152:155], v[56:59], v[112:115], a[152:155]
    v_mfma_f32_16x16x32_bf16 a[184:187], v[56:59], v[116:119], a[184:187]
    v_mfma_f32_16x16x32_bf16 a[216:219], v[56:59], v[120:123], a[216:219]
    v_mfma_f32_16x16x32_bf16 a[248:251], v[56:59], v[124:127], a[248:251]
    s_waitcnt lgkmcnt(4)
    v_mfma_f32_16x16x32_bf16 a[28:31], v[60:63], v[96:99], a[28:31]
    ds_read_b64_tr_b16 v[40:41], v9 offset:24576
    v_mfma_f32_16x16x32_bf16 a[60:63], v[60:63], v[100:103], a[60:63]
    ds_read_b64_tr_b16 v[42:43], v9 offset:26624
    v_mfma_f32_16x16x32_bf16 a[92:95], v[60:63], v[104:107], a[92:95]
    v_mfma_f32_16x16x32_bf16 a[124:127], v[60:63], v[108:111], a[124:127]
    v_mfma_f32_16x16x32_bf16 a[156:159], v[60:63], v[112:115], a[156:159]
    v_mfma_f32_16x16x32_bf16 a[188:191], v[60:63], v[116:119], a[188:191]
    v_mfma_f32_16x16x32_bf16 a[220:223], v[60:63], v[120:123], a[220:223]
    v_mfma_f32_16x16x32_bf16 a[252:255], v[60:63], v[124:127], a[252:255]
    s_waitcnt vmcnt(16)
    s_waitcnt lgkmcnt(4)
    v_mfma_f32_16x16x32_bf16 a[0:3], v[32:35], v[128:131], a[0:3]
    ds_read_b64_tr_b16 v[44:45], v10 offset:24576
    v_mfma_f32_16x16x32_bf16 a[32:35], v[32:35], v[132:135], a[32:35]
    ds_read_b64_tr_b16 v[46:47], v10 offset:26624
    v_mfma_f32_16x16x32_bf16 a[64:67], v[32:35], v[136:139], a[64:67]
    s_bfe_u32 s30, s88, 0x40004
    v_mfma_f32_16x16x32_bf16 a[96:99], v[32:35], v[140:143], a[96:99]
    s_lshl_b32 s30, s30, 13
    v_mfma_f32_16x16x32_bf16 a[128:131], v[32:35], v[144:147], a[128:131]
    v_mfma_f32_16x16x32_bf16 a[160:163], v[32:35], v[148:151], a[160:163]
    s_bfe_u32 s28, s88, 0x40004
    v_mfma_f32_16x16x32_bf16 a[192:195], v[32:35], v[152:155], a[192:195]
    s_add_u32 s30, s30, s32
    v_mfma_f32_16x16x32_bf16 a[224:227], v[32:35], v[156:159], a[224:227]
    s_waitcnt lgkmcnt(4)
    v_mfma_f32_16x16x32_bf16 a[4:7], v[36:39], v[128:131], a[4:7]
    ds_read_b64_tr_b16 v[48:49], v11 offset:24576
    v_mfma_f32_16x16x32_bf16 a[36:39], v[36:39], v[132:135], a[36:39]
    ds_read_b64_tr_b16 v[50:51], v11 offset:26624
    v_mfma_f32_16x16x32_bf16 a[68:71], v[36:39], v[136:139], a[68:71]
    s_xor_b32 s35, s30, 4096
    v_mfma_f32_16x16x32_bf16 a[100:103], v[36:39], v[140:143], a[100:103]
    s_lshl_b32 s28, s28, 13
    v_mfma_f32_16x16x32_bf16 a[132:135], v[36:39], v[144:147], a[132:135]
    v_mfma_f32_16x16x32_bf16 a[164:167], v[36:39], v[148:151], a[164:167]
    s_add_u32 m0, s31, 0
    v_mfma_f32_16x16x32_bf16 a[196:199], v[36:39], v[152:155], a[196:199]
    buffer_load_dwordx4 v24, s[20:23], s30 offen offset:0 sc1 lds
    v_mfma_f32_16x16x32_bf16 a[228:231], v[36:39], v[156:159], a[228:231]
    s_waitcnt lgkmcnt(4)
    v_mfma_f32_16x16x32_bf16 a[8:11], v[40:43], v[128:131], a[8:11]
    ds_read_b64_tr_b16 v[52:53], v12 offset:24576
    v_mfma_f32_16x16x32_bf16 a[40:43], v[40:43], v[132:135], a[40:43]
    ds_read_b64_tr_b16 v[54:55], v12 offset:26624
    v_mfma_f32_16x16x32_bf16 a[72:75], v[40:43], v[136:139], a[72:75]
    s_add_u32 s28, s28, s29
    v_mfma_f32_16x16x32_bf16 a[104:107], v[40:43], v[140:143], a[104:107]
    buffer_load_dwordx4 v24, s[20:23], s30 offen offset:1024 sc1 lds
    v_mfma_f32_16x16x32_bf16 a[136:139], v[40:43], v[144:147], a[136:139]
    v_mfma_f32_16x16x32_bf16 a[168:171], v[40:43], v[148:151], a[168:171]
    buffer_load_dwordx4 v24, s[20:23], s30 offen offset:2048 sc1 lds
    v_mfma_f32_16x16x32_bf16 a[200:203], v[40:43], v[152:155], a[200:203]
    buffer_load_dwordx4 v[192:195], v1, s[20:23], s28 offen offset:0 sc1
    v_mfma_f32_16x16x32_bf16 a[232:235], v[40:43], v[156:159], a[232:235]
    s_waitcnt lgkmcnt(4)
    v_mfma_f32_16x16x32_bf16 a[12:15], v[44:47], v[128:131], a[12:15]
    ds_read_b64_tr_b16 v[56:57], v13 offset:24576
    v_mfma_f32_16x16x32_bf16 a[44:47], v[44:47], v[132:135], a[44:47]
    ds_read_b64_tr_b16 v[58:59], v13 offset:26624
    v_mfma_f32_16x16x32_bf16 a[76:79], v[44:47], v[136:139], a[76:79]
    buffer_load_dwordx4 v[196:199], v1, s[20:23], s28 offen offset:1024 sc1
    v_mfma_f32_16x16x32_bf16 a[108:111], v[44:47], v[140:143], a[108:111]
    buffer_load_dwordx4 v24, s[20:23], s30 offen offset:3072 sc1 lds
    v_mfma_f32_16x16x32_bf16 a[140:143], v[44:47], v[144:147], a[140:143]
    v_mfma_f32_16x16x32_bf16 a[172:175], v[44:47], v[148:151], a[172:175]
    s_add_u32 m0, s31, 4096
    v_mfma_f32_16x16x32_bf16 a[204:207], v[44:47], v[152:155], a[204:207]
    buffer_load_dwordx4 v[200:203], v1, s[20:23], s28 offen offset:2048 sc1
    v_mfma_f32_16x16x32_bf16 a[236:239], v[44:47], v[156:159], a[236:239]
    s_waitcnt lgkmcnt(4)
    v_mfma_f32_16x16x32_bf16 a[16:19], v[48:51], v[128:131], a[16:19]
    ds_read_b64_tr_b16 v[60:61], v14 offset:24576
    v_mfma_f32_16x16x32_bf16 a[48:51], v[48:51], v[132:135], a[48:51]
    ds_read_b64_tr_b16 v[62:63], v14 offset:26624
    v_mfma_f32_16x16x32_bf16 a[80:83], v[48:51], v[136:139], a[80:83]
    buffer_load_dwordx4 v[204:207], v1, s[20:23], s28 offen offset:3072 sc1
    v_mfma_f32_16x16x32_bf16 a[112:115], v[48:51], v[140:143], a[112:115]
    buffer_load_dwordx4 v24, s[20:23], s35 offen offset:0 sc1 lds
    v_mfma_f32_16x16x32_bf16 a[144:147], v[48:51], v[144:147], a[144:147]
    v_mfma_f32_16x16x32_bf16 a[176:179], v[48:51], v[148:151], a[176:179]
    buffer_load_dwordx4 v24, s[20:23], s35 offen offset:1024 sc1 lds
    v_mfma_f32_16x16x32_bf16 a[208:211], v[48:51], v[152:155], a[208:211]
    buffer_load_dwordx4 v[208:211], v2, s[20:23], s28 offen offset:0 sc1
    v_mfma_f32_16x16x32_bf16 a[240:243], v[48:51], v[156:159], a[240:243]
    s_waitcnt lgkmcnt(4)
    v_mfma_f32_16x16x32_bf16 a[20:23], v[52:55], v[128:131], a[20:23]
    s_waitcnt vmcnt(13)
    v_mfma_f32_16x16x32_bf16 a[52:55], v[52:55], v[132:135], a[52:55]
    ds_read_b128 v[32:35], v25 offset:32768
    v_mfma_f32_16x16x32_bf16 a[84:87], v[52:55], v[136:139], a[84:87]
    buffer_load_dwordx4 v[212:215], v2, s[20:23], s28 offen offset:1024 sc1
    v_mfma_f32_16x16x32_bf16 a[116:119], v[52:55], v[140:143], a[116:119]
    buffer_load_dwordx4 v24, s[20:23], s35 offen offset:2048 sc1 lds
    v_mfma_f32_16x16x32_bf16 a[148:151], v[52:55], v[144:147], a[148:151]
    v_mfma_f32_16x16x32_bf16 a[180:183], v[52:55], v[148:151], a[180:183]
    buffer_load_dwordx4 v24, s[20:23], s35 offen offset:3072 sc1 lds
    v_mfma_f32_16x16x32_bf16 a[212:215], v[52:55], v[152:155], a[212:215]
    buffer_load_dwordx4 v[216:219], v2, s[20:23], s28 offen offset:2048 sc1
    v_mfma_f32_16x16x32_bf16 a[244:247], v[52:55], v[156:159], a[244:247]
    s_waitcnt lgkmcnt(3)
    v_mfma_f32_16x16x32_bf16 a[24:27], v[56:59], v[128:131], a[24:27]
    ds_read_b128 v[36:39], v25 offset:33792
    v_mfma_f32_16x16x32_bf16 a[56:59], v[56:59], v[132:135], a[56:59]
    buffer_load_dwordx4 v[220:223], v2, s[20:23], s28 offen offset:3072 sc1
    v_mfma_f32_16x16x32_bf16 a[88:91], v[56:59], v[136:139], a[88:91]
    v_mfma_f32_16x16x32_bf16 a[120:123], v[56:59], v[140:143], a[120:123]
    v_mfma_f32_16x16x32_bf16 a[152:155], v[56:59], v[144:147], a[152:155]
    v_mfma_f32_16x16x32_bf16 a[184:187], v[56:59], v[148:151], a[184:187]
    v_mfma_f32_16x16x32_bf16 a[216:219], v[56:59], v[152:155], a[216:219]
    v_mfma_f32_16x16x32_bf16 a[248:251], v[56:59], v[156:159], a[248:251]
    s_waitcnt lgkmcnt(2)
    v_mfma_f32_16x16x32_bf16 a[28:31], v[60:63], v[128:131], a[28:31]
    ds_read_b128 v[40:43], v25 offset:34816
    v_mfma_f32_16x16x32_bf16 a[60:63], v[60:63], v[132:135], a[60:63]
    v_mfma_f32_16x16x32_bf16 a[92:95], v[60:63], v[136:139], a[92:95]
    v_mfma_f32_16x16x32_bf16 a[124:127], v[60:63], v[140:143], a[124:127]
    v_mfma_f32_16x16x32_bf16 a[156:159], v[60:63], v[144:147], a[156:159]
    v_mfma_f32_16x16x32_bf16 a[188:191], v[60:63], v[148:151], a[188:191]
    v_mfma_f32_16x16x32_bf16 a[220:223], v[60:63], v[152:155], a[220:223]
    v_mfma_f32_16x16x32_bf16 a[252:255], v[60:63], v[156:159], a[252:255]
    s_waitcnt vmcnt(16)
    s_waitcnt lgkmcnt(2)
    v_mfma_f32_16x16x32_bf16 a[0:3], v[32:35], v[160:163], a[0:3]
    ds_read_b128 v[44:47], v25 offset:35840
    v_mfma_f32_16x16x32_bf16 a[32:35], v[32:35], v[164:167], a[32:35]
    s_bfe_u32 s30, s88, 0x40008
    v_mfma_f32_16x16x32_bf16 a[64:67], v[32:35], v[168:171], a[64:67]
    s_lshl_b32 s30, s30, 13
    v_mfma_f32_16x16x32_bf16 a[96:99], v[32:35], v[172:175], a[96:99]
    v_mfma_f32_16x16x32_bf16 a[128:131], v[32:35], v[176:179], a[128:131]
    s_bfe_u32 s28, s88, 0x40008
    v_mfma_f32_16x16x32_bf16 a[160:163], v[32:35], v[180:183], a[160:163]
    v_mfma_f32_16x16x32_bf16 a[192:195], v[32:35], v[184:187], a[192:195]
    s_add_u32 s30, s30, s32
    v_mfma_f32_16x16x32_bf16 a[224:227], v[32:35], v[188:191], a[224:227]
    s_waitcnt lgkmcnt(2)
    v_mfma_f32_16x16x32_bf16 a[4:7], v[36:39], v[160:163], a[4:7]
    ds_read_b128 v[48:51], v25 offset:36864
    v_mfma_f32_16x16x32_bf16 a[36:39], v[36:39], v[164:167], a[36:39]
    s_xor_b32 s35, s30, 4096
    v_mfma_f32_16x16x32_bf16 a[68:71], v[36:39], v[168:171], a[68:71]
    s_lshl_b32 s28, s28, 13
    v_mfma_f32_16x16x32_bf16 a[100:103], v[36:39], v[172:175], a[100:103]
    v_mfma_f32_16x16x32_bf16 a[132:135], v[36:39], v[176:179], a[132:135]
    s_add_u32 m0, s31, 8192
    v_mfma_f32_16x16x32_bf16 a[164:167], v[36:39], v[180:183], a[164:167]
    v_mfma_f32_16x16x32_bf16 a[196:199], v[36:39], v[184:187], a[196:199]
    buffer_load_dwordx4 v24, s[20:23], s30 offen offset:0 sc1 lds
    v_mfma_f32_16x16x32_bf16 a[228:231], v[36:39], v[188:191], a[228:231]
    s_waitcnt lgkmcnt(2)
    v_mfma_f32_16x16x32_bf16 a[8:11], v[40:43], v[160:163], a[8:11]
    ds_read_b128 v[52:55], v25 offset:37888
    v_mfma_f32_16x16x32_bf16 a[40:43], v[40:43], v[164:167], a[40:43]
    s_add_u32 s28, s28, s29
    v_mfma_f32_16x16x32_bf16 a[72:75], v[40:43], v[168:171], a[72:75]
    buffer_load_dwordx4 v24, s[20:23], s30 offen offset:1024 sc1 lds
    v_mfma_f32_16x16x32_bf16 a[104:107], v[40:43], v[172:175], a[104:107]
    v_mfma_f32_16x16x32_bf16 a[136:139], v[40:43], v[176:179], a[136:139]
    buffer_load_dwordx4 v24, s[20:23], s30 offen offset:2048 sc1 lds
    v_mfma_f32_16x16x32_bf16 a[168:171], v[40:43], v[180:183], a[168:171]
    v_mfma_f32_16x16x32_bf16 a[200:203], v[40:43], v[184:187], a[200:203]
    buffer_load_dwordx4 v[96:99], v1, s[20:23], s28 offen offset:0 sc1
    v_mfma_f32_16x16x32_bf16 a[232:235], v[40:43], v[188:191], a[232:235]
    s_waitcnt lgkmcnt(2)
    v_mfma_f32_16x16x32_bf16 a[12:15], v[44:47], v[160:163], a[12:15]
    ds_read_b128 v[56:59], v25 offset:38912
    v_mfma_f32_16x16x32_bf16 a[44:47], v[44:47], v[164:167], a[44:47]
    buffer_load_dwordx4 v[100:103], v1, s[20:23], s28 offen offset:1024 sc1
    v_mfma_f32_16x16x32_bf16 a[76:79], v[44:47], v[168:171], a[76:79]
    buffer_load_dwordx4 v24, s[20:23], s30 offen offset:3072 sc1 lds
    v_mfma_f32_16x16x32_bf16 a[108:111], v[44:47], v[172:175], a[108:111]
    v_mfma_f32_16x16x32_bf16 a[140:143], v[44:47], v[176:179], a[140:143]
    s_add_u32 m0, s31, 12288
    v_mfma_f32_16x16x32_bf16 a[172:175], v[44:47], v[180:183], a[172:175]
    v_mfma_f32_16x16x32_bf16 a[204:207], v[44:47], v[184:187], a[204:207]
    buffer_load_dwordx4 v[104:107], v1, s[20:23], s28 offen offset:2048 sc1
    v_mfma_f32_16x16x32_bf16 a[236:239], v[44:47], v[188:191], a[236:239]
    s_waitcnt lgkmcnt(2)
    v_mfma_f32_16x16x32_bf16 a[16:19], v[48:51], v[160:163], a[16:19]
    ds_read_b128 v[60:63], v25 offset:39936
    v_mfma_f32_16x16x32_bf16 a[48:51], v[48:51], v[164:167], a[48:51]
    buffer_load_dwordx4 v[108:111], v1, s[20:23], s28 offen offset:3072 sc1
    v_mfma_f32_16x16x32_bf16 a[80:83], v[48:51], v[168:171], a[80:83]
    buffer_load_dwordx4 v24, s[20:23], s35 offen offset:0 sc1 lds
    v_mfma_f32_16x16x32_bf16 a[112:115], v[48:51], v[172:175], a[112:115]
    v_mfma_f32_16x16x32_bf16 a[144:147], v[48:51], v[176:179], a[144:147]
    buffer_load_dwordx4 v24, s[20:23], s35 offen offset:1024 sc1 lds
    v_mfma_f32_16x16x32_bf16 a[176:179], v[48:51], v[180:183], a[176:179]
    v_mfma_f32_16x16x32_bf16 a[208:211], v[48:51], v[184:187], a[208:211]
    buffer_load_dwordx4 v[112:115], v2, s[20:23], s28 offen offset:0 sc1
    v_mfma_f32_16x16x32_bf16 a[240:243], v[48:51], v[188:191], a[240:243]
    s_waitcnt lgkmcnt(2)
    v_mfma_f32_16x16x32_bf16 a[20:23], v[52:55], v[160:163], a[20:23]
    s_waitcnt vmcnt(13)
    v_mfma_f32_16x16x32_bf16 a[52:55], v[52:55], v[164:167], a[52:55]
    ds_read_b128 v[32:35], v25 offset:0
    v_mfma_f32_16x16x32_bf16 a[84:87], v[52:55], v[168:171], a[84:87]
    buffer_load_dwordx4 v[116:119], v2, s[20:23], s28 offen offset:1024 sc1
    v_mfma_f32_16x16x32_bf16 a[116:119], v[52:55], v[172:175], a[116:119]
    buffer_load_dwordx4 v24, s[20:23], s35 offen offset:2048 sc1 lds
    v_mfma_f32_16x16x32_bf16 a[148:151], v[52:55], v[176:179], a[148:151]
    v_mfma_f32_16x16x32_bf16 a[180:183], v[52:55], v[180:183], a[180:183]
    buffer_load_dwordx4 v24, s[20:23], s35 offen offset:3072 sc1 lds
    v_mfma_f32_16x16x32_bf16 a[212:215], v[52:55], v[184:187], a[212:215]
    buffer_load_dwordx4 v[120:123], v2, s[20:23], s28 offen offset:2048 sc1
    v_mfma_f32_16x16x32_bf16 a[244:247], v[52:55], v[188:191], a[244:247]
    s_waitcnt lgkmcnt(2)
    v_mfma_f32_16x16x32_bf16 a[24:27], v[56:59], v[160:163], a[24:27]
    ds_read_b128 v[36:39], v25 offset:1024
    v_mfma_f32_16x16x32_bf16 a[56:59], v[56:59], v[164:167], a[56:59]
    buffer_load_dwordx4 v[124:127], v2, s[20:23], s28 offen offset:3072 sc1
    v_mfma_f32_16x16x32_bf16 a[88:91], v[56:59], v[168:171], a[88:91]
    v_mfma_f32_16x16x32_bf16 a[120:123], v[56:59], v[172:175], a[120:123]
    v_mfma_f32_16x16x32_bf16 a[152:155], v[56:59], v[176:179], a[152:155]
    v_mfma_f32_16x16x32_bf16 a[184:187], v[56:59], v[180:183], a[184:187]
    v_mfma_f32_16x16x32_bf16 a[216:219], v[56:59], v[184:187], a[216:219]
    v_mfma_f32_16x16x32_bf16 a[248:251], v[56:59], v[188:191], a[248:251]
    s_waitcnt lgkmcnt(2)
    v_mfma_f32_16x16x32_bf16 a[28:31], v[60:63], v[160:163], a[28:31]
    ds_read_b128 v[40:43], v25 offset:2048
    v_mfma_f32_16x16x32_bf16 a[60:63], v[60:63], v[164:167], a[60:63]
    v_mfma_f32_16x16x32_bf16 a[92:95], v[60:63], v[168:171], a[92:95]
    v_mfma_f32_16x16x32_bf16 a[124:127], v[60:63], v[172:175], a[124:127]
    v_mfma_f32_16x16x32_bf16 a[156:159], v[60:63], v[176:179], a[156:159]
    v_mfma_f32_16x16x32_bf16 a[188:191], v[60:63], v[180:183], a[188:191]
    v_mfma_f32_16x16x32_bf16 a[220:223], v[60:63], v[184:187], a[220:223]
    v_mfma_f32_16x16x32_bf16 a[252:255], v[60:63], v[188:191], a[252:255]
    s_waitcnt vmcnt(16)
    s_waitcnt lgkmcnt(2)
    v_mfma_f32_16x16x32_bf16 a[0:3], v[32:35], v[192:195], a[0:3]
    ds_read_b128 v[44:47], v25 offset:3072
    v_mfma_f32_16x16x32_bf16 a[32:35], v[32:35], v[196:199], a[32:35]
    s_bfe_u32 s30, s88, 0x4000c
    v_mfma_f32_16x16x32_bf16 a[64:67], v[32:35], v[200:203], a[64:67]
    s_lshl_b32 s30, s30, 13
    v_mfma_f32_16x16x32_bf16 a[96:99], v[32:35], v[204:207], a[96:99]
    s_bfe_u32 s28, s88, 0x4000c
    v_mfma_f32_16x16x32_bf16 a[128:131], v[32:35], v[208:211], a[128:131]
    s_add_u32 s30, s30, s32
    v_mfma_f32_16x16x32_bf16 a[160:163], v[32:35], v[212:215], a[160:163]
    v_add_u32 v20, s31, v15
    v_mfma_f32_16x16x32_bf16 a[192:195], v[32:35], v[216:219], a[192:195]
    s_cmp_lt_u32 s3, 0
    s_cselect_b32 s6, 0, 0
    v_mfma_f32_16x16x32_bf16 a[224:227], v[32:35], v[220:223], a[224:227]
    s_lshl_b32 s6, s6, 13
    s_waitcnt lgkmcnt(2)
    v_mfma_f32_16x16x32_bf16 a[4:7], v[36:39], v[192:195], a[4:7]
    ds_read_b128 v[48:51], v25 offset:4096
    v_mfma_f32_16x16x32_bf16 a[36:39], v[36:39], v[196:199], a[36:39]
    s_xor_b32 s35, s30, 4096
    v_mfma_f32_16x16x32_bf16 a[68:71], v[36:39], v[200:203], a[68:71]
    s_lshl_b32 s28, s28, 13
    v_mfma_f32_16x16x32_bf16 a[100:103], v[36:39], v[204:207], a[100:103]
    s_add_u32 m0, s31, 16384
    v_mfma_f32_16x16x32_bf16 a[132:135], v[36:39], v[208:211], a[132:135]
    buffer_load_dwordx4 v24, s[20:23], s30 offen offset:0 sc1 lds
    v_mfma_f32_16x16x32_bf16 a[164:167], v[36:39], v[212:215], a[164:167]
    v_add_u32 v3, s6, v20
    v_mfma_f32_16x16x32_bf16 a[196:199], v[36:39], v[216:219], a[196:199]
    s_cmp_lt_u32 s3, 1
    s_cselect_b32 s6, 0, 1
    v_mfma_f32_16x16x32_bf16 a[228:231], v[36:39], v[220:223], a[228:231]
    s_lshl_b32 s6, s6, 13
    s_waitcnt lgkmcnt(2)
    v_mfma_f32_16x16x32_bf16 a[8:11], v[40:43], v[192:195], a[8:11]
    ds_read_b128 v[52:55], v25 offset:5120
    v_mfma_f32_16x16x32_bf16 a[40:43], v[40:43], v[196:199], a[40:43]
    s_add_u32 s28, s28, s29
    v_mfma_f32_16x16x32_bf16 a[72:75], v[40:43], v[200:203], a[72:75]
    buffer_load_dwordx4 v24, s[20:23], s30 offen offset:1024 sc1 lds
    v_mfma_f32_16x16x32_bf16 a[104:107], v[40:43], v[204:207], a[104:107]
    buffer_load_dwordx4 v24, s[20:23], s30 offen offset:2048 sc1 lds
    v_mfma_f32_16x16x32_bf16 a[136:139], v[40:43], v[208:211], a[136:139]
    buffer_load_dwordx4 v[128:131], v1, s[20:23], s28 offen offset:0 sc1
    v_mfma_f32_16x16x32_bf16 a[168:171], v[40:43], v[212:215], a[168:171]
    v_add_u32 v4, s6, v20
    v_mfma_f32_16x16x32_bf16 a[200:203], v[40:43], v[216:219], a[200:203]
    s_cmp_lt_u32 s3, 2
    s_cselect_b32 s6, 1, 2
    v_mfma_f32_16x16x32_bf16 a[232:235], v[40:43], v[220:223], a[232:235]
    s_lshl_b32 s6, s6, 13
    s_waitcnt lgkmcnt(2)
    v_mfma_f32_16x16x32_bf16 a[12:15], v[44:47], v[192:195], a[12:15]
    ds_read_b128 v[56:59], v25 offset:6144
    v_mfma_f32_16x16x32_bf16 a[44:47], v[44:47], v[196:199], a[44:47]
    buffer_load_dwordx4 v[132:135], v1, s[20:23], s28 offen offset:1024 sc1
    v_mfma_f32_16x16x32_bf16 a[76:79], v[44:47], v[200:203], a[76:79]
    buffer_load_dwordx4 v24, s[20:23], s30 offen offset:3072 sc1 lds
    v_mfma_f32_16x16x32_bf16 a[108:111], v[44:47], v[204:207], a[108:111]
    s_add_u32 m0, s31, 20480
    v_mfma_f32_16x16x32_bf16 a[140:143], v[44:47], v[208:211], a[140:143]
    buffer_load_dwordx4 v[136:139], v1, s[20:23], s28 offen offset:2048 sc1
    v_mfma_f32_16x16x32_bf16 a[172:175], v[44:47], v[212:215], a[172:175]
    v_add_u32 v5, s6, v20
    v_mfma_f32_16x16x32_bf16 a[204:207], v[44:47], v[216:219], a[204:207]
    s_cmp_lt_u32 s3, 3
    s_cselect_b32 s6, 2, 2
    v_mfma_f32_16x16x32_bf16 a[236:239], v[44:47], v[220:223], a[236:239]
    s_lshl_b32 s6, s6, 13
    s_waitcnt lgkmcnt(2)
    v_mfma_f32_16x16x32_bf16 a[16:19], v[48:51], v[192:195], a[16:19]
    ds_read_b128 v[60:63], v25 offset:7168
    v_mfma_f32_16x16x32_bf16 a[48:51], v[48:51], v[196:199], a[48:51]
    buffer_load_dwordx4 v[140:143], v1, s[20:23], s28 offen offset:3072 sc1
    v_mfma_f32_16x16x32_bf16 a[80:83], v[48:51], v[200:203], a[80:83]
    buffer_load_dwordx4 v24, s[20:23], s35 offen offset:0 sc1 lds
    v_mfma_f32_16x16x32_bf16 a[112:115], v[48:51], v[204:207], a[112:115]
    buffer_load_dwordx4 v24, s[20:23], s35 offen offset:1024 sc1 lds
    v_mfma_f32_16x16x32_bf16 a[144:147], v[48:51], v[208:211], a[144:147]
    buffer_load_dwordx4 v[144:147], v2, s[20:23], s28 offen offset:0 sc1
    v_mfma_f32_16x16x32_bf16 a[176:179], v[48:51], v[212:215], a[176:179]
    v_add_u32 v6, s6, v20
    v_mfma_f32_16x16x32_bf16 a[208:211], v[48:51], v[216:219], a[208:211]
    s_cmp_le_u32 s3, 0
    s_cselect_b32 s6, 1, 0
    s_cselect_b32 s7, 0, 1
    v_mfma_f32_16x16x32_bf16 a[240:243], v[48:51], v[220:223], a[240:243]
    s_mul_i32 s6, s6, 40960
    s_waitcnt lgkmcnt(2)
    v_mfma_f32_16x16x32_bf16 a[20:23], v[52:55], v[192:195], a[20:23]
    s_waitcnt vmcnt(13)
    v_mfma_f32_16x16x32_bf16 a[52:55], v[52:55], v[196:199], a[52:55]
    ds_read_b128 v[32:35], v25 offset:8192
    v_mfma_f32_16x16x32_bf16 a[84:87], v[52:55], v[200:203], a[84:87]
    buffer_load_dwordx4 v[148:151], v2, s[20:23], s28 offen offset:1024 sc1
    buffer_load_dwordx4 v24, s[20:23], s35 offen offset:2048 sc1 lds
    v_mfma_f32_16x16x32_bf16 a[116:119], v[52:55], v[204:207], a[116:119]
    buffer_load_dwordx4 v24, s[20:23], s35 offen offset:3072 sc1 lds
    v_mfma_f32_16x16x32_bf16 a[148:151], v[52:55], v[208:211], a[148:151]
    buffer_load_dwordx4 v[152:155], v2, s[20:23], s28 offen offset:2048 sc1
    v_mfma_f32_16x16x32_bf16 a[180:183], v[52:55], v[212:215], a[180:183]
    s_sub_u32 s7, s3, s7
    v_mfma_f32_16x16x32_bf16 a[212:215], v[52:55], v[216:219], a[212:215]
    s_lshl_b32 s7, s7, 13
    v_mfma_f32_16x16x32_bf16 a[244:247], v[52:55], v[220:223], a[244:247]
    s_add_u32 s7, s7, s6
    s_waitcnt lgkmcnt(2)
    v_mfma_f32_16x16x32_bf16 a[24:27], v[56:59], v[192:195], a[24:27]
    ds_read_b128 v[36:39], v25 offset:9216
    v_mfma_f32_16x16x32_bf16 a[56:59], v[56:59], v[196:199], a[56:59]
    buffer_load_dwordx4 v[156:159], v2, s[20:23], s28 offen offset:3072 sc1
    v_mfma_f32_16x16x32_bf16 a[88:91], v[56:59], v[200:203], a[88:91]
    v_add_u32 v7, s7, v15
    v_mfma_f32_16x16x32_bf16 a[120:123], v[56:59], v[204:207], a[120:123]
    v_mfma_f32_16x16x32_bf16 a[152:155], v[56:59], v[208:211], a[152:155]
    s_cmp_le_u32 s3, 1
    s_cselect_b32 s6, 2, 1
    s_cselect_b32 s7, 0, 1
    v_mfma_f32_16x16x32_bf16 a[184:187], v[56:59], v[212:215], a[184:187]
    v_mfma_f32_16x16x32_bf16 a[216:219], v[56:59], v[216:219], a[216:219]
    s_mul_i32 s6, s6, 40960
    v_mfma_f32_16x16x32_bf16 a[248:251], v[56:59], v[220:223], a[248:251]
    s_waitcnt lgkmcnt(2)
    v_mfma_f32_16x16x32_bf16 a[28:31], v[60:63], v[192:195], a[28:31]
    ds_read_b128 v[40:43], v25 offset:10240
    v_mfma_f32_16x16x32_bf16 a[60:63], v[60:63], v[196:199], a[60:63]
    s_sub_u32 s7, s3, s7
    v_mfma_f32_16x16x32_bf16 a[92:95], v[60:63], v[200:203], a[92:95]
    v_mfma_f32_16x16x32_bf16 a[124:127], v[60:63], v[204:207], a[124:127]
    s_lshl_b32 s7, s7, 13
    v_mfma_f32_16x16x32_bf16 a[156:159], v[60:63], v[208:211], a[156:159]
    v_mfma_f32_16x16x32_bf16 a[188:191], v[60:63], v[212:215], a[188:191]
    s_add_u32 s7, s7, s6
    v_mfma_f32_16x16x32_bf16 a[220:223], v[60:63], v[216:219], a[220:223]
    v_mfma_f32_16x16x32_bf16 a[252:255], v[60:63], v[220:223], a[252:255]
    s_waitcnt vmcnt(16)
    s_waitcnt lgkmcnt(2)
    v_mfma_f32_16x16x32_bf16 a[0:3], v[32:35], v[96:99], a[0:3]
    ds_read_b128 v[44:47], v25 offset:11264
    v_mfma_f32_16x16x32_bf16 a[32:35], v[32:35], v[100:103], a[32:35]
    s_bfe_u32 s30, s88, 0x40010
    v_mfma_f32_16x16x32_bf16 a[64:67], v[32:35], v[104:107], a[64:67]
    s_lshl_b32 s30, s30, 13
    v_mfma_f32_16x16x32_bf16 a[96:99], v[32:35], v[108:111], a[96:99]
    s_bfe_u32 s28, s88, 0x40010
    v_mfma_f32_16x16x32_bf16 a[128:131], v[32:35], v[112:115], a[128:131]
    s_add_u32 s30, s30, s32
    v_mfma_f32_16x16x32_bf16 a[160:163], v[32:35], v[116:119], a[160:163]
    v_add_u32 v8, s7, v15
    v_mfma_f32_16x16x32_bf16 a[192:195], v[32:35], v[120:123], a[192:195]
    s_cmp_le_u32 s3, 2
    s_cselect_b32 s6, 3, 2
    s_cselect_b32 s7, 0, 1
    v_mfma_f32_16x16x32_bf16 a[224:227], v[32:35], v[124:127], a[224:227]
    s_mul_i32 s6, s6, 40960
    s_waitcnt lgkmcnt(2)
    v_mfma_f32_16x16x32_bf16 a[4:7], v[36:39], v[96:99], a[4:7]
    ds_read_b128 v[48:51], v25 offset:12288
    v_mfma_f32_16x16x32_bf16 a[36:39], v[36:39], v[100:103], a[36:39]
    s_xor_b32 s35, s30, 4096
    v_mfma_f32_16x16x32_bf16 a[68:71], v[36:39], v[104:107], a[68:71]
    s_lshl_b32 s28, s28, 13
    v_mfma_f32_16x16x32_bf16 a[100:103], v[36:39], v[108:111], a[100:103]
    s_add_u32 m0, s31, 24576
    v_mfma_f32_16x16x32_bf16 a[132:135], v[36:39], v[112:115], a[132:135]
    buffer_load_dwordx4 v24, s[20:23], s30 offen offset:0 sc1 lds
    v_mfma_f32_16x16x32_bf16 a[164:167], v[36:39], v[116:119], a[164:167]
    s_sub_u32 s7, s3, s7
    v_mfma_f32_16x16x32_bf16 a[196:199], v[36:39], v[120:123], a[196:199]
    s_lshl_b32 s7, s7, 13
    v_mfma_f32_16x16x32_bf16 a[228:231], v[36:39], v[124:127], a[228:231]
    s_add_u32 s7, s7, s6
    s_waitcnt lgkmcnt(2)
    v_mfma_f32_16x16x32_bf16 a[8:11], v[40:43], v[96:99], a[8:11]
    ds_read_b128 v[52:55], v25 offset:13312
    v_mfma_f32_16x16x32_bf16 a[40:43], v[40:43], v[100:103], a[40:43]
    s_add_u32 s28, s28, s29
    v_mfma_f32_16x16x32_bf16 a[72:75], v[40:43], v[104:107], a[72:75]
    buffer_load_dwordx4 v24, s[20:23], s30 offen offset:1024 sc1 lds
    v_mfma_f32_16x16x32_bf16 a[104:107], v[40:43], v[108:111], a[104:107]
    buffer_load_dwordx4 v24, s[20:23], s30 offen offset:2048 sc1 lds
    v_mfma_f32_16x16x32_bf16 a[136:139], v[40:43], v[112:115], a[136:139]
    buffer_load_dwordx4 v[160:163], v1, s[20:23], s28 offen offset:0 sc1
    v_mfma_f32_16x16x32_bf16 a[168:171], v[40:43], v[116:119], a[168:171]
    v_add_u32 v9, s7, v15
    v_mfma_f32_16x16x32_bf16 a[200:203], v[40:43], v[120:123], a[200:203]
    s_lshl_b32 s6, s2, 2
    v_mfma_f32_16x16x32_bf16 a[232:235], v[40:43], v[124:127], a[232:235]
    s_add_u32 s6, s6, s3
    s_waitcnt lgkmcnt(2)
    v_mfma_f32_16x16x32_bf16 a[12:15], v[44:47], v[96:99], a[12:15]
    ds_read_b128 v[56:59], v25 offset:14336
    v_mfma_f32_16x16x32_bf16 a[44:47], v[44:47], v[100:103], a[44:47]
    buffer_load_dwordx4 v[164:167], v1, s[20:23], s28 offen offset:1024 sc1
    v_mfma_f32_16x16x32_bf16 a[76:79], v[44:47], v[104:107], a[76:79]
    buffer_load_dwordx4 v24, s[20:23], s30 offen offset:3072 sc1 lds
    v_mfma_f32_16x16x32_bf16 a[108:111], v[44:47], v[108:111], a[108:111]
    s_add_u32 m0, s31, 28672
    v_mfma_f32_16x16x32_bf16 a[140:143], v[44:47], v[112:115], a[140:143]
    buffer_load_dwordx4 v[168:171], v1, s[20:23], s28 offen offset:2048 sc1
    v_mfma_f32_16x16x32_bf16 a[172:175], v[44:47], v[116:119], a[172:175]
    s_lshl_b32 s78, s6, 13
    v_mfma_f32_16x16x32_bf16 a[204:207], v[44:47], v[120:123], a[204:207]
    s_add_u32 s78, s78, 29360128
    v_mfma_f32_16x16x32_bf16 a[236:239], v[44:47], v[124:127], a[236:239]
    s_add_u32 s79, s78, 4096
    s_waitcnt lgkmcnt(2)
    v_mfma_f32_16x16x32_bf16 a[16:19], v[48:51], v[96:99], a[16:19]
    ds_read_b128 v[60:63], v25 offset:15360
    v_mfma_f32_16x16x32_bf16 a[48:51], v[48:51], v[100:103], a[48:51]
    buffer_load_dwordx4 v[172:175], v1, s[20:23], s28 offen offset:3072 sc1
    v_mfma_f32_16x16x32_bf16 a[80:83], v[48:51], v[104:107], a[80:83]
    buffer_load_dwordx4 v24, s[20:23], s35 offen offset:0 sc1 lds
    v_mfma_f32_16x16x32_bf16 a[112:115], v[48:51], v[108:111], a[112:115]
    buffer_load_dwordx4 v24, s[20:23], s35 offen offset:1024 sc1 lds
    v_mfma_f32_16x16x32_bf16 a[144:147], v[48:51], v[112:115], a[144:147]
    buffer_load_dwordx4 v[176:179], v2, s[20:23], s28 offen offset:0 sc1
    v_mfma_f32_16x16x32_bf16 a[176:179], v[48:51], v[116:119], a[176:179]
    s_xor_b32 s80, s78, 0x8000
    v_mfma_f32_16x16x32_bf16 a[208:211], v[48:51], v[120:123], a[208:211]
    s_add_u32 s81, s80, 4096
    v_mfma_f32_16x16x32_bf16 a[240:243], v[48:51], v[124:127], a[240:243]
    s_lshl_b32 s82, s6, 7
    s_waitcnt lgkmcnt(2)
    v_mfma_f32_16x16x32_bf16 a[20:23], v[52:55], v[96:99], a[20:23]
    s_waitcnt vmcnt(13)
    v_mfma_f32_16x16x32_bf16 a[52:55], v[52:55], v[100:103], a[52:55]
    ds_read_b128 v[32:35], v25 offset:16384
    v_mfma_f32_16x16x32_bf16 a[84:87], v[52:55], v[104:107], a[84:87]
    buffer_load_dwordx4 v[180:183], v2, s[20:23], s28 offen offset:1024 sc1
    buffer_load_dwordx4 v24, s[20:23], s35 offen offset:2048 sc1 lds
    v_mfma_f32_16x16x32_bf16 a[116:119], v[52:55], v[108:111], a[116:119]
    buffer_load_dwordx4 v24, s[20:23], s35 offen offset:3072 sc1 lds
    v_mfma_f32_16x16x32_bf16 a[148:151], v[52:55], v[112:115], a[148:151]
    buffer_load_dwordx4 v[184:187], v2, s[20:23], s28 offen offset:2048 sc1
    v_mfma_f32_16x16x32_bf16 a[180:183], v[52:55], v[116:119], a[180:183]
    s_add_u32 s82, s82, 24379392
    v_mfma_f32_16x16x32_bf16 a[212:215], v[52:55], v[120:123], a[212:215]
    s_xor_b32 s83, s82, 0x200
    v_mfma_f32_16x16x32_bf16 a[244:247], v[52:55], v[124:127], a[244:247]
    s_lshl_b32 s6, s92, 7
    s_waitcnt lgkmcnt(2)
    v_mfma_f32_16x16x32_bf16 a[24:27], v[56:59], v[96:99], a[24:27]
    ds_read_b128 v[36:39], v25 offset:17408
    v_mfma_f32_16x16x32_bf16 a[56:59], v[56:59], v[100:103], a[56:59]
    buffer_load_dwordx4 v[188:191], v2, s[20:23], s28 offen offset:3072 sc1
    v_mfma_f32_16x16x32_bf16 a[88:91], v[56:59], v[104:107], a[88:91]
    s_lshr_b32 s7, s3, 1
    v_mfma_f32_16x16x32_bf16 a[120:123], v[56:59], v[108:111], a[120:123]
    v_mfma_f32_16x16x32_bf16 a[152:155], v[56:59], v[112:115], a[152:155]
    s_lshl_b32 s7, s7, 6
    v_mfma_f32_16x16x32_bf16 a[184:187], v[56:59], v[116:119], a[184:187]
    v_mfma_f32_16x16x32_bf16 a[216:219], v[56:59], v[120:123], a[216:219]
    s_add_u32 s6, s6, s7
    v_mfma_f32_16x16x32_bf16 a[248:251], v[56:59], v[124:127], a[248:251]
    s_waitcnt lgkmcnt(2)
    v_mfma_f32_16x16x32_bf16 a[28:31], v[60:63], v[96:99], a[28:31]
    ds_read_b128 v[40:43], v25 offset:18432
    v_mfma_f32_16x16x32_bf16 a[60:63], v[60:63], v[100:103], a[60:63]
    s_and_b32 s7, s3, 1
    v_mfma_f32_16x16x32_bf16 a[92:95], v[60:63], v[104:107], a[92:95]
    v_mfma_f32_16x16x32_bf16 a[124:127], v[60:63], v[108:111], a[124:127]
    s_lshl_b32 s7, s7, 1
    v_mfma_f32_16x16x32_bf16 a[156:159], v[60:63], v[112:115], a[156:159]
    v_mfma_f32_16x16x32_bf16 a[188:191], v[60:63], v[116:119], a[188:191]
    s_add_u32 s74, s6, s7
    v_mfma_f32_16x16x32_bf16 a[220:223], v[60:63], v[120:123], a[220:223]
    v_mfma_f32_16x16x32_bf16 a[252:255], v[60:63], v[124:127], a[252:255]
    s_waitcnt vmcnt(16)
    s_waitcnt lgkmcnt(2)
    v_mfma_f32_16x16x32_bf16 a[0:3], v[32:35], v[128:131], a[0:3]
    ds_read_b128 v[44:47], v25 offset:19456
    v_mfma_f32_16x16x32_bf16 a[32:35], v[32:35], v[132:135], a[32:35]
    s_bfe_u32 s30, s88, 0x40014
    v_mfma_f32_16x16x32_bf16 a[64:67], v[32:35], v[136:139], a[64:67]
    s_lshl_b32 s30, s30, 13
    v_mfma_f32_16x16x32_bf16 a[96:99], v[32:35], v[140:143], a[96:99]
    s_bfe_u32 s28, s88, 0x40014
    v_mfma_f32_16x16x32_bf16 a[128:131], v[32:35], v[144:147], a[128:131]
    s_add_u32 s30, s30, s32
    v_mfma_f32_16x16x32_bf16 a[160:163], v[32:35], v[148:151], a[160:163]
    v_lshl_add_u32 v20, v18, 2, s74
    v_mfma_f32_16x16x32_bf16 a[192:195], v[32:35], v[152:155], a[192:195]
    s_lshl_b32 s7, s93, 7
    v_mfma_f32_16x16x32_bf16 a[224:227], v[32:35], v[156:159], a[224:227]
    s_lshl_b32 s6, s94, 6
    s_waitcnt lgkmcnt(2)
    v_mfma_f32_16x16x32_bf16 a[4:7], v[36:39], v[128:131], a[4:7]
    ds_read_b128 v[48:51], v25 offset:20480
    v_mfma_f32_16x16x32_bf16 a[36:39], v[36:39], v[132:135], a[36:39]
    s_xor_b32 s35, s30, 4096
    v_mfma_f32_16x16x32_bf16 a[68:71], v[36:39], v[136:139], a[68:71]
    s_lshl_b32 s28, s28, 13
    v_mfma_f32_16x16x32_bf16 a[100:103], v[36:39], v[140:143], a[100:103]
    s_add_u32 m0, s31, 32768
    v_mfma_f32_16x16x32_bf16 a[132:135], v[36:39], v[144:147], a[132:135]
    buffer_load_dwordx4 v24, s[20:23], s30 offen offset:0 sc1 lds
    v_mfma_f32_16x16x32_bf16 a[164:167], v[36:39], v[148:151], a[164:167]
    s_add_u32 s7, s7, s6
    v_mfma_f32_16x16x32_bf16 a[196:199], v[36:39], v[152:155], a[196:199]
    v_lshl_add_u32 v21, v19, 2, s7
    v_mfma_f32_16x16x32_bf16 a[228:231], v[36:39], v[156:159], a[228:231]
    v_lshlrev_b32 v28, 10, v20
    s_waitcnt lgkmcnt(2)
    v_mfma_f32_16x16x32_bf16 a[8:11], v[40:43], v[128:131], a[8:11]
    ds_read_b128 v[52:55], v25 offset:21504
    v_mfma_f32_16x16x32_bf16 a[40:43], v[40:43], v[132:135], a[40:43]
    s_add_u32 s28, s28, s29
    v_mfma_f32_16x16x32_bf16 a[72:75], v[40:43], v[136:139], a[72:75]
    buffer_load_dwordx4 v24, s[20:23], s30 offen offset:1024 sc1 lds
    v_mfma_f32_16x16x32_bf16 a[104:107], v[40:43], v[140:143], a[104:107]
    buffer_load_dwordx4 v24, s[20:23], s30 offen offset:2048 sc1 lds
    v_mfma_f32_16x16x32_bf16 a[136:139], v[40:43], v[144:147], a[136:139]
    buffer_load_dwordx4 v[192:195], v1, s[20:23], s28 offen offset:0 sc1
    v_mfma_f32_16x16x32_bf16 a[168:171], v[40:43], v[148:151], a[168:171]
    v_add_u32 v28, v28, v21
    v_mfma_f32_16x16x32_bf16 a[200:203], v[40:43], v[152:155], a[200:203]
    v_lshlrev_b32 v28, 2, v28
    v_mfma_f32_16x16x32_bf16 a[232:235], v[40:43], v[156:159], a[232:235]
    v_add_u32 v29, 0x1000, v28
    s_waitcnt lgkmcnt(2)
    v_mfma_f32_16x16x32_bf16 a[12:15], v[44:47], v[128:131], a[12:15]
    ds_read_b128 v[56:59], v25 offset:22528
    v_mfma_f32_16x16x32_bf16 a[44:47], v[44:47], v[132:135], a[44:47]
    buffer_load_dwordx4 v[196:199], v1, s[20:23], s28 offen offset:1024 sc1
    v_mfma_f32_16x16x32_bf16 a[76:79], v[44:47], v[136:139], a[76:79]
    buffer_load_dwordx4 v24, s[20:23], s30 offen offset:3072 sc1 lds
    v_mfma_f32_16x16x32_bf16 a[108:111], v[44:47], v[140:143], a[108:111]
    s_add_u32 m0, s31, 36864
    v_mfma_f32_16x16x32_bf16 a[140:143], v[44:47], v[144:147], a[140:143]
    buffer_load_dwordx4 v[200:203], v1, s[20:23], s28 offen offset:2048 sc1
    v_mfma_f32_16x16x32_bf16 a[172:175], v[44:47], v[148:151], a[172:175]
    v_lshlrev_b32 v22, 1, v21
    v_mfma_f32_16x16x32_bf16 a[204:207], v[44:47], v[152:155], a[204:207]
    v_lshlrev_b32 v21, 2, v20
    v_mfma_f32_16x16x32_bf16 a[236:239], v[44:47], v[156:159], a[236:239]
    v_bfe_u32 v20, v17, 3, 1
    s_waitcnt lgkmcnt(2)
    v_mfma_f32_16x16x32_bf16 a[16:19], v[48:51], v[128:131], a[16:19]
    ds_read_b128 v[60:63], v25 offset:23552
    v_mfma_f32_16x16x32_bf16 a[48:51], v[48:51], v[132:135], a[48:51]
    buffer_load_dwordx4 v[204:207], v1, s[20:23], s28 offen offset:3072 sc1
    v_mfma_f32_16x16x32_bf16 a[80:83], v[48:51], v[136:139], a[80:83]
    buffer_load_dwordx4 v24, s[20:23], s35 offen offset:0 sc1 lds
    v_mfma_f32_16x16x32_bf16 a[112:115], v[48:51], v[140:143], a[112:115]
    buffer_load_dwordx4 v24, s[20:23], s35 offen offset:1024 sc1 lds
    v_mfma_f32_16x16x32_bf16 a[144:147], v[48:51], v[144:147], a[144:147]
    buffer_load_dwordx4 v[208:211], v2, s[20:23], s28 offen offset:0 sc1
    v_mfma_f32_16x16x32_bf16 a[176:179], v[48:51], v[148:151], a[176:179]
    v_lshl_add_u32 v20, v19, 2, v20
    v_mfma_f32_16x16x32_bf16 a[208:211], v[48:51], v[152:155], a[208:211]
    v_add_u32 v20, s74, v20
    v_mfma_f32_16x16x32_bf16 a[240:243], v[48:51], v[156:159], a[240:243]
    v_lshlrev_b32 v20, 11, v20
    s_waitcnt lgkmcnt(2)
    v_mfma_f32_16x16x32_bf16 a[20:23], v[52:55], v[128:131], a[20:23]
    s_waitcnt vmcnt(13)
    v_mfma_f32_16x16x32_bf16 a[52:55], v[52:55], v[132:135], a[52:55]
    ds_read_b128 v[32:35], v25 offset:24576
    v_mfma_f32_16x16x32_bf16 a[84:87], v[52:55], v[136:139], a[84:87]
    buffer_load_dwordx4 v[212:215], v2, s[20:23], s28 offen offset:1024 sc1
    buffer_load_dwordx4 v24, s[20:23], s35 offen offset:2048 sc1 lds
    v_mfma_f32_16x16x32_bf16 a[116:119], v[52:55], v[140:143], a[116:119]
    buffer_load_dwordx4 v24, s[20:23], s35 offen offset:3072 sc1 lds
    v_mfma_f32_16x16x32_bf16 a[148:151], v[52:55], v[144:147], a[148:151]
    buffer_load_dwordx4 v[216:219], v2, s[20:23], s28 offen offset:2048 sc1
    v_mfma_f32_16x16x32_bf16 a[180:183], v[52:55], v[148:151], a[180:183]
    v_and_b32 v23, 7, v17
    v_mfma_f32_16x16x32_bf16 a[212:215], v[52:55], v[152:155], a[212:215]
    v_xor_b32 v23, v23, v19
    v_mfma_f32_16x16x32_bf16 a[244:247], v[52:55], v[156:159], a[244:247]
    v_lshl_add_u32 v23, v23, 4, v20
    s_waitcnt lgkmcnt(2)
    v_mfma_f32_16x16x32_bf16 a[24:27], v[56:59], v[128:131], a[24:27]
    ds_read_b128 v[36:39], v25 offset:25600
    v_mfma_f32_16x16x32_bf16 a[56:59], v[56:59], v[132:135], a[56:59]
    buffer_load_dwordx4 v[220:223], v2, s[20:23], s28 offen offset:3072 sc1
    v_mfma_f32_16x16x32_bf16 a[88:91], v[56:59], v[136:139], a[88:91]
    s_lshl_b32 s7, s7, 1
    v_mfma_f32_16x16x32_bf16 a[120:123], v[56:59], v[140:143], a[120:123]
    v_mfma_f32_16x16x32_bf16 a[152:155], v[56:59], v[144:147], a[152:155]
    v_add_u32 v23, s7, v23
    v_mfma_f32_16x16x32_bf16 a[184:187], v[56:59], v[148:151], a[184:187]
    v_mfma_f32_16x16x32_bf16 a[216:219], v[56:59], v[152:155], a[216:219]
    v_xor_b32 v11, 64, v23
    v_mfma_f32_16x16x32_bf16 a[248:251], v[56:59], v[156:159], a[248:251]
    s_waitcnt lgkmcnt(2)
    v_mfma_f32_16x16x32_bf16 a[28:31], v[60:63], v[128:131], a[28:31]
    ds_read_b128 v[40:43], v25 offset:26624
    v_mfma_f32_16x16x32_bf16 a[60:63], v[60:63], v[132:135], a[60:63]
    v_add_u32 v11, 0x7c00, v11
    v_mfma_f32_16x16x32_bf16 a[92:95], v[60:63], v[136:139], a[92:95]
    v_mfma_f32_16x16x32_bf16 a[124:127], v[60:63], v[140:143], a[124:127]
    v_and_b32 v20, 7, v18
    v_mfma_f32_16x16x32_bf16 a[156:159], v[60:63], v[144:147], a[156:159]
    v_mfma_f32_16x16x32_bf16 a[188:191], v[60:63], v[148:151], a[188:191]
    v_lshrrev_b32 v10, 1, v19
    v_mfma_f32_16x16x32_bf16 a[220:223], v[60:63], v[152:155], a[220:223]
    v_mfma_f32_16x16x32_bf16 a[252:255], v[60:63], v[156:159], a[252:255]
    s_waitcnt vmcnt(16)
    s_waitcnt lgkmcnt(2)
    v_mfma_f32_16x16x32_bf16 a[0:3], v[32:35], v[160:163], a[0:3]
    ds_read_b128 v[44:47], v25 offset:27648
    v_mfma_f32_16x16x32_bf16 a[32:35], v[32:35], v[164:167], a[32:35]
    s_bfe_u32 s30, s88, 0x40018
    v_mfma_f32_16x16x32_bf16 a[64:67], v[32:35], v[168:171], a[64:67]
    s_lshl_b32 s30, s30, 13
    v_mfma_f32_16x16x32_bf16 a[96:99], v[32:35], v[172:175], a[96:99]
    s_bfe_u32 s28, s88, 0x40018
    v_mfma_f32_16x16x32_bf16 a[128:131], v[32:35], v[176:179], a[128:131]
    s_add_u32 s30, s30, s32
    v_mfma_f32_16x16x32_bf16 a[160:163], v[32:35], v[180:183], a[160:163]
    v_xor_b32 v20, v20, v10
    v_mfma_f32_16x16x32_bf16 a[192:195], v[32:35], v[184:187], a[192:195]
    v_lshlrev_b32 v20, 4, v20
    v_mfma_f32_16x16x32_bf16 a[224:227], v[32:35], v[188:191], a[224:227]
    v_and_b32 v10, 1, v19
    s_waitcnt lgkmcnt(2)
    v_mfma_f32_16x16x32_bf16 a[4:7], v[36:39], v[160:163], a[4:7]
    ds_read_b128 v[48:51], v25 offset:28672
    v_mfma_f32_16x16x32_bf16 a[36:39], v[36:39], v[164:167], a[36:39]
    s_xor_b32 s35, s30, 4096
    v_mfma_f32_16x16x32_bf16 a[68:71], v[36:39], v[168:171], a[68:71]
    s_lshl_b32 s28, s28, 13
    v_mfma_f32_16x16x32_bf16 a[100:103], v[36:39], v[172:175], a[100:103]
    s_add_u32 m0, s31, 0
    v_mfma_f32_16x16x32_bf16 a[132:135], v[36:39], v[176:179], a[132:135]
    buffer_load_dwordx4 v24, s[20:23], s30 offen offset:0 sc1 lds
    v_mfma_f32_16x16x32_bf16 a[164:167], v[36:39], v[180:183], a[164:167]
    v_lshl_add_u32 v20, v10, 3, v20
    v_mfma_f32_16x16x32_bf16 a[196:199], v[36:39], v[184:187], a[196:199]
    v_lshl_add_u32 v20, v18, 8, v20
    v_mfma_f32_16x16x32_bf16 a[228:231], v[36:39], v[188:191], a[228:231]
    v_add_u32 v10, s31, v20
    s_waitcnt lgkmcnt(2)
    v_mfma_f32_16x16x32_bf16 a[8:11], v[40:43], v[160:163], a[8:11]
    ds_read_b128 v[52:55], v25 offset:29696
    v_mfma_f32_16x16x32_bf16 a[40:43], v[40:43], v[164:167], a[40:43]
    s_add_u32 s28, s28, s29
    v_mfma_f32_16x16x32_bf16 a[72:75], v[40:43], v[168:171], a[72:75]
    buffer_load_dwordx4 v24, s[20:23], s30 offen offset:1024 sc1 lds
    v_mfma_f32_16x16x32_bf16 a[104:107], v[40:43], v[172:175], a[104:107]
    buffer_load_dwordx4 v24, s[20:23], s30 offen offset:2048 sc1 lds
    v_mfma_f32_16x16x32_bf16 a[136:139], v[40:43], v[176:179], a[136:139]
    buffer_load_dwordx4 v[96:99], v1, s[20:23], s28 offen offset:0 sc1
    v_mfma_f32_16x16x32_bf16 a[168:171], v[40:43], v[180:183], a[168:171]
    s_mov_b32 s74, 23068672
    v_mfma_f32_16x16x32_bf16 a[200:203], v[40:43], v[184:187], a[200:203]
    s_mov_b32 s89, 0xf800
    v_mfma_f32_16x16x32_bf16 a[232:235], v[40:43], v[188:191], a[232:235]
    s_waitcnt lgkmcnt(2)
    v_mfma_f32_16x16x32_bf16 a[12:15], v[44:47], v[160:163], a[12:15]
    ds_read_b128 v[56:59], v25 offset:30720
    v_mfma_f32_16x16x32_bf16 a[44:47], v[44:47], v[164:167], a[44:47]
    buffer_load_dwordx4 v[100:103], v1, s[20:23], s28 offen offset:1024 sc1
    v_mfma_f32_16x16x32_bf16 a[76:79], v[44:47], v[168:171], a[76:79]
    buffer_load_dwordx4 v24, s[20:23], s30 offen offset:3072 sc1 lds
    v_mfma_f32_16x16x32_bf16 a[108:111], v[44:47], v[172:175], a[108:111]
    v_mfma_f32_16x16x32_bf16 a[140:143], v[44:47], v[176:179], a[140:143]
    s_add_u32 m0, s31, 4096
    v_mfma_f32_16x16x32_bf16 a[172:175], v[44:47], v[180:183], a[172:175]
    v_mfma_f32_16x16x32_bf16 a[204:207], v[44:47], v[184:187], a[204:207]
    buffer_load_dwordx4 v[104:107], v1, s[20:23], s28 offen offset:2048 sc1
    v_mfma_f32_16x16x32_bf16 a[236:239], v[44:47], v[188:191], a[236:239]
    s_waitcnt lgkmcnt(2)
    v_mfma_f32_16x16x32_bf16 a[16:19], v[48:51], v[160:163], a[16:19]
    ds_read_b128 v[60:63], v25 offset:31744
    v_mfma_f32_16x16x32_bf16 a[48:51], v[48:51], v[164:167], a[48:51]
    buffer_load_dwordx4 v[108:111], v1, s[20:23], s28 offen offset:3072 sc1
    v_mfma_f32_16x16x32_bf16 a[80:83], v[48:51], v[168:171], a[80:83]
    buffer_load_dwordx4 v24, s[20:23], s35 offen offset:0 sc1 lds
    v_mfma_f32_16x16x32_bf16 a[112:115], v[48:51], v[172:175], a[112:115]
    v_mfma_f32_16x16x32_bf16 a[144:147], v[48:51], v[176:179], a[144:147]
    buffer_load_dwordx4 v24, s[20:23], s35 offen offset:1024 sc1 lds
    v_mfma_f32_16x16x32_bf16 a[176:179], v[48:51], v[180:183], a[176:179]
    v_mfma_f32_16x16x32_bf16 a[208:211], v[48:51], v[184:187], a[208:211]
    buffer_load_dwordx4 v[112:115], v2, s[20:23], s28 offen offset:0 sc1
    v_mfma_f32_16x16x32_bf16 a[240:243], v[48:51], v[188:191], a[240:243]
    s_waitcnt lgkmcnt(2)
    v_mfma_f32_16x16x32_bf16 a[20:23], v[52:55], v[160:163], a[20:23]
    s_waitcnt vmcnt(13)
    v_mfma_f32_16x16x32_bf16 a[52:55], v[52:55], v[164:167], a[52:55]
    ds_read_b128 v[32:35], v25 offset:32768
    v_mfma_f32_16x16x32_bf16 a[84:87], v[52:55], v[168:171], a[84:87]
    buffer_load_dwordx4 v[116:119], v2, s[20:23], s28 offen offset:1024 sc1
    v_mfma_f32_16x16x32_bf16 a[116:119], v[52:55], v[172:175], a[116:119]
    buffer_load_dwordx4 v24, s[20:23], s35 offen offset:2048 sc1 lds
    v_mfma_f32_16x16x32_bf16 a[148:151], v[52:55], v[176:179], a[148:151]
    v_mfma_f32_16x16x32_bf16 a[180:183], v[52:55], v[180:183], a[180:183]
    buffer_load_dwordx4 v24, s[20:23], s35 offen offset:3072 sc1 lds
    v_mfma_f32_16x16x32_bf16 a[212:215], v[52:55], v[184:187], a[212:215]
    buffer_load_dwordx4 v[120:123], v2, s[20:23], s28 offen offset:2048 sc1
    v_mfma_f32_16x16x32_bf16 a[244:247], v[52:55], v[188:191], a[244:247]
    s_waitcnt lgkmcnt(2)
    v_mfma_f32_16x16x32_bf16 a[24:27], v[56:59], v[160:163], a[24:27]
    ds_read_b128 v[36:39], v25 offset:33792
    v_mfma_f32_16x16x32_bf16 a[56:59], v[56:59], v[164:167], a[56:59]
    buffer_load_dwordx4 v[124:127], v2, s[20:23], s28 offen offset:3072 sc1
    v_mfma_f32_16x16x32_bf16 a[88:91], v[56:59], v[168:171], a[88:91]
    v_mfma_f32_16x16x32_bf16 a[120:123], v[56:59], v[172:175], a[120:123]
    v_mfma_f32_16x16x32_bf16 a[152:155], v[56:59], v[176:179], a[152:155]
    v_mfma_f32_16x16x32_bf16 a[184:187], v[56:59], v[180:183], a[184:187]
    v_mfma_f32_16x16x32_bf16 a[216:219], v[56:59], v[184:187], a[216:219]
    v_mfma_f32_16x16x32_bf16 a[248:251], v[56:59], v[188:191], a[248:251]
    s_waitcnt lgkmcnt(2)
    v_mfma_f32_16x16x32_bf16 a[28:31], v[60:63], v[160:163], a[28:31]
    ds_read_b128 v[40:43], v25 offset:34816
    v_mfma_f32_16x16x32_bf16 a[60:63], v[60:63], v[164:167], a[60:63]
    v_mfma_f32_16x16x32_bf16 a[92:95], v[60:63], v[168:171], a[92:95]
    v_mfma_f32_16x16x32_bf16 a[124:127], v[60:63], v[172:175], a[124:127]
    v_mfma_f32_16x16x32_bf16 a[156:159], v[60:63], v[176:179], a[156:159]
    v_mfma_f32_16x16x32_bf16 a[188:191], v[60:63], v[180:183], a[188:191]
    v_mfma_f32_16x16x32_bf16 a[220:223], v[60:63], v[184:187], a[220:223]
    v_mfma_f32_16x16x32_bf16 a[252:255], v[60:63], v[188:191], a[252:255]
    s_waitcnt vmcnt(16)
    s_waitcnt lgkmcnt(2)
    v_mfma_f32_16x16x32_bf16 a[0:3], v[32:35], v[192:195], a[0:3]
    ds_read_b128 v[44:47], v25 offset:35840
    v_mfma_f32_16x16x32_bf16 a[32:35], v[32:35], v[196:199], a[32:35]
    s_bfe_u32 s30, s88, 0x4001c
    v_mfma_f32_16x16x32_bf16 a[64:67], v[32:35], v[200:203], a[64:67]
    s_lshl_b32 s30, s30, 13
    v_mfma_f32_16x16x32_bf16 a[96:99], v[32:35], v[204:207], a[96:99]
    s_bfe_u32 s28, s88, 0x4001c
    v_mfma_f32_16x16x32_bf16 a[128:131], v[32:35], v[208:211], a[128:131]
    v_mfma_f32_16x16x32_bf16 a[160:163], v[32:35], v[212:215], a[160:163]
    s_add_u32 s30, s30, s32
    v_mfma_f32_16x16x32_bf16 a[192:195], v[32:35], v[216:219], a[192:195]
    s_xor_b32 s35, s30, 4096
    v_mfma_f32_16x16x32_bf16 a[224:227], v[32:35], v[220:223], a[224:227]
    s_waitcnt lgkmcnt(2)
    v_mfma_f32_16x16x32_bf16 a[4:7], v[36:39], v[192:195], a[4:7]
    ds_read_b128 v[48:51], v25 offset:36864
    v_mfma_f32_16x16x32_bf16 a[36:39], v[36:39], v[196:199], a[36:39]
    s_lshl_b32 s28, s28, 13
    v_mfma_f32_16x16x32_bf16 a[68:71], v[36:39], v[200:203], a[68:71]
    s_add_u32 m0, s31, 8192
    v_mfma_f32_16x16x32_bf16 a[100:103], v[36:39], v[204:207], a[100:103]
    buffer_load_dwordx4 v24, s[20:23], s30 offen offset:0 sc1 lds
    v_mfma_f32_16x16x32_bf16 a[132:135], v[36:39], v[208:211], a[132:135]
    v_mfma_f32_16x16x32_bf16 a[164:167], v[36:39], v[212:215], a[164:167]
    s_add_u32 s28, s28, s29
    v_mfma_f32_16x16x32_bf16 a[196:199], v[36:39], v[216:219], a[196:199]
    buffer_load_dwordx4 v24, s[20:23], s30 offen offset:1024 sc1 lds
    v_mfma_f32_16x16x32_bf16 a[228:231], v[36:39], v[220:223], a[228:231]
    s_waitcnt lgkmcnt(2)
    v_mfma_f32_16x16x32_bf16 a[8:11], v[40:43], v[192:195], a[8:11]
    ds_read_b128 v[52:55], v25 offset:37888
    v_mfma_f32_16x16x32_bf16 a[40:43], v[40:43], v[196:199], a[40:43]
    buffer_load_dwordx4 v24, s[20:23], s30 offen offset:2048 sc1 lds
    v_mfma_f32_16x16x32_bf16 a[72:75], v[40:43], v[200:203], a[72:75]
    buffer_load_dwordx4 v[128:131], v1, s[20:23], s28 offen offset:0 sc1
    v_mfma_f32_16x16x32_bf16 a[104:107], v[40:43], v[204:207], a[104:107]
    buffer_load_dwordx4 v[132:135], v1, s[20:23], s28 offen offset:1024 sc1
    v_mfma_f32_16x16x32_bf16 a[136:139], v[40:43], v[208:211], a[136:139]
    v_mfma_f32_16x16x32_bf16 a[168:171], v[40:43], v[212:215], a[168:171]
    buffer_load_dwordx4 v24, s[20:23], s30 offen offset:3072 sc1 lds
    v_mfma_f32_16x16x32_bf16 a[200:203], v[40:43], v[216:219], a[200:203]
    s_add_u32 m0, s31, 12288
    v_mfma_f32_16x16x32_bf16 a[232:235], v[40:43], v[220:223], a[232:235]
    s_waitcnt lgkmcnt(2)
    v_mfma_f32_16x16x32_bf16 a[12:15], v[44:47], v[192:195], a[12:15]
    ds_read_b128 v[56:59], v25 offset:38912
    v_mfma_f32_16x16x32_bf16 a[44:47], v[44:47], v[196:199], a[44:47]
    buffer_load_dwordx4 v[136:139], v1, s[20:23], s28 offen offset:2048 sc1
    v_mfma_f32_16x16x32_bf16 a[76:79], v[44:47], v[200:203], a[76:79]
    buffer_load_dwordx4 v[140:143], v1, s[20:23], s28 offen offset:3072 sc1
    v_mfma_f32_16x16x32_bf16 a[108:111], v[44:47], v[204:207], a[108:111]
    buffer_load_dwordx4 v24, s[20:23], s35 offen offset:0 sc1 lds
    v_mfma_f32_16x16x32_bf16 a[140:143], v[44:47], v[208:211], a[140:143]
    v_mfma_f32_16x16x32_bf16 a[172:175], v[44:47], v[212:215], a[172:175]
    buffer_load_dwordx4 v24, s[20:23], s35 offen offset:1024 sc1 lds
    v_mfma_f32_16x16x32_bf16 a[204:207], v[44:47], v[216:219], a[204:207]
    buffer_load_dwordx4 v[144:147], v2, s[20:23], s28 offen offset:0 sc1
    v_mfma_f32_16x16x32_bf16 a[236:239], v[44:47], v[220:223], a[236:239]
    s_waitcnt lgkmcnt(2)
    v_mfma_f32_16x16x32_bf16 a[16:19], v[48:51], v[192:195], a[16:19]
    ds_read_b128 v[60:63], v25 offset:39936
    v_mfma_f32_16x16x32_bf16 a[48:51], v[48:51], v[196:199], a[48:51]
    buffer_load_dwordx4 v[148:151], v2, s[20:23], s28 offen offset:1024 sc1
    v_mfma_f32_16x16x32_bf16 a[80:83], v[48:51], v[200:203], a[80:83]
    buffer_load_dwordx4 v24, s[20:23], s35 offen offset:2048 sc1 lds
    v_mfma_f32_16x16x32_bf16 a[112:115], v[48:51], v[204:207], a[112:115]
    buffer_load_dwordx4 v24, s[20:23], s35 offen offset:3072 sc1 lds
    v_mfma_f32_16x16x32_bf16 a[144:147], v[48:51], v[208:211], a[144:147]
    v_mfma_f32_16x16x32_bf16 a[176:179], v[48:51], v[212:215], a[176:179]
    buffer_load_dwordx4 v[152:155], v2, s[20:23], s28 offen offset:2048 sc1
    v_mfma_f32_16x16x32_bf16 a[208:211], v[48:51], v[216:219], a[208:211]
    buffer_load_dwordx4 v[156:159], v2, s[20:23], s28 offen offset:3072 sc1
    v_mfma_f32_16x16x32_bf16 a[240:243], v[48:51], v[220:223], a[240:243]
    s_waitcnt lgkmcnt(2)
    v_mfma_f32_16x16x32_bf16 a[20:23], v[52:55], v[192:195], a[20:23]
    s_waitcnt vmcnt(18)
    v_mfma_f32_16x16x32_bf16 a[52:55], v[52:55], v[196:199], a[52:55]
    ds_read_b128 v[32:35], v25 offset:4096
    v_mfma_f32_16x16x32_bf16 a[84:87], v[52:55], v[200:203], a[84:87]
    buffer_load_dwordx2 v[30:31], v21, s[20:23], s74 offen sc1
    v_mfma_f32_16x16x32_bf16 a[116:119], v[52:55], v[204:207], a[116:119]
    global_load_dwordx2 v[80:81], v22, s[52:53] offset:0
    v_mfma_f32_16x16x32_bf16 a[148:151], v[52:55], v[208:211], a[148:151]
    global_load_dwordx2 v[82:83], v22, s[52:53] offset:32
    v_mfma_f32_16x16x32_bf16 a[180:183], v[52:55], v[212:215], a[180:183]
    global_load_dwordx2 v[84:85], v22, s[52:53] offset:64
    v_mfma_f32_16x16x32_bf16 a[212:215], v[52:55], v[216:219], a[212:215]
    global_load_dwordx2 v[86:87], v22, s[52:53] offset:96
    v_mfma_f32_16x16x32_bf16 a[244:247], v[52:55], v[220:223], a[244:247]
    s_waitcnt lgkmcnt(2)
    v_mfma_f32_16x16x32_bf16 a[24:27], v[56:59], v[192:195], a[24:27]
    ds_read_b128 v[36:39], v25 offset:5120
    v_mfma_f32_16x16x32_bf16 a[56:59], v[56:59], v[196:199], a[56:59]
    s_add_u32 m0, s31, 16384
    v_mfma_f32_16x16x32_bf16 a[88:91], v[56:59], v[200:203], a[88:91]
    buffer_load_dwordx4 v23, s[8:11], 0 offen offset:0 lds
    v_mfma_f32_16x16x32_bf16 a[120:123], v[56:59], v[204:207], a[120:123]
    buffer_load_dwordx4 v11, s[8:11], 0 offen offset:1024 lds
    v_mfma_f32_16x16x32_bf16 a[152:155], v[56:59], v[208:211], a[152:155]
    v_mfma_f32_16x16x32_bf16 a[184:187], v[56:59], v[212:215], a[184:187]
    buffer_load_dwordx4 v23, s[8:11], s89 offen offset:2048 lds
    v_mfma_f32_16x16x32_bf16 a[216:219], v[56:59], v[216:219], a[216:219]
    buffer_load_dwordx4 v11, s[8:11], s89 offen offset:3072 lds
    v_mfma_f32_16x16x32_bf16 a[248:251], v[56:59], v[220:223], a[248:251]
    s_waitcnt lgkmcnt(2)
    v_mfma_f32_16x16x32_bf16 a[28:31], v[60:63], v[192:195], a[28:31]
    ds_read_b128 v[40:43], v25 offset:6144
    v_mfma_f32_16x16x32_bf16 a[60:63], v[60:63], v[196:199], a[60:63]
    v_mfma_f32_16x16x32_bf16 a[92:95], v[60:63], v[200:203], a[92:95]
    v_mfma_f32_16x16x32_bf16 a[124:127], v[60:63], v[204:207], a[124:127]
    v_mfma_f32_16x16x32_bf16 a[156:159], v[60:63], v[208:211], a[156:159]
    v_mfma_f32_16x16x32_bf16 a[188:191], v[60:63], v[212:215], a[188:191]
    v_mfma_f32_16x16x32_bf16 a[220:223], v[60:63], v[216:219], a[220:223]
    v_mfma_f32_16x16x32_bf16 a[252:255], v[60:63], v[220:223], a[252:255]
    s_waitcnt vmcnt(25)
    s_waitcnt lgkmcnt(2)
    v_mfma_f32_16x16x32_bf16 a[16:19], v[32:35], v[96:99], a[16:19]
    ds_read_b128 v[44:47], v25 offset:7168
    v_mfma_f32_16x16x32_bf16 a[48:51], v[32:35], v[100:103], a[48:51]
    v_mfma_f32_16x16x32_bf16 a[80:83], v[32:35], v[104:107], a[80:83]
    v_mfma_f32_16x16x32_bf16 a[112:115], v[32:35], v[108:111], a[112:115]
    v_mfma_f32_16x16x32_bf16 a[144:147], v[32:35], v[112:115], a[144:147]
    v_mfma_f32_16x16x32_bf16 a[176:179], v[32:35], v[116:119], a[176:179]
    v_mfma_f32_16x16x32_bf16 a[208:211], v[32:35], v[120:123], a[208:211]
    v_mfma_f32_16x16x32_bf16 a[240:243], v[32:35], v[124:127], a[240:243]
    s_waitcnt lgkmcnt(2)
    v_mfma_f32_16x16x32_bf16 a[20:23], v[36:39], v[96:99], a[20:23]
    s_waitcnt vmcnt(11)
    v_mfma_f32_16x16x32_bf16 a[52:55], v[36:39], v[100:103], a[52:55]
    ds_read_b128 v[48:51], v25 offset:12288
    v_mfma_f32_16x16x32_bf16 a[84:87], v[36:39], v[104:107], a[84:87]
    v_mfma_f32_16x16x32_bf16 a[116:119], v[36:39], v[108:111], a[116:119]
    v_mfma_f32_16x16x32_bf16 a[148:151], v[36:39], v[112:115], a[148:151]
    v_mfma_f32_16x16x32_bf16 a[180:183], v[36:39], v[116:119], a[180:183]
    v_mfma_f32_16x16x32_bf16 a[212:215], v[36:39], v[120:123], a[212:215]
    v_mfma_f32_16x16x32_bf16 a[244:247], v[36:39], v[124:127], a[244:247]
    s_waitcnt lgkmcnt(2)
    v_mfma_f32_16x16x32_bf16 a[24:27], v[40:43], v[96:99], a[24:27]
    ds_read_b128 v[52:55], v25 offset:13312
    v_mfma_f32_16x16x32_bf16 a[56:59], v[40:43], v[100:103], a[56:59]
    v_mfma_f32_16x16x32_bf16 a[88:91], v[40:43], v[104:107], a[88:91]
    v_mfma_f32_16x16x32_bf16 a[120:123], v[40:43], v[108:111], a[120:123]
    v_mfma_f32_16x16x32_bf16 a[152:155], v[40:43], v[112:115], a[152:155]
    v_mfma_f32_16x16x32_bf16 a[184:187], v[40:43], v[116:119], a[184:187]
    v_mfma_f32_16x16x32_bf16 a[216:219], v[40:43], v[120:123], a[216:219]
    v_mfma_f32_16x16x32_bf16 a[248:251], v[40:43], v[124:127], a[248:251]
    s_waitcnt lgkmcnt(2)
    v_mfma_f32_16x16x32_bf16 a[28:31], v[44:47], v[96:99], a[28:31]
    ds_read_b128 v[56:59], v25 offset:14336
    v_mfma_f32_16x16x32_bf16 a[60:63], v[44:47], v[100:103], a[60:63]
    v_mfma_f32_16x16x32_bf16 a[92:95], v[44:47], v[104:107], a[92:95]
    v_mfma_f32_16x16x32_bf16 a[124:127], v[44:47], v[108:111], a[124:127]
    v_mfma_f32_16x16x32_bf16 a[156:159], v[44:47], v[112:115], a[156:159]
    v_mfma_f32_16x16x32_bf16 a[188:191], v[44:47], v[116:119], a[188:191]
    v_mfma_f32_16x16x32_bf16 a[220:223], v[44:47], v[120:123], a[220:223]
    v_mfma_f32_16x16x32_bf16 a[252:255], v[44:47], v[124:127], a[252:255]
    s_waitcnt vmcnt(9)
    s_waitcnt lgkmcnt(2)
    v_mfma_f32_16x16x32_bf16 a[16:19], v[48:51], v[128:131], a[16:19]
    ds_read_b128 v[60:63], v25 offset:15360
    v_mfma_f32_16x16x32_bf16 a[48:51], v[48:51], v[132:135], a[48:51]
    s_waitcnt vmcnt(0)
    v_mfma_f32_16x16x32_bf16 a[80:83], v[48:51], v[136:139], a[80:83]
    v_mfma_f32_16x16x32_bf16 a[112:115], v[48:51], v[140:143], a[112:115]
    v_xor_b32 v12, 32, v10
    v_mfma_f32_16x16x32_bf16 a[144:147], v[48:51], v[144:147], a[144:147]
    v_mfma_f32_16x16x32_bf16 a[176:179], v[48:51], v[148:151], a[176:179]
    v_xor_b32 v13, 64, v10
    v_mfma_f32_16x16x32_bf16 a[208:211], v[48:51], v[152:155], a[208:211]
    v_mfma_f32_16x16x32_bf16 a[240:243], v[48:51], v[156:159], a[240:243]
    s_waitcnt lgkmcnt(2)
    v_mfma_f32_16x16x32_bf16 a[20:23], v[52:55], v[128:131], a[20:23]
    s_waitcnt vmcnt(27)
    v_mfma_f32_16x16x32_bf16 a[52:55], v[52:55], v[132:135], a[52:55]
    ds_read_b128 v[32:35], v25 offset:0
    v_mfma_f32_16x16x32_bf16 a[84:87], v[52:55], v[136:139], a[84:87]
    v_xor_b32 v14, 96, v10
    v_mfma_f32_16x16x32_bf16 a[116:119], v[52:55], v[140:143], a[116:119]
    v_mfma_f32_16x16x32_bf16 a[148:151], v[52:55], v[144:147], a[148:151]
    ds_read_b64 v[64:65], v10 offset:16384
    v_mfma_f32_16x16x32_bf16 a[180:183], v[52:55], v[148:151], a[180:183]
    v_mfma_f32_16x16x32_bf16 a[212:215], v[52:55], v[152:155], a[212:215]
    ds_read_b64 v[66:67], v12 offset:16384
    v_mfma_f32_16x16x32_bf16 a[244:247], v[52:55], v[156:159], a[244:247]
    s_waitcnt lgkmcnt(4)
    v_mfma_f32_16x16x32_bf16 a[24:27], v[56:59], v[128:131], a[24:27]
    ds_read_b128 v[36:39], v25 offset:1024
    v_mfma_f32_16x16x32_bf16 a[56:59], v[56:59], v[132:135], a[56:59]
    ds_read_b64 v[68:69], v13 offset:16384
    v_mfma_f32_16x16x32_bf16 a[88:91], v[56:59], v[136:139], a[88:91]
    v_mfma_f32_16x16x32_bf16 a[120:123], v[56:59], v[140:143], a[120:123]
    ds_read_b64 v[70:71], v14 offset:16384
    v_mfma_f32_16x16x32_bf16 a[152:155], v[56:59], v[144:147], a[152:155]
    v_mfma_f32_16x16x32_bf16 a[184:187], v[56:59], v[148:151], a[184:187]
    ds_read_b64 v[72:73], v10 offset:16512
    v_mfma_f32_16x16x32_bf16 a[216:219], v[56:59], v[152:155], a[216:219]
    v_mfma_f32_16x16x32_bf16 a[248:251], v[56:59], v[156:159], a[248:251]
    s_waitcnt lgkmcnt(7)
    v_mfma_f32_16x16x32_bf16 a[28:31], v[60:63], v[128:131], a[28:31]
    ds_read_b128 v[40:43], v25 offset:2048
    v_mfma_f32_16x16x32_bf16 a[60:63], v[60:63], v[132:135], a[60:63]
    ds_read_b64 v[74:75], v12 offset:16512
    v_mfma_f32_16x16x32_bf16 a[92:95], v[60:63], v[136:139], a[92:95]
    v_mfma_f32_16x16x32_bf16 a[124:127], v[60:63], v[140:143], a[124:127]
    ds_read_b64 v[76:77], v13 offset:16512
    v_mfma_f32_16x16x32_bf16 a[156:159], v[60:63], v[144:147], a[156:159]
    v_mfma_f32_16x16x32_bf16 a[188:191], v[60:63], v[148:151], a[188:191]
    ds_read_b64 v[78:79], v14 offset:16512
    v_mfma_f32_16x16x32_bf16 a[220:223], v[60:63], v[152:155], a[220:223]
    v_mfma_f32_16x16x32_bf16 a[252:255], v[60:63], v[156:159], a[252:255]
    s_waitcnt vmcnt(25)
    s_waitcnt lgkmcnt(0)
    s_waitcnt lgkmcnt(10)
    v_mfma_f32_16x16x32_bf16 a[0:3], v[32:35], v[96:99], a[0:3]
    ds_read_b128 v[44:47], v25 offset:3072
    v_mfma_f32_16x16x32_bf16 a[32:35], v[32:35], v[100:103], a[32:35]
    s_cmp_eq_u32 s3, 0
    s_cbranch_scc1 P2_w0_0
    ds_write_b128 v3, a[16:19] offset:16384
    ds_write_b128 v3, a[20:23] offset:17408
    ds_write_b128 v3, a[48:51] offset:20480
P2_w0_0:
    v_mfma_f32_16x16x32_bf16 a[64:67], v[32:35], v[104:107], a[64:67]
    s_cmp_eq_u32 s3, 1
    s_cbranch_scc1 P2_w1_0
    ds_write_b128 v4, a[80:83] offset:16384
    ds_write_b128 v4, a[84:87] offset:17408
    ds_write_b128 v4, a[112:115] offset:20480
P2_w1_0:
    v_mfma_f32_16x16x32_bf16 a[96:99], v[32:35], v[108:111], a[96:99]
    v_mfma_f32_16x16x32_bf16 a[128:131], v[32:35], v[112:115], a[128:131]
    s_cmp_eq_u32 s3, 2
    s_cbranch_scc1 P2_w2_0
    ds_write_b128 v5, a[144:147] offset:16384
    ds_write_b128 v5, a[148:151] offset:17408
    ds_write_b128 v5, a[176:179] offset:20480
P2_w2_0:
    v_mfma_f32_16x16x32_bf16 a[160:163], v[32:35], v[116:119], a[160:163]
    v_mfma_f32_16x16x32_bf16 a[192:195], v[32:35], v[120:123], a[192:195]
    s_cmp_eq_u32 s3, 3
    s_cbranch_scc1 P2_w3_0
    ds_write_b128 v6, a[208:211] offset:16384
    ds_write_b128 v6, a[212:215] offset:17408
    ds_write_b128 v6, a[240:243] offset:20480
P2_w3_0:
    v_mfma_f32_16x16x32_bf16 a[224:227], v[32:35], v[124:127], a[224:227]
    s_waitcnt lgkmcnt(8)
    v_mfma_f32_16x16x32_bf16 a[4:7], v[36:39], v[96:99], a[4:7]
    s_waitcnt vmcnt(11)
    v_mfma_f32_16x16x32_bf16 a[36:39], v[36:39], v[100:103], a[36:39]
    ds_read_b128 v[48:51], v25 offset:8192
    v_mfma_f32_16x16x32_bf16 a[68:71], v[36:39], v[104:107], a[68:71]
    s_cmp_eq_u32 s3, 0
    s_cbranch_scc1 P2_w0_2
    ds_write_b128 v3, a[24:27] offset:18432
    ds_write_b128 v3, a[52:55] offset:21504
    ds_write_b128 v3, a[56:59] offset:22528
P2_w0_2:
    v_mfma_f32_16x16x32_bf16 a[100:103], v[36:39], v[108:111], a[100:103]
    s_cmp_eq_u32 s3, 1
    s_cbranch_scc1 P2_w1_2
    ds_write_b128 v4, a[88:91] offset:18432
    ds_write_b128 v4, a[116:119] offset:21504
    ds_write_b128 v4, a[120:123] offset:22528
P2_w1_2:
    v_mfma_f32_16x16x32_bf16 a[132:135], v[36:39], v[112:115], a[132:135]
    v_mfma_f32_16x16x32_bf16 a[164:167], v[36:39], v[116:119], a[164:167]
    s_cmp_eq_u32 s3, 2
    s_cbranch_scc1 P2_w2_2
    ds_write_b128 v5, a[152:155] offset:18432
    ds_write_b128 v5, a[180:183] offset:21504
    ds_write_b128 v5, a[184:187] offset:22528
P2_w2_2:
    v_mfma_f32_16x16x32_bf16 a[196:199], v[36:39], v[120:123], a[196:199]
    s_cmp_eq_u32 s3, 3
    s_cbranch_scc1 P2_w3_2
    ds_write_b128 v6, a[216:219] offset:18432
    ds_write_b128 v6, a[244:247] offset:21504
    ds_write_b128 v6, a[248:251] offset:22528
P2_w3_2:
    v_mfma_f32_16x16x32_bf16 a[228:231], v[36:39], v[124:127], a[228:231]
    s_waitcnt lgkmcnt(5)
    v_mfma_f32_16x16x32_bf16 a[8:11], v[40:43], v[96:99], a[8:11]
    ds_read_b128 v[52:55], v25 offset:9216
    v_mfma_f32_16x16x32_bf16 a[40:43], v[40:43], v[100:103], a[40:43]
    s_cmp_eq_u32 s3, 0
    s_cbranch_scc1 P2_w0_3
    ds_write_b128 v3, a[28:31] offset:19456
    ds_write_b128 v3, a[60:63] offset:23552
P2_w0_3:
    v_mfma_f32_16x16x32_bf16 a[72:75], v[40:43], v[104:107], a[72:75]
    s_cmp_eq_u32 s3, 1
    s_cbranch_scc1 P2_w1_3
    ds_write_b128 v4, a[92:95] offset:19456
    ds_write_b128 v4, a[124:127] offset:23552
P2_w1_3:
    v_mfma_f32_16x16x32_bf16 a[104:107], v[40:43], v[108:111], a[104:107]
    v_mfma_f32_16x16x32_bf16 a[136:139], v[40:43], v[112:115], a[136:139]
    s_cmp_eq_u32 s3, 2
    s_cbranch_scc1 P2_w2_3
    ds_write_b128 v5, a[156:159] offset:19456
    ds_write_b128 v5, a[188:191] offset:23552
P2_w2_3:
    v_mfma_f32_16x16x32_bf16 a[168:171], v[40:43], v[116:119], a[168:171]
    v_mfma_f32_16x16x32_bf16 a[200:203], v[40:43], v[120:123], a[200:203]
    s_cmp_eq_u32 s3, 3
    s_cbranch_scc1 P2_w3_3
    ds_write_b128 v6, a[220:223] offset:19456
    ds_write_b128 v6, a[252:255] offset:23552
P2_w3_3:
    v_mfma_f32_16x16x32_bf16 a[232:235], v[40:43], v[124:127], a[232:235]
    s_cmp_lg_u32 s3, 0
    s_cbranch_scc1 P2_so0
    v_accvgpr_read_b32 v160, a16
    v_accvgpr_read_b32 v161, a17
    v_accvgpr_read_b32 v162, a18
    v_accvgpr_read_b32 v163, a19
    v_accvgpr_read_b32 v164, a20
    v_accvgpr_read_b32 v165, a21
    v_accvgpr_read_b32 v166, a22
    v_accvgpr_read_b32 v167, a23
    v_accvgpr_read_b32 v168, a24
    v_accvgpr_read_b32 v169, a25
    v_accvgpr_read_b32 v170, a26
    v_accvgpr_read_b32 v171, a27
    v_accvgpr_read_b32 v172, a28
    v_accvgpr_read_b32 v173, a29
    v_accvgpr_read_b32 v174, a30
    v_accvgpr_read_b32 v175, a31
    v_accvgpr_read_b32 v176, a48
    v_accvgpr_read_b32 v177, a49
    v_accvgpr_read_b32 v178, a50
    v_accvgpr_read_b32 v179, a51
    v_accvgpr_read_b32 v180, a52
    v_accvgpr_read_b32 v181, a53
    v_accvgpr_read_b32 v182, a54
    v_accvgpr_read_b32 v183, a55
    v_accvgpr_read_b32 v184, a56
    v_accvgpr_read_b32 v185, a57
    v_accvgpr_read_b32 v186, a58
    v_accvgpr_read_b32 v187, a59
    v_accvgpr_read_b32 v188, a60
    v_accvgpr_read_b32 v189, a61
    v_accvgpr_read_b32 v190, a62
    v_accvgpr_read_b32 v191, a63
    s_branch P2_sox
P2_so0:
    s_cmp_lg_u32 s3, 1
    s_cbranch_scc1 P2_so1
    v_accvgpr_read_b32 v160, a80
    v_accvgpr_read_b32 v161, a81
    v_accvgpr_read_b32 v162, a82
    v_accvgpr_read_b32 v163, a83
    v_accvgpr_read_b32 v164, a84
    v_accvgpr_read_b32 v165, a85
    v_accvgpr_read_b32 v166, a86
    v_accvgpr_read_b32 v167, a87
    v_accvgpr_read_b32 v168, a88
    v_accvgpr_read_b32 v169, a89
    v_accvgpr_read_b32 v170, a90
    v_accvgpr_read_b32 v171, a91
    v_accvgpr_read_b32 v172, a92
    v_accvgpr_read_b32 v173, a93
    v_accvgpr_read_b32 v174, a94
    v_accvgpr_read_b32 v175, a95
    v_accvgpr_read_b32 v176, a112
    v_accvgpr_read_b32 v177, a113
    v_accvgpr_read_b32 v178, a114
    v_accvgpr_read_b32 v179, a115
    v_accvgpr_read_b32 v180, a116
    v_accvgpr_read_b32 v181, a117
    v_accvgpr_read_b32 v182, a118
    v_accvgpr_read_b32 v183, a119
    v_accvgpr_read_b32 v184, a120
    v_accvgpr_read_b32 v185, a121
    v_accvgpr_read_b32 v186, a122
    v_accvgpr_read_b32 v187, a123
    v_accvgpr_read_b32 v188, a124
    v_accvgpr_read_b32 v189, a125
    v_accvgpr_read_b32 v190, a126
    v_accvgpr_read_b32 v191, a127
    s_branch P2_sox
P2_so1:
    s_cmp_lg_u32 s3, 2
    s_cbranch_scc1 P2_so2
    v_accvgpr_read_b32 v160, a144
    v_accvgpr_read_b32 v161, a145
    v_accvgpr_read_b32 v162, a146
    v_accvgpr_read_b32 v163, a147
    v_accvgpr_read_b32 v164, a148
    v_accvgpr_read_b32 v165, a149
    v_accvgpr_read_b32 v166, a150
    v_accvgpr_read_b32 v167, a151
    v_accvgpr_read_b32 v168, a152
    v_accvgpr_read_b32 v169, a153
    v_accvgpr_read_b32 v170, a154
    v_accvgpr_read_b32 v171, a155
    v_accvgpr_read_b32 v172, a156
    v_accvgpr_read_b32 v173, a157
    v_accvgpr_read_b32 v174, a158
    v_accvgpr_read_b32 v175, a159
    v_accvgpr_read_b32 v176, a176
    v_accvgpr_read_b32 v177, a177
    v_accvgpr_read_b32 v178, a178
    v_accvgpr_read_b32 v179, a179
    v_accvgpr_read_b32 v180, a180
    v_accvgpr_read_b32 v181, a181
    v_accvgpr_read_b32 v182, a182
    v_accvgpr_read_b32 v183, a183
    v_accvgpr_read_b32 v184, a184
    v_accvgpr_read_b32 v185, a185
    v_accvgpr_read_b32 v186, a186
    v_accvgpr_read_b32 v187, a187
    v_accvgpr_read_b32 v188, a188
    v_accvgpr_read_b32 v189, a189
    v_accvgpr_read_b32 v190, a190
    v_accvgpr_read_b32 v191, a191
    s_branch P2_sox
P2_so2:
    v_accvgpr_read_b32 v160, a208
    v_accvgpr_read_b32 v161, a209
    v_accvgpr_read_b32 v162, a210
    v_accvgpr_read_b32 v163, a211
    v_accvgpr_read_b32 v164, a212
    v_accvgpr_read_b32 v165, a213
    v_accvgpr_read_b32 v166, a214
    v_accvgpr_read_b32 v167, a215
    v_accvgpr_read_b32 v168, a216
    v_accvgpr_read_b32 v169, a217
    v_accvgpr_read_b32 v170, a218
    v_accvgpr_read_b32 v171, a219
    v_accvgpr_read_b32 v172, a220
    v_accvgpr_read_b32 v173, a221
    v_accvgpr_read_b32 v174, a222
    v_accvgpr_read_b32 v175, a223
    v_accvgpr_read_b32 v176, a240
    v_accvgpr_read_b32 v177, a241
    v_accvgpr_read_b32 v178, a242
    v_accvgpr_read_b32 v179, a243
    v_accvgpr_read_b32 v180, a244
    v_accvgpr_read_b32 v181, a245
    v_accvgpr_read_b32 v182, a246
    v_accvgpr_read_b32 v183, a247
    v_accvgpr_read_b32 v184, a248
    v_accvgpr_read_b32 v185, a249
    v_accvgpr_read_b32 v186, a250
    v_accvgpr_read_b32 v187, a251
    v_accvgpr_read_b32 v188, a252
    v_accvgpr_read_b32 v189, a253
    v_accvgpr_read_b32 v190, a254
    v_accvgpr_read_b32 v191, a255
P2_sox:
    s_waitcnt lgkmcnt(2)
    v_mfma_f32_16x16x32_bf16 a[12:15], v[44:47], v[96:99], a[12:15]
    ds_read_b128 v[56:59], v25 offset:10240
    v_mfma_f32_16x16x32_bf16 a[44:47], v[44:47], v[100:103], a[44:47]
    v_mfma_f32_16x16x32_bf16 a[76:79], v[44:47], v[104:107], a[76:79]
    v_mfma_f32_16x16x32_bf16 a[108:111], v[44:47], v[108:111], a[108:111]
    v_mfma_f32_16x16x32_bf16 a[140:143], v[44:47], v[112:115], a[140:143]
    v_mfma_f32_16x16x32_bf16 a[172:175], v[44:47], v[116:119], a[172:175]
    v_mfma_f32_16x16x32_bf16 a[204:207], v[44:47], v[120:123], a[204:207]
    v_mfma_f32_16x16x32_bf16 a[236:239], v[44:47], v[124:127], a[236:239]
    s_waitcnt lgkmcnt(0)
    s_barrier
    s_waitcnt vmcnt(9)
    v_mfma_f32_16x16x32_bf16 a[0:3], v[48:51], v[128:131], a[0:3]
    ds_read_b128 v[60:63], v25 offset:11264
    v_mfma_f32_16x16x32_bf16 a[32:35], v[48:51], v[132:135], a[32:35]
    ds_read_b128 v[192:195], v7 offset:16384
    v_mfma_f32_16x16x32_bf16 a[64:67], v[48:51], v[136:139], a[64:67]
    ds_read_b128 v[196:199], v8 offset:16384
    v_mfma_f32_16x16x32_bf16 a[96:99], v[48:51], v[140:143], a[96:99]
    ds_read_b128 v[200:203], v9 offset:16384
    v_mfma_f32_16x16x32_bf16 a[128:131], v[48:51], v[144:147], a[128:131]
    ds_read_b128 v[204:207], v7 offset:17408
    v_mfma_f32_16x16x32_bf16 a[160:163], v[48:51], v[148:151], a[160:163]
    ds_read_b128 v[208:211], v8 offset:17408
    v_mfma_f32_16x16x32_bf16 a[192:195], v[48:51], v[152:155], a[192:195]
    ds_read_b128 v[212:215], v9 offset:17408
    v_mfma_f32_16x16x32_bf16 a[224:227], v[48:51], v[156:159], a[224:227]
    v_mfma_f32_16x16x32_bf16 a[4:7], v[52:55], v[128:131], a[4:7]
    s_waitcnt lgkmcnt(3)
    v_pk_add_f32 v[192:193], v[192:193], v[196:197]
    v_pk_add_f32 v[194:195], v[194:195], v[198:199]
    s_nop 0
    v_mfma_f32_16x16x32_bf16 a[36:39], v[52:55], v[132:135], a[36:39]
    v_pk_add_f32 v[160:161], v[160:161], v[200:201]
    v_pk_add_f32 v[162:163], v[162:163], v[202:203]
    v_pk_add_f32 v[160:161], v[160:161], v[192:193]
    s_nop 0
    v_mfma_f32_16x16x32_bf16 a[68:71], v[52:55], v[136:139], a[68:71]
    v_pk_add_f32 v[162:163], v[162:163], v[194:195]
    buffer_store_dwordx4 v[160:163], v15, s[20:23], s78 offen offset:0 sc1
    s_waitcnt lgkmcnt(0)
    v_mfma_f32_16x16x32_bf16 a[100:103], v[52:55], v[140:143], a[100:103]
    v_pk_add_f32 v[204:205], v[204:205], v[208:209]
    v_pk_add_f32 v[206:207], v[206:207], v[210:211]
    s_nop 0
    v_mfma_f32_16x16x32_bf16 a[132:135], v[52:55], v[144:147], a[132:135]
    v_pk_add_f32 v[164:165], v[164:165], v[212:213]
    v_pk_add_f32 v[166:167], v[166:167], v[214:215]
    v_pk_add_f32 v[164:165], v[164:165], v[204:205]
    s_nop 0
    v_mfma_f32_16x16x32_bf16 a[164:167], v[52:55], v[148:151], a[164:167]
    v_pk_add_f32 v[166:167], v[166:167], v[206:207]
    buffer_store_dwordx4 v[164:167], v15, s[20:23], s78 offen offset:1024 sc1
    ds_read_b128 v[216:219], v7 offset:18432
    v_mfma_f32_16x16x32_bf16 a[196:199], v[52:55], v[152:155], a[196:199]
    ds_read_b128 v[220:223], v8 offset:18432
    ds_read_b128 v[224:227], v9 offset:18432
    ds_read_b128 v[228:231], v7 offset:19456
    v_mfma_f32_16x16x32_bf16 a[228:231], v[52:55], v[156:159], a[228:231]
    ds_read_b128 v[232:235], v8 offset:19456
    ds_read_b128 v[236:239], v9 offset:19456
    v_mfma_f32_16x16x32_bf16 a[8:11], v[56:59], v[128:131], a[8:11]
    s_waitcnt lgkmcnt(3)
    v_pk_add_f32 v[216:217], v[216:217], v[220:221]
    v_pk_add_f32 v[218:219], v[218:219], v[222:223]
    s_nop 0
    v_mfma_f32_16x16x32_bf16 a[40:43], v[56:59], v[132:135], a[40:43]
    v_pk_add_f32 v[168:169], v[168:169], v[224:225]
    v_pk_add_f32 v[170:171], v[170:171], v[226:227]
    v_pk_add_f32 v[168:169], v[168:169], v[216:217]
    s_nop 0
    v_mfma_f32_16x16x32_bf16 a[72:75], v[56:59], v[136:139], a[72:75]
    v_pk_add_f32 v[170:171], v[170:171], v[218:219]
    buffer_store_dwordx4 v[168:171], v15, s[20:23], s78 offen offset:2048 sc1
    s_waitcnt lgkmcnt(0)
    v_mfma_f32_16x16x32_bf16 a[104:107], v[56:59], v[140:143], a[104:107]
    v_pk_add_f32 v[228:229], v[228:229], v[232:233]
    v_pk_add_f32 v[230:231], v[230:231], v[234:235]
    s_nop 0
    v_mfma_f32_16x16x32_bf16 a[136:139], v[56:59], v[144:147], a[136:139]
    v_pk_add_f32 v[172:173], v[172:173], v[236:237]
    v_pk_add_f32 v[174:175], v[174:175], v[238:239]
    v_pk_add_f32 v[172:173], v[172:173], v[228:229]
    s_nop 0
    v_mfma_f32_16x16x32_bf16 a[168:171], v[56:59], v[148:151], a[168:171]
    v_pk_add_f32 v[174:175], v[174:175], v[230:231]
    buffer_store_dwordx4 v[172:175], v15, s[20:23], s78 offen offset:3072 sc1
    ds_read_b128 v[192:195], v7 offset:20480
    v_mfma_f32_16x16x32_bf16 a[200:203], v[56:59], v[152:155], a[200:203]
    ds_read_b128 v[196:199], v8 offset:20480
    ds_read_b128 v[200:203], v9 offset:20480
    ds_read_b128 v[204:207], v7 offset:21504
    v_mfma_f32_16x16x32_bf16 a[232:235], v[56:59], v[156:159], a[232:235]
    ds_read_b128 v[208:211], v8 offset:21504
    ds_read_b128 v[212:215], v9 offset:21504
    s_waitcnt lgkmcnt(14)
    v_mfma_f32_16x16x32_bf16 a[12:15], v[60:63], v[128:131], a[12:15]
    s_waitcnt lgkmcnt(3)
    v_pk_add_f32 v[192:193], v[192:193], v[196:197]
    v_pk_add_f32 v[194:195], v[194:195], v[198:199]
    s_nop 0
    v_mfma_f32_16x16x32_bf16 a[44:47], v[60:63], v[132:135], a[44:47]
    v_pk_add_f32 v[176:177], v[176:177], v[200:201]
    v_pk_add_f32 v[178:179], v[178:179], v[202:203]
    v_pk_add_f32 v[176:177], v[176:177], v[192:193]
    s_nop 0
    v_mfma_f32_16x16x32_bf16 a[76:79], v[60:63], v[136:139], a[76:79]
    v_pk_add_f32 v[178:179], v[178:179], v[194:195]
    buffer_store_dwordx4 v[176:179], v15, s[20:23], s79 offen offset:0 sc1
    s_waitcnt lgkmcnt(0)
    v_mfma_f32_16x16x32_bf16 a[108:111], v[60:63], v[140:143], a[108:111]
    v_pk_add_f32 v[204:205], v[204:205], v[208:209]
    v_pk_add_f32 v[206:207], v[206:207], v[210:211]
    s_nop 0
    v_mfma_f32_16x16x32_bf16 a[140:143], v[60:63], v[144:147], a[140:143]
    v_pk_add_f32 v[180:181], v[180:181], v[212:213]
    v_pk_add_f32 v[182:183], v[182:183], v[214:215]
    v_pk_add_f32 v[180:181], v[180:181], v[204:205]
    s_nop 0
    v_mfma_f32_16x16x32_bf16 a[172:175], v[60:63], v[148:151], a[172:175]
    v_pk_add_f32 v[182:183], v[182:183], v[206:207]
    buffer_store_dwordx4 v[180:183], v15, s[20:23], s79 offen offset:1024 sc1
    ds_read_b128 v[216:219], v7 offset:22528
    v_mfma_f32_16x16x32_bf16 a[204:207], v[60:63], v[152:155], a[204:207]
    ds_read_b128 v[220:223], v8 offset:22528
    ds_read_b128 v[224:227], v9 offset:22528
    ds_read_b128 v[228:231], v7 offset:23552
    v_mfma_f32_16x16x32_bf16 a[236:239], v[60:63], v[156:159], a[236:239]
    ds_read_b128 v[232:235], v8 offset:23552
    ds_read_b128 v[236:239], v9 offset:23552
    s_waitcnt lgkmcnt(3)
    v_pk_add_f32 v[216:217], v[216:217], v[220:221]
    v_pk_add_f32 v[218:219], v[218:219], v[222:223]
    v_pk_add_f32 v[184:185], v[184:185], v[224:225]
    v_pk_add_f32 v[186:187], v[186:187], v[226:227]
    v_pk_add_f32 v[184:185], v[184:185], v[216:217]
    v_pk_add_f32 v[186:187], v[186:187], v[218:219]
    buffer_store_dwordx4 v[184:187], v15, s[20:23], s79 offen offset:2048 sc1
    s_waitcnt lgkmcnt(0)
    v_pk_add_f32 v[228:229], v[228:229], v[232:233]
    v_pk_add_f32 v[230:231], v[230:231], v[234:235]
    v_pk_add_f32 v[188:189], v[188:189], v[236:237]
    v_pk_add_f32 v[190:191], v[190:191], v[238:239]
    v_pk_add_f32 v[188:189], v[188:189], v[228:229]
    v_pk_add_f32 v[190:191], v[190:191], v[230:231]
    buffer_store_dwordx4 v[188:191], v15, s[20:23], s79 offen offset:3072 sc1
    s_waitcnt lgkmcnt(0)
    s_barrier
    s_nop 7
    s_cmp_eq_u32 s3, 0
    s_cbranch_scc1 P2_kw0
    ds_write_b128 v3, a[0:3] offset:0
    ds_write_b128 v3, a[4:7] offset:1024
    ds_write_b128 v3, a[8:11] offset:2048
    ds_write_b128 v3, a[12:15] offset:3072
    ds_write_b128 v3, a[32:35] offset:4096
    ds_write_b128 v3, a[36:39] offset:5120
    ds_write_b128 v3, a[40:43] offset:6144
    ds_write_b128 v3, a[44:47] offset:7168
P2_kw0:
    s_cmp_eq_u32 s3, 1
    s_cbranch_scc1 P2_kw1
    ds_write_b128 v4, a[64:67] offset:0
    ds_write_b128 v4, a[68:71] offset:1024
    ds_write_b128 v4, a[72:75] offset:2048
    ds_write_b128 v4, a[76:79] offset:3072
    ds_write_b128 v4, a[96:99] offset:4096
    ds_write_b128 v4, a[100:103] offset:5120
    ds_write_b128 v4, a[104:107] offset:6144
    ds_write_b128 v4, a[108:111] offset:7168
P2_kw1:
    s_cmp_eq_u32 s3, 2
    s_cbranch_scc1 P2_kw2
    ds_write_b128 v5, a[128:131] offset:0
    ds_write_b128 v5, a[132:135] offset:1024
    ds_write_b128 v5, a[136:139] offset:2048
    ds_write_b128 v5, a[140:143] offset:3072
    ds_write_b128 v5, a[160:163] offset:4096
    ds_write_b128 v5, a[164:167] offset:5120
    ds_write_b128 v5, a[168:171] offset:6144
    ds_write_b128 v5, a[172:175] offset:7168
P2_kw2:
    s_cmp_eq_u32 s3, 3
    s_cbranch_scc1 P2_kw3
    ds_write_b128 v6, a[192:195] offset:0
    ds_write_b128 v6, a[196:199] offset:1024
    ds_write_b128 v6, a[200:203] offset:2048
    ds_write_b128 v6, a[204:207] offset:3072
    ds_write_b128 v6, a[224:227] offset:4096
    ds_write_b128 v6, a[228:231] offset:5120
    ds_write_b128 v6, a[232:235] offset:6144
    ds_write_b128 v6, a[236:239] offset:7168
P2_kw3:
    s_cmp_lg_u32 s3, 0
    s_cbranch_scc1 P2_ko0
    v_accvgpr_read_b32 v128, a0
    v_accvgpr_read_b32 v129, a1
    v_accvgpr_read_b32 v130, a2
    v_accvgpr_read_b32 v131, a3
    v_accvgpr_read_b32 v132, a4
    v_accvgpr_read_b32 v133, a5
    v_accvgpr_read_b32 v134, a6
    v_accvgpr_read_b32 v135, a7
    v_accvgpr_read_b32 v136, a8
    v_accvgpr_read_b32 v137, a9
    v_accvgpr_read_b32 v138, a10
    v_accvgpr_read_b32 v139, a11
    v_accvgpr_read_b32 v140, a12
    v_accvgpr_read_b32 v141, a13
    v_accvgpr_read_b32 v142, a14
    v_accvgpr_read_b32 v143, a15
    v_accvgpr_read_b32 v144, a32
    v_accvgpr_read_b32 v145, a33
    v_accvgpr_read_b32 v146, a34
    v_accvgpr_read_b32 v147, a35
    v_accvgpr_read_b32 v148, a36
    v_accvgpr_read_b32 v149, a37
    v_accvgpr_read_b32 v150, a38
    v_accvgpr_read_b32 v151, a39
    v_accvgpr_read_b32 v152, a40
    v_accvgpr_read_b32 v153, a41
    v_accvgpr_read_b32 v154, a42
    v_accvgpr_read_b32 v155, a43
    v_accvgpr_read_b32 v156, a44
    v_accvgpr_read_b32 v157, a45
    v_accvgpr_read_b32 v158, a46
    v_accvgpr_read_b32 v159, a47
    s_branch P2_kox
P2_ko0:
    s_cmp_lg_u32 s3, 1
    s_cbranch_scc1 P2_ko1
    v_accvgpr_read_b32 v128, a64
    v_accvgpr_read_b32 v129, a65
    v_accvgpr_read_b32 v130, a66
    v_accvgpr_read_b32 v131, a67
    v_accvgpr_read_b32 v132, a68
    v_accvgpr_read_b32 v133, a69
    v_accvgpr_read_b32 v134, a70
    v_accvgpr_read_b32 v135, a71
    v_accvgpr_read_b32 v136, a72
    v_accvgpr_read_b32 v137, a73
    v_accvgpr_read_b32 v138, a74
    v_accvgpr_read_b32 v139, a75
    v_accvgpr_read_b32 v140, a76
    v_accvgpr_read_b32 v141, a77
    v_accvgpr_read_b32 v142, a78
    v_accvgpr_read_b32 v143, a79
    v_accvgpr_read_b32 v144, a96
    v_accvgpr_read_b32 v145, a97
    v_accvgpr_read_b32 v146, a98
    v_accvgpr_read_b32 v147, a99
    v_accvgpr_read_b32 v148, a100
    v_accvgpr_read_b32 v149, a101
    v_accvgpr_read_b32 v150, a102
    v_accvgpr_read_b32 v151, a103
    v_accvgpr_read_b32 v152, a104
    v_accvgpr_read_b32 v153, a105
    v_accvgpr_read_b32 v154, a106
    v_accvgpr_read_b32 v155, a107
    v_accvgpr_read_b32 v156, a108
    v_accvgpr_read_b32 v157, a109
    v_accvgpr_read_b32 v158, a110
    v_accvgpr_read_b32 v159, a111
    s_branch P2_kox
P2_ko1:
    s_cmp_lg_u32 s3, 2
    s_cbranch_scc1 P2_ko2
    v_accvgpr_read_b32 v128, a128
    v_accvgpr_read_b32 v129, a129
    v_accvgpr_read_b32 v130, a130
    v_accvgpr_read_b32 v131, a131
    v_accvgpr_read_b32 v132, a132
    v_accvgpr_read_b32 v133, a133
    v_accvgpr_read_b32 v134, a134
    v_accvgpr_read_b32 v135, a135
    v_accvgpr_read_b32 v136, a136
    v_accvgpr_read_b32 v137, a137
    v_accvgpr_read_b32 v138, a138
    v_accvgpr_read_b32 v139, a139
    v_accvgpr_read_b32 v140, a140
    v_accvgpr_read_b32 v141, a141
    v_accvgpr_read_b32 v142, a142
    v_accvgpr_read_b32 v143, a143
    v_accvgpr_read_b32 v144, a160
    v_accvgpr_read_b32 v145, a161
    v_accvgpr_read_b32 v146, a162
    v_accvgpr_read_b32 v147, a163
    v_accvgpr_read_b32 v148, a164
    v_accvgpr_read_b32 v149, a165
    v_accvgpr_read_b32 v150, a166
    v_accvgpr_read_b32 v151, a167
    v_accvgpr_read_b32 v152, a168
    v_accvgpr_read_b32 v153, a169
    v_accvgpr_read_b32 v154, a170
    v_accvgpr_read_b32 v155, a171
    v_accvgpr_read_b32 v156, a172
    v_accvgpr_read_b32 v157, a173
    v_accvgpr_read_b32 v158, a174
    v_accvgpr_read_b32 v159, a175
    s_branch P2_kox
P2_ko2:
    v_accvgpr_read_b32 v128, a192
    v_accvgpr_read_b32 v129, a193
    v_accvgpr_read_b32 v130, a194
    v_accvgpr_read_b32 v131, a195
    v_accvgpr_read_b32 v132, a196
    v_accvgpr_read_b32 v133, a197
    v_accvgpr_read_b32 v134, a198
    v_accvgpr_read_b32 v135, a199
    v_accvgpr_read_b32 v136, a200
    v_accvgpr_read_b32 v137, a201
    v_accvgpr_read_b32 v138, a202
    v_accvgpr_read_b32 v139, a203
    v_accvgpr_read_b32 v140, a204
    v_accvgpr_read_b32 v141, a205
    v_accvgpr_read_b32 v142, a206
    v_accvgpr_read_b32 v143, a207
    v_accvgpr_read_b32 v144, a224
    v_accvgpr_read_b32 v145, a225
    v_accvgpr_read_b32 v146, a226
    v_accvgpr_read_b32 v147, a227
    v_accvgpr_read_b32 v148, a228
    v_accvgpr_read_b32 v149, a229
    v_accvgpr_read_b32 v150, a230
    v_accvgpr_read_b32 v151, a231
    v_accvgpr_read_b32 v152, a232
    v_accvgpr_read_b32 v153, a233
    v_accvgpr_read_b32 v154, a234
    v_accvgpr_read_b32 v155, a235
    v_accvgpr_read_b32 v156, a236
    v_accvgpr_read_b32 v157, a237
    v_accvgpr_read_b32 v158, a238
    v_accvgpr_read_b32 v159, a239
P2_kox:
    s_waitcnt vmcnt(0)
    s_mov_b64 exec, 1
    buffer_store_dword v26, off, s[20:23], s82 sc1
    s_mov_b64 exec, -1
    s_waitcnt lgkmcnt(0)
    s_barrier
    ds_read_b128 v[160:163], v7 offset:0
    ds_read_b128 v[192:195], v8 offset:0
    ds_read_b128 v[224:227], v9 offset:0
    ds_read_b128 v[164:167], v7 offset:1024
    ds_read_b128 v[196:199], v8 offset:1024
    ds_read_b128 v[228:231], v9 offset:1024
    ds_read_b128 v[168:171], v7 offset:2048
    ds_read_b128 v[200:203], v8 offset:2048
    ds_read_b128 v[232:235], v9 offset:2048
    ds_read_b128 v[172:175], v7 offset:3072
    ds_read_b128 v[204:207], v8 offset:3072
    ds_read_b128 v[236:239], v9 offset:3072
    ds_read_b128 v[176:179], v7 offset:4096
    ds_read_b128 v[208:211], v8 offset:4096
    ds_read_b128 v[240:243], v9 offset:4096
    ds_read_b128 v[180:183], v7 offset:5120
    ds_read_b128 v[212:215], v8 offset:5120
    ds_read_b128 v[244:247], v9 offset:5120
    ds_read_b128 v[184:187], v7 offset:6144
    ds_read_b128 v[216:219], v8 offset:6144
    ds_read_b128 v[248:251], v9 offset:6144
    ds_read_b128 v[188:191], v7 offset:7168
    ds_read_b128 v[220:223], v8 offset:7168
    ds_read_b128 v[252:255], v9 offset:7168
    buffer_load_dword v59, off, s[20:23], s83 sc1
    v_and_b32 v89, 0xffff0000, v80
    v_lshlrev_b32 v88, 16, v80
    v_lshlrev_b32 v90, 16, v64
    v_lshlrev_b32 v92, 16, v72
    v_and_b32 v91, 0xffff0000, v64
    v_and_b32 v93, 0xffff0000, v72
    v_pk_mul_f32 v[90:91], v[90:91], v[88:89]
    v_pk_mul_f32 v[92:93], v[92:93], v[88:89]
    v_cvt_pk_bf16_f32 v90, v90, v91
    v_cvt_pk_bf16_f32 v92, v92, v93
    v_and_b32 v91, 0xffff0000, v90
    v_and_b32 v93, 0xffff0000, v92
    v_lshlrev_b32 v90, 16, v90
    v_lshlrev_b32 v92, 16, v92
    v_pk_fma_f32 v[128:129], v[90:91], v[30:31], v[128:129] op_sel:[0,0,0] op_sel_hi:[1,0,1]
    v_pk_fma_f32 v[144:145], v[92:93], v[30:31], v[144:145] op_sel:[0,1,0] op_sel_hi:[1,1,1]
    v_and_b32 v89, 0xffff0000, v81
    v_lshlrev_b32 v88, 16, v81
    v_lshlrev_b32 v90, 16, v65
    v_lshlrev_b32 v92, 16, v73
    v_and_b32 v91, 0xffff0000, v65
    v_and_b32 v93, 0xffff0000, v73
    v_pk_mul_f32 v[90:91], v[90:91], v[88:89]
    v_pk_mul_f32 v[92:93], v[92:93], v[88:89]
    v_cvt_pk_bf16_f32 v90, v90, v91
    v_cvt_pk_bf16_f32 v92, v92, v93
    v_and_b32 v91, 0xffff0000, v90
    v_and_b32 v93, 0xffff0000, v92
    v_lshlrev_b32 v90, 16, v90
    v_lshlrev_b32 v92, 16, v92
    v_pk_fma_f32 v[130:131], v[90:91], v[30:31], v[130:131] op_sel:[0,0,0] op_sel_hi:[1,0,1]
    v_pk_fma_f32 v[146:147], v[92:93], v[30:31], v[146:147] op_sel:[0,1,0] op_sel_hi:[1,1,1]
    v_and_b32 v89, 0xffff0000, v82
    v_lshlrev_b32 v88, 16, v82
    v_lshlrev_b32 v90, 16, v66
    v_lshlrev_b32 v92, 16, v74
    v_and_b32 v91, 0xffff0000, v66
    v_and_b32 v93, 0xffff0000, v74
    v_pk_mul_f32 v[90:91], v[90:91], v[88:89]
    v_pk_mul_f32 v[92:93], v[92:93], v[88:89]
    v_cvt_pk_bf16_f32 v90, v90, v91
    v_cvt_pk_bf16_f32 v92, v92, v93
    v_and_b32 v91, 0xffff0000, v90
    v_and_b32 v93, 0xffff0000, v92
    v_lshlrev_b32 v90, 16, v90
    v_lshlrev_b32 v92, 16, v92
    v_pk_fma_f32 v[132:133], v[90:91], v[30:31], v[132:133] op_sel:[0,0,0] op_sel_hi:[1,0,1]
    v_pk_fma_f32 v[148:149], v[92:93], v[30:31], v[148:149] op_sel:[0,1,0] op_sel_hi:[1,1,1]
    v_and_b32 v89, 0xffff0000, v83
    v_lshlrev_b32 v88, 16, v83
    v_lshlrev_b32 v90, 16, v67
    v_lshlrev_b32 v92, 16, v75
    v_and_b32 v91, 0xffff0000, v67
    v_and_b32 v93, 0xffff0000, v75
    v_pk_mul_f32 v[90:91], v[90:91], v[88:89]
    v_pk_mul_f32 v[92:93], v[92:93], v[88:89]
    v_cvt_pk_bf16_f32 v90, v90, v91
    v_cvt_pk_bf16_f32 v92, v92, v93
    v_and_b32 v91, 0xffff0000, v90
    v_and_b32 v93, 0xffff0000, v92
    v_lshlrev_b32 v90, 16, v90
    v_lshlrev_b32 v92, 16, v92
    v_pk_fma_f32 v[134:135], v[90:91], v[30:31], v[134:135] op_sel:[0,0,0] op_sel_hi:[1,0,1]
    v_pk_fma_f32 v[150:151], v[92:93], v[30:31], v[150:151] op_sel:[0,1,0] op_sel_hi:[1,1,1]
    v_and_b32 v89, 0xffff0000, v84
    v_lshlrev_b32 v88, 16, v84
    v_lshlrev_b32 v90, 16, v68
    v_lshlrev_b32 v92, 16, v76
    v_and_b32 v91, 0xffff0000, v68
    v_and_b32 v93, 0xffff0000, v76
    v_pk_mul_f32 v[90:91], v[90:91], v[88:89]
    v_pk_mul_f32 v[92:93], v[92:93], v[88:89]
    v_cvt_pk_bf16_f32 v90, v90, v91
    v_cvt_pk_bf16_f32 v92, v92, v93
    v_and_b32 v91, 0xffff0000, v90
    v_and_b32 v93, 0xffff0000, v92
    v_lshlrev_b32 v90, 16, v90
    v_lshlrev_b32 v92, 16, v92
    v_pk_fma_f32 v[136:137], v[90:91], v[30:31], v[136:137] op_sel:[0,0,0] op_sel_hi:[1,0,1]
    v_pk_fma_f32 v[152:153], v[92:93], v[30:31], v[152:153] op_sel:[0,1,0] op_sel_hi:[1,1,1]
    v_and_b32 v89, 0xffff0000, v85
    v_lshlrev_b32 v88, 16, v85
    v_lshlrev_b32 v90, 16, v69
    v_lshlrev_b32 v92, 16, v77
    v_and_b32 v91, 0xffff0000, v69
    v_and_b32 v93, 0xffff0000, v77
    v_pk_mul_f32 v[90:91], v[90:91], v[88:89]
    v_pk_mul_f32 v[92:93], v[92:93], v[88:89]
    v_cvt_pk_bf16_f32 v90, v90, v91
    v_cvt_pk_bf16_f32 v92, v92, v93
    v_and_b32 v91, 0xffff0000, v90
    v_and_b32 v93, 0xffff0000, v92
    v_lshlrev_b32 v90, 16, v90
    v_lshlrev_b32 v92, 16, v92
    v_pk_fma_f32 v[138:139], v[90:91], v[30:31], v[138:139] op_sel:[0,0,0] op_sel_hi:[1,0,1]
    v_pk_fma_f32 v[154:155], v[92:93], v[30:31], v[154:155] op_sel:[0,1,0] op_sel_hi:[1,1,1]
    v_and_b32 v89, 0xffff0000, v86
    v_lshlrev_b32 v88, 16, v86
    v_lshlrev_b32 v90, 16, v70
    v_lshlrev_b32 v92, 16, v78
    v_and_b32 v91, 0xffff0000, v70
    v_and_b32 v93, 0xffff0000, v78
    v_pk_mul_f32 v[90:91], v[90:91], v[88:89]
    v_pk_mul_f32 v[92:93], v[92:93], v[88:89]
    v_cvt_pk_bf16_f32 v90, v90, v91
    v_cvt_pk_bf16_f32 v92, v92, v93
    v_and_b32 v91, 0xffff0000, v90
    v_and_b32 v93, 0xffff0000, v92
    v_lshlrev_b32 v90, 16, v90
    v_lshlrev_b32 v92, 16, v92
    v_pk_fma_f32 v[140:141], v[90:91], v[30:31], v[140:141] op_sel:[0,0,0] op_sel_hi:[1,0,1]
    v_pk_fma_f32 v[156:157], v[92:93], v[30:31], v[156:157] op_sel:[0,1,0] op_sel_hi:[1,1,1]
    v_and_b32 v89, 0xffff0000, v87
    v_lshlrev_b32 v88, 16, v87
    v_lshlrev_b32 v90, 16, v71
    v_lshlrev_b32 v92, 16, v79
    v_and_b32 v91, 0xffff0000, v71
    v_and_b32 v93, 0xffff0000, v79
    v_pk_mul_f32 v[90:91], v[90:91], v[88:89]
    v_pk_mul_f32 v[92:93], v[92:93], v[88:89]
    v_cvt_pk_bf16_f32 v90, v90, v91
    v_cvt_pk_bf16_f32 v92, v92, v93
    v_and_b32 v91, 0xffff0000, v90
    v_and_b32 v93, 0xffff0000, v92
    v_lshlrev_b32 v90, 16, v90
    v_lshlrev_b32 v92, 16, v92
    v_pk_fma_f32 v[142:143], v[90:91], v[30:31], v[142:143] op_sel:[0,0,0] op_sel_hi:[1,0,1]
    v_pk_fma_f32 v[158:159], v[92:93], v[30:31], v[158:159] op_sel:[0,1,0] op_sel_hi:[1,1,1]
    s_waitcnt vmcnt(0)
    v_cmp_ne_u32 vcc, 1, v59
    s_mov_b32 s74, 0
    s_nop 0
    s_cmp_eq_u64 vcc, 0
    s_cbranch_scc0 P2_xa
    buffer_load_dwordx4 v[96:99], v15, s[20:23], s80 offen offset:0 sc1
    buffer_load_dwordx4 v[100:103], v15, s[20:23], s80 offen offset:1024 sc1
    buffer_load_dwordx4 v[104:107], v15, s[20:23], s80 offen offset:2048 sc1
    buffer_load_dwordx4 v[108:111], v15, s[20:23], s80 offen offset:3072 sc1
    buffer_load_dwordx4 v[112:115], v15, s[20:23], s81 offen offset:0 sc1
    buffer_load_dwordx4 v[116:119], v15, s[20:23], s81 offen offset:1024 sc1
    buffer_load_dwordx4 v[120:123], v15, s[20:23], s81 offen offset:2048 sc1
    buffer_load_dwordx4 v[124:127], v15, s[20:23], s81 offen offset:3072 sc1
    s_mov_b32 s74, 1
    s_branch P2_xb
P2_xa:
    buffer_load_dword v59, off, s[20:23], s83 sc1
P2_xb:
    s_waitcnt lgkmcnt(0)
    v_pk_add_f32 v[160:161], v[160:161], v[192:193]
    v_pk_add_f32 v[128:129], v[128:129], v[224:225]
    v_pk_add_f32 v[162:163], v[162:163], v[194:195]
    v_pk_add_f32 v[130:131], v[130:131], v[226:227]
    v_pk_add_f32 v[128:129], v[128:129], v[160:161]
    v_pk_add_f32 v[130:131], v[130:131], v[162:163]
    v_pk_add_f32 v[164:165], v[164:165], v[196:197]
    v_pk_add_f32 v[132:133], v[132:133], v[228:229]
    v_pk_add_f32 v[166:167], v[166:167], v[198:199]
    v_pk_add_f32 v[134:135], v[134:135], v[230:231]
    v_pk_add_f32 v[132:133], v[132:133], v[164:165]
    v_pk_add_f32 v[134:135], v[134:135], v[166:167]
    v_pk_add_f32 v[168:169], v[168:169], v[200:201]
    v_pk_add_f32 v[136:137], v[136:137], v[232:233]
    v_pk_add_f32 v[170:171], v[170:171], v[202:203]
    v_pk_add_f32 v[138:139], v[138:139], v[234:235]
    v_pk_add_f32 v[136:137], v[136:137], v[168:169]
    v_pk_add_f32 v[138:139], v[138:139], v[170:171]
    v_pk_add_f32 v[172:173], v[172:173], v[204:205]
    v_pk_add_f32 v[140:141], v[140:141], v[236:237]
    v_pk_add_f32 v[174:175], v[174:175], v[206:207]
    v_pk_add_f32 v[142:143], v[142:143], v[238:239]
    v_pk_add_f32 v[140:141], v[140:141], v[172:173]
    v_pk_add_f32 v[142:143], v[142:143], v[174:175]
    v_pk_add_f32 v[176:177], v[176:177], v[208:209]
    v_pk_add_f32 v[144:145], v[144:145], v[240:241]
    v_pk_add_f32 v[178:179], v[178:179], v[210:211]
    v_pk_add_f32 v[146:147], v[146:147], v[242:243]
    v_pk_add_f32 v[144:145], v[144:145], v[176:177]
    v_pk_add_f32 v[146:147], v[146:147], v[178:179]
    v_pk_add_f32 v[180:181], v[180:181], v[212:213]
    v_pk_add_f32 v[148:149], v[148:149], v[244:245]
    v_pk_add_f32 v[182:183], v[182:183], v[214:215]
    v_pk_add_f32 v[150:151], v[150:151], v[246:247]
    v_pk_add_f32 v[148:149], v[148:149], v[180:181]
    v_pk_add_f32 v[150:151], v[150:151], v[182:183]
    v_pk_add_f32 v[184:185], v[184:185], v[216:217]
    v_pk_add_f32 v[152:153], v[152:153], v[248:249]
    v_pk_add_f32 v[186:187], v[186:187], v[218:219]
    v_pk_add_f32 v[154:155], v[154:155], v[250:251]
    v_pk_add_f32 v[152:153], v[152:153], v[184:185]
    v_pk_add_f32 v[154:155], v[154:155], v[186:187]
    v_pk_add_f32 v[188:189], v[188:189], v[220:221]
    v_pk_add_f32 v[156:157], v[156:157], v[252:253]
    v_pk_add_f32 v[190:191], v[190:191], v[222:223]
    v_pk_add_f32 v[158:159], v[158:159], v[254:255]
    v_pk_add_f32 v[156:157], v[156:157], v[188:189]
    v_pk_add_f32 v[158:159], v[158:159], v[190:191]
    s_cmp_eq_u32 s74, 1
    s_cbranch_scc1 P2_xc
    s_waitcnt vmcnt(0)
    s_mov_b32 s75, 0
P2_x:
    v_cmp_ne_u32 vcc, 1, v59
    s_add_u32 s75, s75, 1
    s_nop 0
    s_cmp_eq_u64 vcc, 0
    s_cbranch_scc1 P2_xok
    s_cmp_ge_u32 s75, 0x4000
    s_cbranch_scc1 P2_xok
    s_sleep 1
    buffer_load_dword v59, off, s[20:23], s83 sc1
    s_waitcnt vmcnt(0)
    s_branch P2_x
P2_xok:
    buffer_load_dwordx4 v[96:99], v15, s[20:23], s80 offen offset:0 sc1
    buffer_load_dwordx4 v[100:103], v15, s[20:23], s80 offen offset:1024 sc1
    buffer_load_dwordx4 v[104:107], v15, s[20:23], s80 offen offset:2048 sc1
    buffer_load_dwordx4 v[108:111], v15, s[20:23], s80 offen offset:3072 sc1
    buffer_load_dwordx4 v[112:115], v15, s[20:23], s81 offen offset:0 sc1
    buffer_load_dwordx4 v[116:119], v15, s[20:23], s81 offen offset:1024 sc1
    buffer_load_dwordx4 v[120:123], v15, s[20:23], s81 offen offset:2048 sc1
    buffer_load_dwordx4 v[124:127], v15, s[20:23], s81 offen offset:3072 sc1
P2_xc:
    s_waitcnt vmcnt(7)
    v_pk_add_f32 v[128:129], v[128:129], v[96:97]
    v_pk_add_f32 v[130:131], v[130:131], v[98:99]
    buffer_store_dwordx4 v[128:131], v28, s[12:15], 0 offen offset:0
    s_waitcnt vmcnt(7)
    v_pk_add_f32 v[132:133], v[132:133], v[100:101]
    v_pk_add_f32 v[134:135], v[134:135], v[102:103]
    buffer_store_dwordx4 v[132:135], v28, s[12:15], 0 offen offset:64
    s_waitcnt vmcnt(7)
    v_pk_add_f32 v[136:137], v[136:137], v[104:105]
    v_pk_add_f32 v[138:139], v[138:139], v[106:107]
    buffer_store_dwordx4 v[136:139], v28, s[12:15], 0 offen offset:128
    s_waitcnt vmcnt(7)
    v_pk_add_f32 v[140:141], v[140:141], v[108:109]
    v_pk_add_f32 v[142:143], v[142:143], v[110:111]
    buffer_store_dwordx4 v[140:143], v28, s[12:15], 0 offen offset:192
    s_waitcnt vmcnt(7)
    v_pk_add_f32 v[144:145], v[144:145], v[112:113]
    v_pk_add_f32 v[146:147], v[146:147], v[114:115]
    buffer_store_dwordx4 v[144:147], v29, s[12:15], 0 offen offset:0
    s_waitcnt vmcnt(7)
    v_pk_add_f32 v[148:149], v[148:149], v[116:117]
    v_pk_add_f32 v[150:151], v[150:151], v[118:119]
    buffer_store_dwordx4 v[148:151], v29, s[12:15], 0 offen offset:64
    s_waitcnt vmcnt(7)
    v_pk_add_f32 v[152:153], v[152:153], v[120:121]
    v_pk_add_f32 v[154:155], v[154:155], v[122:123]
    buffer_store_dwordx4 v[152:155], v29, s[12:15], 0 offen offset:128
    s_waitcnt vmcnt(7)
    v_pk_add_f32 v[156:157], v[156:157], v[124:125]
    v_pk_add_f32 v[158:159], v[158:159], v[126:127]
    buffer_store_dwordx4 v[156:159], v29, s[12:15], 0 offen offset:192
    s_waitcnt vmcnt(0)
K1_done:
    s_endpgm
K1_t1:
    s_lshl_b32 s6, 1, s4
    v_mov_b32 v26, s6
    s_lshl_b32 s7, s5, 2
    s_mov_b64 exec, 1
    buffer_atomic_add v26, off, s[24:27], s7 offset:128 sc1
    s_mov_b64 exec, -1
    s_branch K1_tback
CP_end:
.section .rodata,"a"
.p2align 6
.amdhsa_kernel gated_mix__ssm_conv_s5__glu_gated_reglu__prompt_kernel
  .amdhsa_next_free_vgpr 512
  .amdhsa_next_free_sgpr 96
  .amdhsa_accum_offset 256
  .amdhsa_group_segment_fixed_size 0
  .amdhsa_kernarg_size 136
  .amdhsa_user_sgpr_count 2
  .amdhsa_user_sgpr_kernarg_segment_ptr 1
  .amdhsa_system_sgpr_workgroup_id_x 1
.end_amdhsa_kernel
```
